```python
import torch

def _softmax(x, axis=-1):
    return torch.softmax(x, dim=axis)
def _gelu(x):
    return torch.nn.functional.gelu(x, approximate="tanh")
def _silu(x):
    return torch.nn.functional.silu(x)
def _sigmoid(x):
    return torch.sigmoid(x)
def _layernorm(x, axis=-1, eps=1e-5):
    m = x.mean(dim=axis, keepdim=True)
    v = x.var(dim=axis, keepdim=True, unbiased=False)
    return (x - m) / torch.sqrt(v + eps)
def _scatter_add(tgt, idx, src, axis=0):
    return tgt.clone().index_add_(axis, idx, src)
def _segment_sum(src, seg, n):
    out = torch.zeros((n,) + src.shape[1:], dtype=src.dtype)
    return out.index_add_(0, seg, src)
def _pad(x, pw):
    flat = tuple(v for pair in reversed(pw) for v in pair)
    return torch.nn.functional.pad(x, flat)

kernel_name = 'sequential_preLN__mha_block__mixer_token_mlp__prompt'

def setup_inputs():

    _w = (lambda a: (lambda t: t.to(torch.bfloat16) if t.is_floating_point() else t)(torch.as_tensor(a)))
    def _A_setup():
        B, S, D, H = 1, 2048, 512, 32
        return {
            "x": _w((lambda *s: torch.randn(*s, dtype=torch.bfloat16) * 0.05)(B, S, D)),
            "wqkv": _w((lambda *s: torch.randn(*s, dtype=torch.bfloat16) * 0.05)(D, 3 * D)),
            "wo": _w((lambda *s: torch.randn(*s, dtype=torch.bfloat16) * 0.05)(D, D)),
        }
    _A_in = _A_setup()

    def _B_setup():
        B, S, D, F = 1, 2048, 512, 1792
        return {
            "x": _w((lambda *s: torch.randn(*s, dtype=torch.bfloat16) * 0.05)(B, S, D)),
            "w1": _w((lambda *s: torch.randn(*s, dtype=torch.bfloat16) * 0.8)(S, F) * (S ** -0.5)),
            "b1": _w((lambda *s: torch.randn(*s, dtype=torch.bfloat16) * 12.8)(F) * 0.02),
            "w2": _w((lambda *s: torch.randn(*s, dtype=torch.bfloat16) * 0.2)(F, S) * (F ** -0.5)),
            "b2": _w((lambda *s: torch.randn(*s, dtype=torch.bfloat16) * 3.2)(S) * 0.02),
        }
    _B_in = _B_setup()

    return {
        "A_x": _A_in["x"],
        "A_wqkv": _A_in["wqkv"],
        "A_wo": _A_in["wo"],
        "B_x": _B_in["x"],
        "B_w1": _B_in["w1"],
        "B_b1": _B_in["b1"],
        "B_w2": _B_in["w2"],
        "B_b2": _B_in["b2"],
    }

def reference(A_x, A_wqkv, A_wo, B_x, B_w1, B_b1, B_w2, B_b2):
    def _A_ref(x, wqkv, wo):
        B, S, D = x.shape
        H = 32
        Dh = D // H
        qkv = (lambda x, *d: x.permute(*d))((x @ wqkv).reshape(B, S, 3, H, Dh), 2, 0, 3, 1, 4)
        q, k, v = qkv[0], qkv[1], qkv[2]
        scores = torch.einsum("bhqd,bhkd->bhqk", q, k) * (Dh ** -0.5)
        p = _softmax(scores, axis=-1)
        o = torch.einsum("bhqk,bhkd->bhqd", p, v)
        return (lambda x, *d: x.permute(*d))(o, 0, 2, 1, 3).reshape(B, S, D) @ wo

    def _B_ref(x, w1, b1, w2, b2):
        B, S, D = x.shape
        h = _layernorm(x, axis=-1)
        u = torch.einsum("bsd,sf->bdf", h, w1) + b1
        u = _gelu(u)
        y = torch.einsum("bdf,fs->bds", u, w2) + b2
        return (lambda x, *d: x.permute(*d))(y, 0, 2, 1)

    x = A_x
    h = x + _A_ref(_layernorm(x, axis=-1), A_wqkv, A_wo)
    h2 = h + _B_ref(_layernorm(h, axis=-1), B_w1, B_b1, B_w2, B_b2)
    return h2
```

```asm
; @launch grid=(256,1,1) block=(256,1,1) lds=163840
.amdgcn_target "amdgcn-amd-amdhsa--gfx950"
.text
.set K2_CODE_BYTES, 56512
.globl sequential_preLN__mha_block__mixer_token_mlp__prompt_kernel
.p2align 8
.type sequential_preLN__mha_block__mixer_token_mlp__prompt_kernel,@function
sequential_preLN__mha_block__mixer_token_mlp__prompt_kernel:
    s_cmp_ge_u32 s2, 256
    s_cbranch_scc1 L_sequential_preLN__mha_block__mixer_token_mlp__prompt_kernel_end
    s_load_dwordx16 s[40:55], s[0:1], 0
    s_load_dwordx2 s[20:21], s[0:1], 80
    s_load_dwordx2 s[56:57], s[0:1], 64
    s_load_dwordx2 s[84:85], s[0:1], 72
    v_lshrrev_b32 v2, 6, v0
    v_and_b32 v1, 63, v0
    v_readfirstlane_b32 s22, v2
    s_getpc_b64 s[32:33]
L_k1_pc:
    v_lshlrev_b32 v26, 6, v0
    global_load_dword v8, v26, s[32:33]
    s_and_b32 s23, s2, 3
    s_lshl_b32 s23, s23, 2
    s_lshr_b32 s29, s2, 3
    s_and_b32 s30, s29, 3
    s_add_u32 s23, s23, s30
    s_bfe_u32 s24, s2, 0x10002
    s_lshl_b32 s24, s24, 3
    s_lshr_b32 s30, s29, 2
    s_add_u32 s24, s24, s30
    s_lshl_b32 s25, s23, 17
    s_lshl_b32 s30, s22, 15
    s_add_u32 s25, s25, s30
    s_add_u32 s38, s24, 5
    s_and_b32 s38, s38, 15
    s_add_u32 s39, s24, 10
    s_and_b32 s39, s39, 15
    s_mul_i32 s30, s22, 49152
    s_lshl_b32 s70, s24, 6
    s_add_u32 s70, s70, s30
    s_lshl_b32 s71, s38, 6
    s_add_u32 s71, s71, s30
    s_lshl_b32 s72, s39, 6
    s_add_u32 s72, s72, s30
    s_lshl_b32 s27, s22, 12
    s_add_u32 s27, s27, 1024
    s_lshl_b32 s28, s22, 10
    s_add_u32 s28, s28, 17408
    v_lshrrev_b32 v10, 3, v1
    v_lshlrev_b32 v10, 10, v10
    v_lshrrev_b32 v11, 4, v1
    v_and_b32 v12, 7, v1
    v_xor_b32 v11, v11, v12
    v_xor_b32 v12, 0, v11
    v_lshl_add_u32 v12, v12, 4, v10
    v_add_u32 v2, 0, v12
    v_xor_b32 v12, 4, v11
    v_lshl_add_u32 v12, v12, 4, v10
    v_add_u32 v3, 7168, v12
    v_xor_b32 v12, 0, v11
    v_lshl_add_u32 v12, v12, 4, v10
    v_add_u32 v4, 14336, v12
    v_xor_b32 v12, 4, v11
    v_lshl_add_u32 v12, v12, 4, v10
    v_add_u32 v5, 21504, v12
    v_lshrrev_b32 v10, 2, v1
    s_movk_i32 s30, 3072
    v_mul_lo_u32 v10, v10, s30
    v_and_b32 v11, 3, v1
    v_lshl_add_u32 v6, v11, 4, v10
    s_waitcnt lgkmcnt(0)
    s_mov_b32 s8, s40
    s_and_b32 s9, s41, 0xffff
    s_mov_b32 s10, 2097152
    s_mov_b32 s11, 0x00020000
    s_mov_b32 s12, s42
    s_and_b32 s13, s43, 0xffff
    s_mov_b32 s14, 1572864
    s_mov_b32 s15, 0x00020000
    s_mov_b32 s16, s20
    s_and_b32 s17, s21, 0xffff
    s_mov_b32 s18, 16777216
    s_mov_b32 s19, 0x00020000
    s_add_u32 m0, s27, 0
    s_nop 0
    buffer_load_dwordx4 v2, s[8:11], s25 offen offset:0 lds
    buffer_load_dwordx4 v3, s[8:11], s25 offen offset:1024 lds
    buffer_load_dwordx4 v4, s[8:11], s25 offen offset:2048 lds
    buffer_load_dwordx4 v5, s[8:11], s25 offen offset:3072 lds
    s_add_u32 m0, s28, 0
    s_add_u32 s29, s70, 0
    buffer_load_dwordx4 v6, s[12:15], s29 offen offset:0 lds
    s_add_u32 m0, s28, 3072
    s_add_u32 s29, s71, 0
    buffer_load_dwordx4 v6, s[12:15], s29 offen offset:1024 lds
    s_add_u32 m0, s28, 6144
    s_add_u32 s29, s72, 0
    buffer_load_dwordx4 v6, s[12:15], s29 offen offset:2048 lds
    s_add_u32 m0, s27, 28544
    s_nop 0
    buffer_load_dwordx4 v2, s[8:11], s25 offen offset:128 lds
    buffer_load_dwordx4 v3, s[8:11], s25 offen offset:1152 lds
    buffer_load_dwordx4 v4, s[8:11], s25 offen offset:2176 lds
    buffer_load_dwordx4 v5, s[8:11], s25 offen offset:3200 lds
    s_add_u32 m0, s28, 28672
    s_add_u32 s29, s70, 196608
    buffer_load_dwordx4 v6, s[12:15], s29 offen offset:0 lds
    s_add_u32 m0, s28, 31744
    s_add_u32 s29, s71, 196608
    buffer_load_dwordx4 v6, s[12:15], s29 offen offset:1024 lds
    s_add_u32 m0, s28, 34816
    s_add_u32 s29, s72, 196608
    buffer_load_dwordx4 v6, s[12:15], s29 offen offset:2048 lds
    s_add_u32 m0, s27, 57088
    s_nop 0
    buffer_load_dwordx4 v2, s[8:11], s25 offen offset:256 lds
    buffer_load_dwordx4 v3, s[8:11], s25 offen offset:1280 lds
    buffer_load_dwordx4 v4, s[8:11], s25 offen offset:2304 lds
    buffer_load_dwordx4 v5, s[8:11], s25 offen offset:3328 lds
    s_add_u32 m0, s28, 57344
    s_add_u32 s29, s70, 393216
    buffer_load_dwordx4 v6, s[12:15], s29 offen offset:0 lds
    s_add_u32 m0, s28, 60416
    s_add_u32 s29, s71, 393216
    buffer_load_dwordx4 v6, s[12:15], s29 offen offset:1024 lds
    s_add_u32 m0, s28, 63488
    s_add_u32 s29, s72, 393216
    buffer_load_dwordx4 v6, s[12:15], s29 offen offset:2048 lds
    s_mov_b32 s34, s32
    s_mov_b32 s35, s33
    s_lshr_b32 s36, s2, 3
    s_lshl_b32 s36, s36, 11
    v_and_b32 v27, 31, v0
    v_lshlrev_b32 v27, 6, v27
    v_add_u32 v27, s36, v27
    v_min_u32 v27, K2_CODE_BYTES, v27
    global_load_dword v9, v27, s[34:35]
    s_cmp_ge_u32 s2, 16
    s_cselect_b32 s33, 0x7ffffff0, 0
    s_lshl_b32 s36, s2, 8
    s_add_u32 s36, s36, 6356992
    s_add_u32 s36, s36, s33
    v_mov_b32 v20, 0
    v_mov_b32 v21, 0
    buffer_store_dword v20, v21, s[16:19], s36 offen sc1
    s_add_u32 s36, s36, 4096
    buffer_store_dword v20, v21, s[16:19], s36 offen sc1
    v_and_b32 v10, 31, v1
    v_lshrrev_b32 v11, 5, v1
    v_bfe_u32 v16, v1, 1, 3
    v_lshlrev_b32 v10, 7, v10
    v_add_u32 v10, s27, v10
    v_add_u32 v17, 0, v11
    v_xor_b32 v17, v17, v16
    v_lshl_add_u32 v12, v17, 4, v10
    v_add_u32 v17, 2, v11
    v_xor_b32 v17, v17, v16
    v_lshl_add_u32 v13, v17, 4, v10
    v_add_u32 v17, 4, v11
    v_xor_b32 v17, v17, v16
    v_lshl_add_u32 v14, v17, 4, v10
    v_add_u32 v17, 6, v11
    v_xor_b32 v17, v17, v16
    v_lshl_add_u32 v15, v17, 4, v10
    v_bfe_u32 v10, v1, 2, 2
    v_lshl_add_u32 v10, v11, 3, v10
    v_lshlrev_b32 v10, 6, v10
    v_bfe_u32 v16, v1, 4, 1
    v_lshl_add_u32 v10, v16, 5, v10
    v_and_b32 v16, 3, v1
    v_lshl_add_u32 v10, v16, 3, v10
    v_add_u32 v7, 17408, v10
    s_lshl_b32 s30, s22, 10
    v_add_u32 v11, s30, v7
    v_mov_b32 v60, 0
    v_mov_b32 v61, 0
    v_mov_b32 v62, 0
    v_mov_b32 v63, 0
    v_mov_b32 v64, 0
    v_mov_b32 v65, 0
    v_mov_b32 v66, 0
    v_mov_b32 v67, 0
    v_mov_b32 v68, 0
    v_mov_b32 v69, 0
    v_mov_b32 v80, 0
    v_mov_b32 v81, 0
    v_mov_b32 v82, 0
    v_mov_b32 v83, 0
    v_mov_b32 v84, 0
    v_mov_b32 v85, 0
    v_mov_b32 v86, 0
    v_mov_b32 v87, 0
    v_mov_b32 v88, 0
    v_mov_b32 v89, 0
    v_mov_b32 v90, 0
    v_mov_b32 v91, 0
    v_mov_b32 v92, 0
    v_mov_b32 v93, 0
    v_mov_b32 v94, 0
    v_mov_b32 v95, 0
    v_mov_b32 v96, 0
    v_mov_b32 v97, 0
    v_mov_b32 v98, 0
    v_mov_b32 v99, 0
    v_mov_b32 v100, 0
    v_mov_b32 v101, 0
    v_mov_b32 v102, 0
    v_mov_b32 v103, 0
    v_mov_b32 v104, 0
    v_mov_b32 v105, 0
    v_mov_b32 v106, 0
    v_mov_b32 v107, 0
    v_mov_b32 v108, 0
    v_mov_b32 v109, 0
    v_mov_b32 v110, 0
    v_mov_b32 v111, 0
    v_mov_b32 v112, 0
    v_mov_b32 v113, 0
    v_mov_b32 v114, 0
    v_mov_b32 v115, 0
    v_mov_b32 v116, 0
    v_mov_b32 v117, 0
    v_mov_b32 v118, 0
    v_mov_b32 v119, 0
    v_mov_b32 v120, 0
    v_mov_b32 v121, 0
    v_mov_b32 v122, 0
    v_mov_b32 v123, 0
    v_mov_b32 v124, 0
    v_mov_b32 v125, 0
    v_mov_b32 v126, 0
    v_mov_b32 v127, 0
    s_mov_b32 s31, 0x3f803f80
    s_add_u32 m0, s27, 85504
    s_nop 0
    buffer_load_dwordx4 v2, s[8:11], s25 offen offset:512 lds
    buffer_load_dwordx4 v3, s[8:11], s25 offen offset:1536 lds
    buffer_load_dwordx4 v4, s[8:11], s25 offen offset:2560 lds
    buffer_load_dwordx4 v5, s[8:11], s25 offen offset:3584 lds
    s_add_u32 m0, s28, 86016
    s_add_u32 s29, s70, 786432
    buffer_load_dwordx4 v6, s[12:15], s29 offen offset:0 lds
    s_add_u32 m0, s28, 89088
    s_add_u32 s29, s71, 786432
    buffer_load_dwordx4 v6, s[12:15], s29 offen offset:1024 lds
    s_add_u32 m0, s28, 92160
    s_add_u32 s29, s72, 786432
    buffer_load_dwordx4 v6, s[12:15], s29 offen offset:2048 lds
    v_mov_b32 v44, 0x3f80
    v_mov_b32 v45, 0x3f800000
    v_and_b32 v42, 31, v1
    v_lshrrev_b32 v43, 5, v1
    v_lshlrev_b32 v43, 2, v43
    v_sub_u32 v42, v42, v43
    v_cmp_eq_u32 vcc, 0, v42
    v_cmp_eq_u32 s[58:59], 1, v42
    s_nop 0
    v_cndmask_b32 v34, 0, v44, vcc
    v_cndmask_b32 v34, v34, v45, s[58:59]
    v_cmp_eq_u32 vcc, 2, v42
    v_cmp_eq_u32 s[58:59], 3, v42
    s_nop 0
    v_cndmask_b32 v35, 0, v44, vcc
    v_cndmask_b32 v35, v35, v45, s[58:59]
    v_cmp_eq_u32 vcc, 8, v42
    v_cmp_eq_u32 s[58:59], 9, v42
    s_nop 0
    v_cndmask_b32 v36, 0, v44, vcc
    v_cndmask_b32 v36, v36, v45, s[58:59]
    v_cmp_eq_u32 vcc, 10, v42
    v_cmp_eq_u32 s[58:59], 11, v42
    s_nop 0
    v_cndmask_b32 v37, 0, v44, vcc
    v_cndmask_b32 v37, v37, v45, s[58:59]
    v_cmp_eq_u32 vcc, 16, v42
    v_cmp_eq_u32 s[58:59], 17, v42
    s_nop 0
    v_cndmask_b32 v38, 0, v44, vcc
    v_cndmask_b32 v38, v38, v45, s[58:59]
    v_cmp_eq_u32 vcc, 18, v42
    v_cmp_eq_u32 s[58:59], 19, v42
    s_nop 0
    v_cndmask_b32 v39, 0, v44, vcc
    v_cndmask_b32 v39, v39, v45, s[58:59]
    v_cmp_eq_u32 vcc, 24, v42
    v_cmp_eq_u32 s[58:59], 25, v42
    s_nop 0
    v_cndmask_b32 v40, 0, v44, vcc
    v_cndmask_b32 v40, v40, v45, s[58:59]
    v_cmp_eq_u32 vcc, 26, v42
    v_cmp_eq_u32 s[58:59], 27, v42
    s_nop 0
    v_cndmask_b32 v41, 0, v44, vcc
    v_cndmask_b32 v41, v41, v45, s[58:59]
    v_and_b32 v44, 31, v1
    v_lshlrev_b32 v44, 2, v44
    s_waitcnt vmcnt(24)
    s_barrier
    ds_read_b128 v[128:131], v12
    ds_read_b64_tr_b16 v[132:133], v7 offset:0
    ds_read_b64_tr_b16 v[134:135], v7 offset:256
    ds_read_b64_tr_b16 v[136:137], v7 offset:4096
    ds_read_b64_tr_b16 v[138:139], v7 offset:4352
    ds_read_b64_tr_b16 v[140:141], v7 offset:8192
    ds_read_b64_tr_b16 v[142:143], v7 offset:8448
    ds_read_b128 v[144:147], v13
    ds_read_b64_tr_b16 v[148:149], v7 offset:1024
    ds_read_b64_tr_b16 v[150:151], v7 offset:1280
    ds_read_b64_tr_b16 v[152:153], v7 offset:5120
    ds_read_b64_tr_b16 v[154:155], v7 offset:5376
    ds_read_b64_tr_b16 v[156:157], v7 offset:9216
    ds_read_b64_tr_b16 v[158:159], v7 offset:9472
    s_waitcnt lgkmcnt(8)
    ds_read_b128 v[160:163], v14
    ds_read_b64_tr_b16 v[164:165], v7 offset:2048
    ds_read_b64_tr_b16 v[166:167], v7 offset:2304
    ds_read_b64_tr_b16 v[168:169], v7 offset:6144
    ds_read_b64_tr_b16 v[170:171], v7 offset:6400
    ds_read_b64_tr_b16 v[172:173], v7 offset:10240
    ds_read_b64_tr_b16 v[174:175], v7 offset:10496
    s_waitcnt lgkmcnt(8)
    ds_read_b128 v[176:179], v15
    ds_read_b64_tr_b16 v[180:181], v7 offset:3072
    ds_read_b64_tr_b16 v[182:183], v7 offset:3328
    ds_read_b64_tr_b16 v[184:185], v7 offset:7168
    ds_read_b64_tr_b16 v[186:187], v7 offset:7424
    ds_read_b64_tr_b16 v[188:189], v7 offset:11264
    ds_read_b64_tr_b16 v[190:191], v7 offset:11520
    s_waitcnt lgkmcnt(9)
    ds_read_b64_tr_b16 v[48:49], v11 offset:0
    ds_read_b64_tr_b16 v[50:51], v11 offset:256
    ds_read_b64_tr_b16 v[52:53], v11 offset:4096
    ds_read_b64_tr_b16 v[54:55], v11 offset:4352
    ds_read_b64_tr_b16 v[56:57], v11 offset:8192
    ds_read_b64_tr_b16 v[58:59], v11 offset:8448
    s_add_u32 m0, s27, 114048
    s_nop 0
    buffer_load_dwordx4 v2, s[8:11], s25 offen offset:640 lds
    buffer_load_dwordx4 v3, s[8:11], s25 offen offset:1664 lds
    buffer_load_dwordx4 v4, s[8:11], s25 offen offset:2688 lds
    buffer_load_dwordx4 v5, s[8:11], s25 offen offset:3712 lds
    s_add_u32 m0, s28, 114688
    s_add_u32 s29, s70, 983040
    buffer_load_dwordx4 v6, s[12:15], s29 offen offset:0 lds
    s_add_u32 m0, s28, 117760
    s_add_u32 s29, s71, 983040
    buffer_load_dwordx4 v6, s[12:15], s29 offen offset:1024 lds
    s_add_u32 m0, s28, 120832
    s_add_u32 s29, s72, 983040
    buffer_load_dwordx4 v6, s[12:15], s29 offen offset:2048 lds
    s_waitcnt lgkmcnt(0)
    s_waitcnt vmcnt(24)
    s_barrier
    v_add_u32 v12, 28672, v12
    v_add_u32 v13, 28672, v13
    v_add_u32 v14, 28672, v14
    v_add_u32 v15, 28672, v15
    v_add_u32 v7, 28672, v7
    v_add_u32 v11, 28672, v11
    v_mfma_f32_32x32x16_bf16 v[80:95], v[132:135], v[128:131], v[80:95]
    ds_read_b128 v[192:195], v12
    ds_read_b64_tr_b16 v[196:197], v7 offset:0
    ds_read_b64_tr_b16 v[198:199], v7 offset:256
    v_mfma_f32_32x32x16_bf16 v[96:111], v[136:139], v[128:131], v[96:111]
    ds_read_b64_tr_b16 v[200:201], v7 offset:4096
    ds_read_b64_tr_b16 v[202:203], v7 offset:4352
    ds_read_b64_tr_b16 v[204:205], v7 offset:8192
    ds_read_b64_tr_b16 v[206:207], v7 offset:8448
    v_mfma_f32_32x32x16_bf16 v[112:127], v[140:143], v[128:131], v[112:127]
    s_add_u32 m0, s27, -768
    s_nop 0
    buffer_load_dwordx4 v2, s[8:11], s25 offen offset:768 lds
    v_dot2c_f32_bf16 v64, s31, v48
    v_dot2c_f32_bf16 v65, s31, v49
    v_dot2c_f32_bf16 v64, s31, v50
    v_dot2c_f32_bf16 v65, s31, v51
    v_dot2c_f32_bf16 v66, s31, v52
    v_dot2c_f32_bf16 v67, s31, v53
    v_dot2c_f32_bf16 v66, s31, v54
    v_dot2c_f32_bf16 v67, s31, v55
    v_dot2c_f32_bf16 v68, s31, v56
    v_dot2c_f32_bf16 v69, s31, v57
    v_dot2c_f32_bf16 v68, s31, v58
    v_dot2c_f32_bf16 v69, s31, v59
    v_dot2c_f32_bf16 v60, s31, v128
    v_dot2c_f32_bf16 v62, v128, v128
    v_dot2c_f32_bf16 v61, s31, v129
    v_dot2c_f32_bf16 v63, v129, v129
    buffer_load_dwordx4 v3, s[8:11], s25 offen offset:1792 lds
    v_dot2c_f32_bf16 v60, s31, v130
    v_dot2c_f32_bf16 v62, v130, v130
    v_dot2c_f32_bf16 v61, s31, v131
    v_dot2c_f32_bf16 v63, v131, v131
    v_mfma_f32_32x32x16_bf16 v[80:95], v[148:151], v[144:147], v[80:95]
    ds_read_b128 v[208:211], v13
    ds_read_b64_tr_b16 v[212:213], v7 offset:1024
    ds_read_b64_tr_b16 v[214:215], v7 offset:1280
    v_mfma_f32_32x32x16_bf16 v[96:111], v[152:155], v[144:147], v[96:111]
    ds_read_b64_tr_b16 v[216:217], v7 offset:5120
    ds_read_b64_tr_b16 v[218:219], v7 offset:5376
    ds_read_b64_tr_b16 v[220:221], v7 offset:9216
    ds_read_b64_tr_b16 v[222:223], v7 offset:9472
    v_mfma_f32_32x32x16_bf16 v[112:127], v[156:159], v[144:147], v[112:127]
    buffer_load_dwordx4 v4, s[8:11], s25 offen offset:2816 lds
    v_dot2c_f32_bf16 v60, s31, v144
    v_dot2c_f32_bf16 v62, v144, v144
    v_dot2c_f32_bf16 v61, s31, v145
    v_dot2c_f32_bf16 v63, v145, v145
    buffer_load_dwordx4 v5, s[8:11], s25 offen offset:3840 lds
    v_dot2c_f32_bf16 v60, s31, v146
    v_dot2c_f32_bf16 v62, v146, v146
    v_dot2c_f32_bf16 v61, s31, v147
    v_dot2c_f32_bf16 v63, v147, v147
    v_mfma_f32_32x32x16_bf16 v[80:95], v[164:167], v[160:163], v[80:95]
    s_waitcnt lgkmcnt(8)
    ds_read_b128 v[224:227], v14
    ds_read_b64_tr_b16 v[228:229], v7 offset:2048
    ds_read_b64_tr_b16 v[230:231], v7 offset:2304
    v_mfma_f32_32x32x16_bf16 v[96:111], v[168:171], v[160:163], v[96:111]
    ds_read_b64_tr_b16 v[232:233], v7 offset:6144
    ds_read_b64_tr_b16 v[234:235], v7 offset:6400
    ds_read_b64_tr_b16 v[236:237], v7 offset:10240
    ds_read_b64_tr_b16 v[238:239], v7 offset:10496
    v_mfma_f32_32x32x16_bf16 v[112:127], v[172:175], v[160:163], v[112:127]
    s_add_u32 m0, s28, 0
    s_add_u32 s29, s70, 1179648
    buffer_load_dwordx4 v6, s[12:15], s29 offen offset:0 lds
    v_dot2c_f32_bf16 v60, s31, v160
    v_dot2c_f32_bf16 v62, v160, v160
    v_dot2c_f32_bf16 v61, s31, v161
    v_dot2c_f32_bf16 v63, v161, v161
    s_add_u32 m0, s28, 3072
    s_add_u32 s29, s71, 1179648
    buffer_load_dwordx4 v6, s[12:15], s29 offen offset:1024 lds
    v_dot2c_f32_bf16 v60, s31, v162
    v_dot2c_f32_bf16 v62, v162, v162
    v_dot2c_f32_bf16 v61, s31, v163
    v_dot2c_f32_bf16 v63, v163, v163
    v_mfma_f32_32x32x16_bf16 v[80:95], v[180:183], v[176:179], v[80:95]
    s_waitcnt lgkmcnt(8)
    ds_read_b128 v[240:243], v15
    ds_read_b64_tr_b16 v[244:245], v7 offset:3072
    ds_read_b64_tr_b16 v[246:247], v7 offset:3328
    v_mfma_f32_32x32x16_bf16 v[96:111], v[184:187], v[176:179], v[96:111]
    ds_read_b64_tr_b16 v[248:249], v7 offset:7168
    ds_read_b64_tr_b16 v[250:251], v7 offset:7424
    ds_read_b64_tr_b16 v[252:253], v7 offset:11264
    ds_read_b64_tr_b16 v[254:255], v7 offset:11520
    v_mfma_f32_32x32x16_bf16 v[112:127], v[188:191], v[176:179], v[112:127]
    s_add_u32 m0, s28, 6144
    s_add_u32 s29, s72, 1179648
    buffer_load_dwordx4 v6, s[12:15], s29 offen offset:2048 lds
    v_dot2c_f32_bf16 v60, s31, v176
    v_dot2c_f32_bf16 v62, v176, v176
    v_dot2c_f32_bf16 v61, s31, v177
    v_dot2c_f32_bf16 v63, v177, v177
    v_dot2c_f32_bf16 v60, s31, v178
    v_dot2c_f32_bf16 v62, v178, v178
    v_dot2c_f32_bf16 v61, s31, v179
    v_dot2c_f32_bf16 v63, v179, v179
    s_waitcnt lgkmcnt(9)
    ds_read_b64_tr_b16 v[48:49], v11 offset:0
    ds_read_b64_tr_b16 v[50:51], v11 offset:256
    ds_read_b64_tr_b16 v[52:53], v11 offset:4096
    ds_read_b64_tr_b16 v[54:55], v11 offset:4352
    ds_read_b64_tr_b16 v[56:57], v11 offset:8192
    ds_read_b64_tr_b16 v[58:59], v11 offset:8448
    s_waitcnt lgkmcnt(0)
    s_waitcnt vmcnt(24)
    s_barrier
    v_add_u32 v12, 28672, v12
    v_add_u32 v13, 28672, v13
    v_add_u32 v14, 28672, v14
    v_add_u32 v15, 28672, v15
    v_add_u32 v7, 28672, v7
    v_add_u32 v11, 28672, v11
    v_mfma_f32_32x32x16_bf16 v[80:95], v[196:199], v[192:195], v[80:95]
    ds_read_b128 v[128:131], v12
    ds_read_b64_tr_b16 v[132:133], v7 offset:0
    ds_read_b64_tr_b16 v[134:135], v7 offset:256
    v_mfma_f32_32x32x16_bf16 v[96:111], v[200:203], v[192:195], v[96:111]
    ds_read_b64_tr_b16 v[136:137], v7 offset:4096
    ds_read_b64_tr_b16 v[138:139], v7 offset:4352
    ds_read_b64_tr_b16 v[140:141], v7 offset:8192
    ds_read_b64_tr_b16 v[142:143], v7 offset:8448
    v_mfma_f32_32x32x16_bf16 v[112:127], v[204:207], v[192:195], v[112:127]
    s_add_u32 m0, s27, 27776
    s_nop 0
    buffer_load_dwordx4 v2, s[8:11], s25 offen offset:896 lds
    v_dot2c_f32_bf16 v64, s31, v48
    v_dot2c_f32_bf16 v65, s31, v49
    v_dot2c_f32_bf16 v64, s31, v50
    v_dot2c_f32_bf16 v65, s31, v51
    v_dot2c_f32_bf16 v66, s31, v52
    v_dot2c_f32_bf16 v67, s31, v53
    v_dot2c_f32_bf16 v66, s31, v54
    v_dot2c_f32_bf16 v67, s31, v55
    v_dot2c_f32_bf16 v68, s31, v56
    v_dot2c_f32_bf16 v69, s31, v57
    v_dot2c_f32_bf16 v68, s31, v58
    v_dot2c_f32_bf16 v69, s31, v59
    v_dot2c_f32_bf16 v60, s31, v192
    v_dot2c_f32_bf16 v62, v192, v192
    v_dot2c_f32_bf16 v61, s31, v193
    v_dot2c_f32_bf16 v63, v193, v193
    buffer_load_dwordx4 v3, s[8:11], s25 offen offset:1920 lds
    v_dot2c_f32_bf16 v60, s31, v194
    v_dot2c_f32_bf16 v62, v194, v194
    v_dot2c_f32_bf16 v61, s31, v195
    v_dot2c_f32_bf16 v63, v195, v195
    v_mfma_f32_32x32x16_bf16 v[80:95], v[212:215], v[208:211], v[80:95]
    ds_read_b128 v[144:147], v13
    ds_read_b64_tr_b16 v[148:149], v7 offset:1024
    ds_read_b64_tr_b16 v[150:151], v7 offset:1280
    v_mfma_f32_32x32x16_bf16 v[96:111], v[216:219], v[208:211], v[96:111]
    ds_read_b64_tr_b16 v[152:153], v7 offset:5120
    ds_read_b64_tr_b16 v[154:155], v7 offset:5376
    ds_read_b64_tr_b16 v[156:157], v7 offset:9216
    ds_read_b64_tr_b16 v[158:159], v7 offset:9472
    v_mfma_f32_32x32x16_bf16 v[112:127], v[220:223], v[208:211], v[112:127]
    buffer_load_dwordx4 v4, s[8:11], s25 offen offset:2944 lds
    v_dot2c_f32_bf16 v60, s31, v208
    v_dot2c_f32_bf16 v62, v208, v208
    v_dot2c_f32_bf16 v61, s31, v209
    v_dot2c_f32_bf16 v63, v209, v209
    buffer_load_dwordx4 v5, s[8:11], s25 offen offset:3968 lds
    v_dot2c_f32_bf16 v60, s31, v210
    v_dot2c_f32_bf16 v62, v210, v210
    v_dot2c_f32_bf16 v61, s31, v211
    v_dot2c_f32_bf16 v63, v211, v211
    v_mfma_f32_32x32x16_bf16 v[80:95], v[228:231], v[224:227], v[80:95]
    s_waitcnt lgkmcnt(8)
    ds_read_b128 v[160:163], v14
    ds_read_b64_tr_b16 v[164:165], v7 offset:2048
    ds_read_b64_tr_b16 v[166:167], v7 offset:2304
    v_mfma_f32_32x32x16_bf16 v[96:111], v[232:235], v[224:227], v[96:111]
    ds_read_b64_tr_b16 v[168:169], v7 offset:6144
    ds_read_b64_tr_b16 v[170:171], v7 offset:6400
    ds_read_b64_tr_b16 v[172:173], v7 offset:10240
    ds_read_b64_tr_b16 v[174:175], v7 offset:10496
    v_mfma_f32_32x32x16_bf16 v[112:127], v[236:239], v[224:227], v[112:127]
    s_add_u32 m0, s28, 28672
    s_add_u32 s29, s70, 1376256
    buffer_load_dwordx4 v6, s[12:15], s29 offen offset:0 lds
    v_dot2c_f32_bf16 v60, s31, v224
    v_dot2c_f32_bf16 v62, v224, v224
    v_dot2c_f32_bf16 v61, s31, v225
    v_dot2c_f32_bf16 v63, v225, v225
    s_add_u32 m0, s28, 31744
    s_add_u32 s29, s71, 1376256
    buffer_load_dwordx4 v6, s[12:15], s29 offen offset:1024 lds
    v_dot2c_f32_bf16 v60, s31, v226
    v_dot2c_f32_bf16 v62, v226, v226
    v_dot2c_f32_bf16 v61, s31, v227
    v_dot2c_f32_bf16 v63, v227, v227
    v_mfma_f32_32x32x16_bf16 v[80:95], v[244:247], v[240:243], v[80:95]
    s_waitcnt lgkmcnt(8)
    ds_read_b128 v[176:179], v15
    ds_read_b64_tr_b16 v[180:181], v7 offset:3072
    ds_read_b64_tr_b16 v[182:183], v7 offset:3328
    v_mfma_f32_32x32x16_bf16 v[96:111], v[248:251], v[240:243], v[96:111]
    ds_read_b64_tr_b16 v[184:185], v7 offset:7168
    ds_read_b64_tr_b16 v[186:187], v7 offset:7424
    ds_read_b64_tr_b16 v[188:189], v7 offset:11264
    ds_read_b64_tr_b16 v[190:191], v7 offset:11520
    v_mfma_f32_32x32x16_bf16 v[112:127], v[252:255], v[240:243], v[112:127]
    s_add_u32 m0, s28, 34816
    s_add_u32 s29, s72, 1376256
    buffer_load_dwordx4 v6, s[12:15], s29 offen offset:2048 lds
    v_dot2c_f32_bf16 v60, s31, v240
    v_dot2c_f32_bf16 v62, v240, v240
    v_dot2c_f32_bf16 v61, s31, v241
    v_dot2c_f32_bf16 v63, v241, v241
    v_dot2c_f32_bf16 v60, s31, v242
    v_dot2c_f32_bf16 v62, v242, v242
    v_dot2c_f32_bf16 v61, s31, v243
    v_dot2c_f32_bf16 v63, v243, v243
    s_waitcnt lgkmcnt(9)
    ds_read_b64_tr_b16 v[48:49], v11 offset:0
    ds_read_b64_tr_b16 v[50:51], v11 offset:256
    ds_read_b64_tr_b16 v[52:53], v11 offset:4096
    ds_read_b64_tr_b16 v[54:55], v11 offset:4352
    ds_read_b64_tr_b16 v[56:57], v11 offset:8192
    ds_read_b64_tr_b16 v[58:59], v11 offset:8448
    s_waitcnt lgkmcnt(0)
    s_waitcnt vmcnt(21)
    s_barrier
    v_add_u32 v12, 28672, v12
    v_add_u32 v13, 28672, v13
    v_add_u32 v14, 28672, v14
    v_add_u32 v15, 28672, v15
    v_add_u32 v7, 28672, v7
    v_add_u32 v11, 28672, v11
    v_mfma_f32_32x32x16_bf16 v[80:95], v[132:135], v[128:131], v[80:95]
    ds_read_b128 v[192:195], v12
    ds_read_b64_tr_b16 v[196:197], v7 offset:0
    ds_read_b64_tr_b16 v[198:199], v7 offset:256
    v_mfma_f32_32x32x16_bf16 v[96:111], v[136:139], v[128:131], v[96:111]
    ds_read_b64_tr_b16 v[200:201], v7 offset:4096
    ds_read_b64_tr_b16 v[202:203], v7 offset:4352
    ds_read_b64_tr_b16 v[204:205], v7 offset:8192
    ds_read_b64_tr_b16 v[206:207], v7 offset:8448
    v_mfma_f32_32x32x16_bf16 v[112:127], v[140:143], v[128:131], v[112:127]
    s_add_u32 m0, s27, 56960
    s_nop 0
    buffer_load_dwordx4 v2, s[8:11], s25 offen offset:384 lds
    v_dot2c_f32_bf16 v64, s31, v48
    v_dot2c_f32_bf16 v65, s31, v49
    v_dot2c_f32_bf16 v64, s31, v50
    v_dot2c_f32_bf16 v65, s31, v51
    v_dot2c_f32_bf16 v66, s31, v52
    v_dot2c_f32_bf16 v67, s31, v53
    v_dot2c_f32_bf16 v66, s31, v54
    v_dot2c_f32_bf16 v67, s31, v55
    v_dot2c_f32_bf16 v68, s31, v56
    v_dot2c_f32_bf16 v69, s31, v57
    v_dot2c_f32_bf16 v68, s31, v58
    v_dot2c_f32_bf16 v69, s31, v59
    v_dot2c_f32_bf16 v60, s31, v128
    v_dot2c_f32_bf16 v62, v128, v128
    v_dot2c_f32_bf16 v61, s31, v129
    v_dot2c_f32_bf16 v63, v129, v129
    buffer_load_dwordx4 v3, s[8:11], s25 offen offset:1408 lds
    v_dot2c_f32_bf16 v60, s31, v130
    v_dot2c_f32_bf16 v62, v130, v130
    v_dot2c_f32_bf16 v61, s31, v131
    v_dot2c_f32_bf16 v63, v131, v131
    v_mfma_f32_32x32x16_bf16 v[80:95], v[148:151], v[144:147], v[80:95]
    ds_read_b128 v[208:211], v13
    ds_read_b64_tr_b16 v[212:213], v7 offset:1024
    ds_read_b64_tr_b16 v[214:215], v7 offset:1280
    v_mfma_f32_32x32x16_bf16 v[96:111], v[152:155], v[144:147], v[96:111]
    ds_read_b64_tr_b16 v[216:217], v7 offset:5120
    ds_read_b64_tr_b16 v[218:219], v7 offset:5376
    ds_read_b64_tr_b16 v[220:221], v7 offset:9216
    ds_read_b64_tr_b16 v[222:223], v7 offset:9472
    v_mfma_f32_32x32x16_bf16 v[112:127], v[156:159], v[144:147], v[112:127]
    buffer_load_dwordx4 v4, s[8:11], s25 offen offset:2432 lds
    v_dot2c_f32_bf16 v60, s31, v144
    v_dot2c_f32_bf16 v62, v144, v144
    v_dot2c_f32_bf16 v61, s31, v145
    v_dot2c_f32_bf16 v63, v145, v145
    buffer_load_dwordx4 v5, s[8:11], s25 offen offset:3456 lds
    v_dot2c_f32_bf16 v60, s31, v146
    v_dot2c_f32_bf16 v62, v146, v146
    v_dot2c_f32_bf16 v61, s31, v147
    v_dot2c_f32_bf16 v63, v147, v147
    v_mfma_f32_32x32x16_bf16 v[80:95], v[164:167], v[160:163], v[80:95]
    s_waitcnt lgkmcnt(8)
    ds_read_b128 v[224:227], v14
    ds_read_b64_tr_b16 v[228:229], v7 offset:2048
    ds_read_b64_tr_b16 v[230:231], v7 offset:2304
    v_mfma_f32_32x32x16_bf16 v[96:111], v[168:171], v[160:163], v[96:111]
    ds_read_b64_tr_b16 v[232:233], v7 offset:6144
    ds_read_b64_tr_b16 v[234:235], v7 offset:6400
    ds_read_b64_tr_b16 v[236:237], v7 offset:10240
    ds_read_b64_tr_b16 v[238:239], v7 offset:10496
    v_mfma_f32_32x32x16_bf16 v[112:127], v[172:175], v[160:163], v[112:127]
    s_add_u32 m0, s28, 57344
    s_add_u32 s29, s70, 589824
    buffer_load_dwordx4 v6, s[12:15], s29 offen offset:0 lds
    v_dot2c_f32_bf16 v60, s31, v160
    v_dot2c_f32_bf16 v62, v160, v160
    v_dot2c_f32_bf16 v61, s31, v161
    v_dot2c_f32_bf16 v63, v161, v161
    s_add_u32 m0, s28, 60416
    s_add_u32 s29, s71, 589824
    buffer_load_dwordx4 v6, s[12:15], s29 offen offset:1024 lds
    v_dot2c_f32_bf16 v60, s31, v162
    v_dot2c_f32_bf16 v62, v162, v162
    v_dot2c_f32_bf16 v61, s31, v163
    v_dot2c_f32_bf16 v63, v163, v163
    v_mfma_f32_32x32x16_bf16 v[80:95], v[180:183], v[176:179], v[80:95]
    s_waitcnt lgkmcnt(8)
    ds_read_b128 v[240:243], v15
    ds_read_b64_tr_b16 v[244:245], v7 offset:3072
    ds_read_b64_tr_b16 v[246:247], v7 offset:3328
    v_mfma_f32_32x32x16_bf16 v[96:111], v[184:187], v[176:179], v[96:111]
    ds_read_b64_tr_b16 v[248:249], v7 offset:7168
    ds_read_b64_tr_b16 v[250:251], v7 offset:7424
    ds_read_b64_tr_b16 v[252:253], v7 offset:11264
    ds_read_b64_tr_b16 v[254:255], v7 offset:11520
    v_mfma_f32_32x32x16_bf16 v[112:127], v[188:191], v[176:179], v[112:127]
    s_add_u32 m0, s28, 63488
    s_add_u32 s29, s72, 589824
    buffer_load_dwordx4 v6, s[12:15], s29 offen offset:2048 lds
    v_dot2c_f32_bf16 v60, s31, v176
    v_dot2c_f32_bf16 v62, v176, v176
    v_dot2c_f32_bf16 v61, s31, v177
    v_dot2c_f32_bf16 v63, v177, v177
    v_dot2c_f32_bf16 v60, s31, v178
    v_dot2c_f32_bf16 v62, v178, v178
    v_dot2c_f32_bf16 v61, s31, v179
    v_dot2c_f32_bf16 v63, v179, v179
    s_waitcnt lgkmcnt(9)
    ds_read_b64_tr_b16 v[48:49], v11 offset:0
    ds_read_b64_tr_b16 v[50:51], v11 offset:256
    ds_read_b64_tr_b16 v[52:53], v11 offset:4096
    ds_read_b64_tr_b16 v[54:55], v11 offset:4352
    ds_read_b64_tr_b16 v[56:57], v11 offset:8192
    ds_read_b64_tr_b16 v[58:59], v11 offset:8448
    s_waitcnt lgkmcnt(0)
    s_waitcnt vmcnt(21)
    s_barrier
    v_add_u32 v12, 28672, v12
    v_add_u32 v13, 28672, v13
    v_add_u32 v14, 28672, v14
    v_add_u32 v15, 28672, v15
    v_add_u32 v7, 28672, v7
    v_add_u32 v11, 28672, v11
    s_cmp_lt_u32 s2, 16
    s_cbranch_scc0 L_A_noclr
    s_cmp_eq_u32 s22, 0
    s_cbranch_scc0 L_A_noclr
    v_mov_b32 v20, 0
    v_mov_b32 v21, 1
    s_mov_b64 exec, 1
    global_atomic_add v20, v21, s[84:85] sc1
    s_mov_b64 exec, -1
L_A_noclr:
    v_mfma_f32_32x32x16_bf16 v[80:95], v[196:199], v[192:195], v[80:95]
    ds_read_b128 v[128:131], v12
    ds_read_b64_tr_b16 v[132:133], v7 offset:0
    ds_read_b64_tr_b16 v[134:135], v7 offset:256
    v_mfma_f32_32x32x16_bf16 v[96:111], v[200:203], v[192:195], v[96:111]
    ds_read_b64_tr_b16 v[136:137], v7 offset:4096
    ds_read_b64_tr_b16 v[138:139], v7 offset:4352
    ds_read_b64_tr_b16 v[140:141], v7 offset:8192
    ds_read_b64_tr_b16 v[142:143], v7 offset:8448
    v_mfma_f32_32x32x16_bf16 v[112:127], v[204:207], v[192:195], v[112:127]
    v_dot2c_f32_bf16 v64, s31, v48
    v_dot2c_f32_bf16 v65, s31, v49
    v_dot2c_f32_bf16 v64, s31, v50
    v_dot2c_f32_bf16 v65, s31, v51
    v_dot2c_f32_bf16 v66, s31, v52
    v_dot2c_f32_bf16 v67, s31, v53
    v_dot2c_f32_bf16 v66, s31, v54
    v_dot2c_f32_bf16 v67, s31, v55
    v_dot2c_f32_bf16 v68, s31, v56
    v_dot2c_f32_bf16 v69, s31, v57
    v_dot2c_f32_bf16 v68, s31, v58
    v_dot2c_f32_bf16 v69, s31, v59
    v_dot2c_f32_bf16 v60, s31, v192
    v_dot2c_f32_bf16 v62, v192, v192
    v_dot2c_f32_bf16 v61, s31, v193
    v_dot2c_f32_bf16 v63, v193, v193
    v_dot2c_f32_bf16 v60, s31, v194
    v_dot2c_f32_bf16 v62, v194, v194
    v_dot2c_f32_bf16 v61, s31, v195
    v_dot2c_f32_bf16 v63, v195, v195
    v_mfma_f32_32x32x16_bf16 v[80:95], v[212:215], v[208:211], v[80:95]
    ds_read_b128 v[144:147], v13
    ds_read_b64_tr_b16 v[148:149], v7 offset:1024
    ds_read_b64_tr_b16 v[150:151], v7 offset:1280
    v_mfma_f32_32x32x16_bf16 v[96:111], v[216:219], v[208:211], v[96:111]
    ds_read_b64_tr_b16 v[152:153], v7 offset:5120
    ds_read_b64_tr_b16 v[154:155], v7 offset:5376
    ds_read_b64_tr_b16 v[156:157], v7 offset:9216
    ds_read_b64_tr_b16 v[158:159], v7 offset:9472
    v_mfma_f32_32x32x16_bf16 v[112:127], v[220:223], v[208:211], v[112:127]
    v_dot2c_f32_bf16 v60, s31, v208
    v_dot2c_f32_bf16 v62, v208, v208
    v_dot2c_f32_bf16 v61, s31, v209
    v_dot2c_f32_bf16 v63, v209, v209
    v_dot2c_f32_bf16 v60, s31, v210
    v_dot2c_f32_bf16 v62, v210, v210
    v_dot2c_f32_bf16 v61, s31, v211
    v_dot2c_f32_bf16 v63, v211, v211
    v_mfma_f32_32x32x16_bf16 v[80:95], v[228:231], v[224:227], v[80:95]
    s_waitcnt lgkmcnt(8)
    ds_read_b128 v[160:163], v14
    ds_read_b64_tr_b16 v[164:165], v7 offset:2048
    ds_read_b64_tr_b16 v[166:167], v7 offset:2304
    v_mfma_f32_32x32x16_bf16 v[96:111], v[232:235], v[224:227], v[96:111]
    ds_read_b64_tr_b16 v[168:169], v7 offset:6144
    ds_read_b64_tr_b16 v[170:171], v7 offset:6400
    ds_read_b64_tr_b16 v[172:173], v7 offset:10240
    ds_read_b64_tr_b16 v[174:175], v7 offset:10496
    v_mfma_f32_32x32x16_bf16 v[112:127], v[236:239], v[224:227], v[112:127]
    v_dot2c_f32_bf16 v60, s31, v224
    v_dot2c_f32_bf16 v62, v224, v224
    v_dot2c_f32_bf16 v61, s31, v225
    v_dot2c_f32_bf16 v63, v225, v225
    v_dot2c_f32_bf16 v60, s31, v226
    v_dot2c_f32_bf16 v62, v226, v226
    v_dot2c_f32_bf16 v61, s31, v227
    v_dot2c_f32_bf16 v63, v227, v227
    v_mfma_f32_32x32x16_bf16 v[80:95], v[244:247], v[240:243], v[80:95]
    s_waitcnt lgkmcnt(8)
    ds_read_b128 v[176:179], v15
    ds_read_b64_tr_b16 v[180:181], v7 offset:3072
    ds_read_b64_tr_b16 v[182:183], v7 offset:3328
    v_mfma_f32_32x32x16_bf16 v[96:111], v[248:251], v[240:243], v[96:111]
    ds_read_b64_tr_b16 v[184:185], v7 offset:7168
    ds_read_b64_tr_b16 v[186:187], v7 offset:7424
    ds_read_b64_tr_b16 v[188:189], v7 offset:11264
    ds_read_b64_tr_b16 v[190:191], v7 offset:11520
    v_mfma_f32_32x32x16_bf16 v[112:127], v[252:255], v[240:243], v[112:127]
    v_dot2c_f32_bf16 v60, s31, v240
    v_dot2c_f32_bf16 v62, v240, v240
    v_dot2c_f32_bf16 v61, s31, v241
    v_dot2c_f32_bf16 v63, v241, v241
    v_dot2c_f32_bf16 v60, s31, v242
    v_dot2c_f32_bf16 v62, v242, v242
    v_dot2c_f32_bf16 v61, s31, v243
    v_dot2c_f32_bf16 v63, v243, v243
    s_waitcnt lgkmcnt(9)
    ds_read_b64_tr_b16 v[48:49], v11 offset:0
    ds_read_b64_tr_b16 v[50:51], v11 offset:256
    ds_read_b64_tr_b16 v[52:53], v11 offset:4096
    ds_read_b64_tr_b16 v[54:55], v11 offset:4352
    ds_read_b64_tr_b16 v[56:57], v11 offset:8192
    ds_read_b64_tr_b16 v[58:59], v11 offset:8448
    s_waitcnt lgkmcnt(0)
    s_waitcnt vmcnt(14)
    s_barrier
    v_subrev_u32 v12, 114688, v12
    v_subrev_u32 v13, 114688, v13
    v_subrev_u32 v14, 114688, v14
    v_subrev_u32 v15, 114688, v15
    v_subrev_u32 v7, 114688, v7
    v_subrev_u32 v11, 114688, v11
    v_mfma_f32_32x32x16_bf16 v[80:95], v[132:135], v[128:131], v[80:95]
    ds_read_b128 v[192:195], v12
    ds_read_b64_tr_b16 v[196:197], v7 offset:0
    ds_read_b64_tr_b16 v[198:199], v7 offset:256
    v_mfma_f32_32x32x16_bf16 v[96:111], v[136:139], v[128:131], v[96:111]
    ds_read_b64_tr_b16 v[200:201], v7 offset:4096
    ds_read_b64_tr_b16 v[202:203], v7 offset:4352
    ds_read_b64_tr_b16 v[204:205], v7 offset:8192
    ds_read_b64_tr_b16 v[206:207], v7 offset:8448
    v_mfma_f32_32x32x16_bf16 v[112:127], v[140:143], v[128:131], v[112:127]
    v_dot2c_f32_bf16 v64, s31, v48
    v_dot2c_f32_bf16 v65, s31, v49
    v_dot2c_f32_bf16 v64, s31, v50
    v_dot2c_f32_bf16 v65, s31, v51
    v_dot2c_f32_bf16 v66, s31, v52
    v_dot2c_f32_bf16 v67, s31, v53
    v_dot2c_f32_bf16 v66, s31, v54
    v_dot2c_f32_bf16 v67, s31, v55
    v_dot2c_f32_bf16 v68, s31, v56
    v_dot2c_f32_bf16 v69, s31, v57
    v_dot2c_f32_bf16 v68, s31, v58
    v_dot2c_f32_bf16 v69, s31, v59
    v_dot2c_f32_bf16 v60, s31, v128
    v_dot2c_f32_bf16 v62, v128, v128
    v_dot2c_f32_bf16 v61, s31, v129
    v_dot2c_f32_bf16 v63, v129, v129
    v_dot2c_f32_bf16 v60, s31, v130
    v_dot2c_f32_bf16 v62, v130, v130
    v_dot2c_f32_bf16 v61, s31, v131
    v_dot2c_f32_bf16 v63, v131, v131
    v_mfma_f32_32x32x16_bf16 v[80:95], v[148:151], v[144:147], v[80:95]
    ds_read_b128 v[208:211], v13
    ds_read_b64_tr_b16 v[212:213], v7 offset:1024
    ds_read_b64_tr_b16 v[214:215], v7 offset:1280
    v_mfma_f32_32x32x16_bf16 v[96:111], v[152:155], v[144:147], v[96:111]
    ds_read_b64_tr_b16 v[216:217], v7 offset:5120
    ds_read_b64_tr_b16 v[218:219], v7 offset:5376
    ds_read_b64_tr_b16 v[220:221], v7 offset:9216
    ds_read_b64_tr_b16 v[222:223], v7 offset:9472
    v_mfma_f32_32x32x16_bf16 v[112:127], v[156:159], v[144:147], v[112:127]
    v_dot2c_f32_bf16 v60, s31, v144
    v_dot2c_f32_bf16 v62, v144, v144
    v_dot2c_f32_bf16 v61, s31, v145
    v_dot2c_f32_bf16 v63, v145, v145
    v_dot2c_f32_bf16 v60, s31, v146
    v_dot2c_f32_bf16 v62, v146, v146
    v_dot2c_f32_bf16 v61, s31, v147
    v_dot2c_f32_bf16 v63, v147, v147
    v_mfma_f32_32x32x16_bf16 v[80:95], v[164:167], v[160:163], v[80:95]
    s_waitcnt lgkmcnt(8)
    ds_read_b128 v[224:227], v14
    ds_read_b64_tr_b16 v[228:229], v7 offset:2048
    ds_read_b64_tr_b16 v[230:231], v7 offset:2304
    v_mfma_f32_32x32x16_bf16 v[96:111], v[168:171], v[160:163], v[96:111]
    ds_read_b64_tr_b16 v[232:233], v7 offset:6144
    ds_read_b64_tr_b16 v[234:235], v7 offset:6400
    ds_read_b64_tr_b16 v[236:237], v7 offset:10240
    ds_read_b64_tr_b16 v[238:239], v7 offset:10496
    v_mfma_f32_32x32x16_bf16 v[112:127], v[172:175], v[160:163], v[112:127]
    v_dot2c_f32_bf16 v60, s31, v160
    v_dot2c_f32_bf16 v62, v160, v160
    v_dot2c_f32_bf16 v61, s31, v161
    v_dot2c_f32_bf16 v63, v161, v161
    v_dot2c_f32_bf16 v60, s31, v162
    v_dot2c_f32_bf16 v62, v162, v162
    v_dot2c_f32_bf16 v61, s31, v163
    v_dot2c_f32_bf16 v63, v163, v163
    v_mfma_f32_32x32x16_bf16 v[80:95], v[180:183], v[176:179], v[80:95]
    s_waitcnt lgkmcnt(8)
    ds_read_b128 v[240:243], v15
    ds_read_b64_tr_b16 v[244:245], v7 offset:3072
    ds_read_b64_tr_b16 v[246:247], v7 offset:3328
    v_mfma_f32_32x32x16_bf16 v[96:111], v[184:187], v[176:179], v[96:111]
    ds_read_b64_tr_b16 v[248:249], v7 offset:7168
    ds_read_b64_tr_b16 v[250:251], v7 offset:7424
    ds_read_b64_tr_b16 v[252:253], v7 offset:11264
    ds_read_b64_tr_b16 v[254:255], v7 offset:11520
    v_mfma_f32_32x32x16_bf16 v[112:127], v[188:191], v[176:179], v[112:127]
    v_dot2c_f32_bf16 v60, s31, v176
    v_dot2c_f32_bf16 v62, v176, v176
    v_dot2c_f32_bf16 v61, s31, v177
    v_dot2c_f32_bf16 v63, v177, v177
    v_dot2c_f32_bf16 v60, s31, v178
    v_dot2c_f32_bf16 v62, v178, v178
    v_dot2c_f32_bf16 v61, s31, v179
    v_dot2c_f32_bf16 v63, v179, v179
    s_waitcnt lgkmcnt(9)
    ds_read_b64_tr_b16 v[48:49], v11 offset:0
    ds_read_b64_tr_b16 v[50:51], v11 offset:256
    ds_read_b64_tr_b16 v[52:53], v11 offset:4096
    ds_read_b64_tr_b16 v[54:55], v11 offset:4352
    ds_read_b64_tr_b16 v[56:57], v11 offset:8192
    ds_read_b64_tr_b16 v[58:59], v11 offset:8448
    s_waitcnt lgkmcnt(0)
    s_waitcnt vmcnt(7)
    s_barrier
    v_add_u32 v12, 28672, v12
    v_add_u32 v13, 28672, v13
    v_add_u32 v14, 28672, v14
    v_add_u32 v15, 28672, v15
    v_add_u32 v7, 28672, v7
    v_add_u32 v11, 28672, v11
    v_mfma_f32_32x32x16_bf16 v[80:95], v[196:199], v[192:195], v[80:95]
    ds_read_b128 v[128:131], v12
    ds_read_b64_tr_b16 v[132:133], v7 offset:0
    ds_read_b64_tr_b16 v[134:135], v7 offset:256
    v_mfma_f32_32x32x16_bf16 v[96:111], v[200:203], v[192:195], v[96:111]
    ds_read_b64_tr_b16 v[136:137], v7 offset:4096
    ds_read_b64_tr_b16 v[138:139], v7 offset:4352
    ds_read_b64_tr_b16 v[140:141], v7 offset:8192
    ds_read_b64_tr_b16 v[142:143], v7 offset:8448
    v_mfma_f32_32x32x16_bf16 v[112:127], v[204:207], v[192:195], v[112:127]
    v_and_b32 v28, 7, v1
    v_lshlrev_b32 v28, 21, v28
    buffer_load_dword v29, v28, s[16:19], 0 offen
    s_mov_b32 s60, s48
    s_and_b32 s61, s49, 0xffff
    s_mov_b32 s62, 7340032
    s_mov_b32 s63, 0x00020000
    buffer_load_dword v30, v28, s[60:63], 0 offen
    s_mov_b32 s60, s52
    s_and_b32 s61, s53, 0xffff
    s_mov_b32 s62, 7340032
    s_mov_b32 s63, 0x00020000
    buffer_load_dword v31, v28, s[60:63], 0 offen
    s_mov_b32 s60, s44
    s_and_b32 s61, s45, 0xffff
    s_mov_b32 s62, 524288
    s_mov_b32 s63, 0x00020000
    buffer_load_dword v32, v28, s[60:63], 0 offen
    v_dot2c_f32_bf16 v64, s31, v48
    v_dot2c_f32_bf16 v65, s31, v49
    v_dot2c_f32_bf16 v64, s31, v50
    v_dot2c_f32_bf16 v65, s31, v51
    v_dot2c_f32_bf16 v66, s31, v52
    v_dot2c_f32_bf16 v67, s31, v53
    v_dot2c_f32_bf16 v66, s31, v54
    v_dot2c_f32_bf16 v67, s31, v55
    v_dot2c_f32_bf16 v68, s31, v56
    v_dot2c_f32_bf16 v69, s31, v57
    v_dot2c_f32_bf16 v68, s31, v58
    v_dot2c_f32_bf16 v69, s31, v59
    v_dot2c_f32_bf16 v60, s31, v192
    v_dot2c_f32_bf16 v62, v192, v192
    v_dot2c_f32_bf16 v61, s31, v193
    v_dot2c_f32_bf16 v63, v193, v193
    v_dot2c_f32_bf16 v60, s31, v194
    v_dot2c_f32_bf16 v62, v194, v194
    v_dot2c_f32_bf16 v61, s31, v195
    v_dot2c_f32_bf16 v63, v195, v195
    v_mfma_f32_32x32x16_bf16 v[80:95], v[212:215], v[208:211], v[80:95]
    ds_read_b128 v[144:147], v13
    ds_read_b64_tr_b16 v[148:149], v7 offset:1024
    ds_read_b64_tr_b16 v[150:151], v7 offset:1280
    v_mfma_f32_32x32x16_bf16 v[96:111], v[216:219], v[208:211], v[96:111]
    ds_read_b64_tr_b16 v[152:153], v7 offset:5120
    ds_read_b64_tr_b16 v[154:155], v7 offset:5376
    ds_read_b64_tr_b16 v[156:157], v7 offset:9216
    ds_read_b64_tr_b16 v[158:159], v7 offset:9472
    v_mfma_f32_32x32x16_bf16 v[112:127], v[220:223], v[208:211], v[112:127]
    v_dot2c_f32_bf16 v60, s31, v208
    v_dot2c_f32_bf16 v62, v208, v208
    v_dot2c_f32_bf16 v61, s31, v209
    v_dot2c_f32_bf16 v63, v209, v209
    v_dot2c_f32_bf16 v60, s31, v210
    v_dot2c_f32_bf16 v62, v210, v210
    v_dot2c_f32_bf16 v61, s31, v211
    v_dot2c_f32_bf16 v63, v211, v211
    v_mfma_f32_32x32x16_bf16 v[80:95], v[228:231], v[224:227], v[80:95]
    s_waitcnt lgkmcnt(8)
    ds_read_b128 v[160:163], v14
    ds_read_b64_tr_b16 v[164:165], v7 offset:2048
    ds_read_b64_tr_b16 v[166:167], v7 offset:2304
    v_mfma_f32_32x32x16_bf16 v[96:111], v[232:235], v[224:227], v[96:111]
    ds_read_b64_tr_b16 v[168:169], v7 offset:6144
    ds_read_b64_tr_b16 v[170:171], v7 offset:6400
    ds_read_b64_tr_b16 v[172:173], v7 offset:10240
    ds_read_b64_tr_b16 v[174:175], v7 offset:10496
    v_mfma_f32_32x32x16_bf16 v[112:127], v[236:239], v[224:227], v[112:127]
    v_dot2c_f32_bf16 v60, s31, v224
    v_dot2c_f32_bf16 v62, v224, v224
    v_dot2c_f32_bf16 v61, s31, v225
    v_dot2c_f32_bf16 v63, v225, v225
    v_dot2c_f32_bf16 v60, s31, v226
    v_dot2c_f32_bf16 v62, v226, v226
    v_dot2c_f32_bf16 v61, s31, v227
    v_dot2c_f32_bf16 v63, v227, v227
    v_mfma_f32_32x32x16_bf16 v[80:95], v[244:247], v[240:243], v[80:95]
    s_waitcnt lgkmcnt(8)
    ds_read_b128 v[176:179], v15
    ds_read_b64_tr_b16 v[180:181], v7 offset:3072
    ds_read_b64_tr_b16 v[182:183], v7 offset:3328
    v_mfma_f32_32x32x16_bf16 v[96:111], v[248:251], v[240:243], v[96:111]
    ds_read_b64_tr_b16 v[184:185], v7 offset:7168
    ds_read_b64_tr_b16 v[186:187], v7 offset:7424
    ds_read_b64_tr_b16 v[188:189], v7 offset:11264
    ds_read_b64_tr_b16 v[190:191], v7 offset:11520
    v_mfma_f32_32x32x16_bf16 v[112:127], v[252:255], v[240:243], v[112:127]
    v_dot2c_f32_bf16 v60, s31, v240
    v_dot2c_f32_bf16 v62, v240, v240
    v_dot2c_f32_bf16 v61, s31, v241
    v_dot2c_f32_bf16 v63, v241, v241
    v_dot2c_f32_bf16 v60, s31, v242
    v_dot2c_f32_bf16 v62, v242, v242
    v_dot2c_f32_bf16 v61, s31, v243
    v_dot2c_f32_bf16 v63, v243, v243
    s_waitcnt lgkmcnt(9)
    ds_read_b64_tr_b16 v[48:49], v11 offset:0
    ds_read_b64_tr_b16 v[50:51], v11 offset:256
    ds_read_b64_tr_b16 v[52:53], v11 offset:4096
    ds_read_b64_tr_b16 v[54:55], v11 offset:4352
    ds_read_b64_tr_b16 v[56:57], v11 offset:8192
    ds_read_b64_tr_b16 v[58:59], v11 offset:8448
    s_waitcnt lgkmcnt(0)
    s_waitcnt vmcnt(4)
    s_barrier
    v_add_u32 v12, 28672, v12
    v_add_u32 v13, 28672, v13
    v_add_u32 v14, 28672, v14
    v_add_u32 v15, 28672, v15
    v_add_u32 v7, 28672, v7
    v_add_u32 v11, 28672, v11
    v_mfma_f32_32x32x16_bf16 v[80:95], v[132:135], v[128:131], v[80:95]
    ds_read_b128 v[192:195], v12
    ds_read_b64_tr_b16 v[196:197], v7 offset:0
    ds_read_b64_tr_b16 v[198:199], v7 offset:256
    v_mfma_f32_32x32x16_bf16 v[96:111], v[136:139], v[128:131], v[96:111]
    ds_read_b64_tr_b16 v[200:201], v7 offset:4096
    ds_read_b64_tr_b16 v[202:203], v7 offset:4352
    ds_read_b64_tr_b16 v[204:205], v7 offset:8192
    ds_read_b64_tr_b16 v[206:207], v7 offset:8448
    v_mfma_f32_32x32x16_bf16 v[112:127], v[140:143], v[128:131], v[112:127]
    v_mov_b32 v20, 0
    global_load_dword v22, v20, s[84:85] sc1
    v_dot2c_f32_bf16 v64, s31, v48
    v_dot2c_f32_bf16 v65, s31, v49
    v_dot2c_f32_bf16 v64, s31, v50
    v_dot2c_f32_bf16 v65, s31, v51
    v_dot2c_f32_bf16 v66, s31, v52
    v_dot2c_f32_bf16 v67, s31, v53
    v_dot2c_f32_bf16 v66, s31, v54
    v_dot2c_f32_bf16 v67, s31, v55
    v_dot2c_f32_bf16 v68, s31, v56
    v_dot2c_f32_bf16 v69, s31, v57
    v_dot2c_f32_bf16 v68, s31, v58
    v_dot2c_f32_bf16 v69, s31, v59
    v_dot2c_f32_bf16 v60, s31, v128
    v_dot2c_f32_bf16 v62, v128, v128
    v_dot2c_f32_bf16 v61, s31, v129
    v_dot2c_f32_bf16 v63, v129, v129
    v_dot2c_f32_bf16 v60, s31, v130
    v_dot2c_f32_bf16 v62, v130, v130
    v_dot2c_f32_bf16 v61, s31, v131
    v_dot2c_f32_bf16 v63, v131, v131
    v_mfma_f32_32x32x16_bf16 v[80:95], v[148:151], v[144:147], v[80:95]
    ds_read_b128 v[208:211], v13
    ds_read_b64_tr_b16 v[212:213], v7 offset:1024
    ds_read_b64_tr_b16 v[214:215], v7 offset:1280
    v_mfma_f32_32x32x16_bf16 v[96:111], v[152:155], v[144:147], v[96:111]
    ds_read_b64_tr_b16 v[216:217], v7 offset:5120
    ds_read_b64_tr_b16 v[218:219], v7 offset:5376
    ds_read_b64_tr_b16 v[220:221], v7 offset:9216
    ds_read_b64_tr_b16 v[222:223], v7 offset:9472
    v_mfma_f32_32x32x16_bf16 v[112:127], v[156:159], v[144:147], v[112:127]
    v_dot2c_f32_bf16 v60, s31, v144
    v_dot2c_f32_bf16 v62, v144, v144
    v_dot2c_f32_bf16 v61, s31, v145
    v_dot2c_f32_bf16 v63, v145, v145
    v_dot2c_f32_bf16 v60, s31, v146
    v_dot2c_f32_bf16 v62, v146, v146
    v_dot2c_f32_bf16 v61, s31, v147
    v_dot2c_f32_bf16 v63, v147, v147
    v_mfma_f32_32x32x16_bf16 v[80:95], v[164:167], v[160:163], v[80:95]
    s_waitcnt lgkmcnt(8)
    ds_read_b128 v[224:227], v14
    ds_read_b64_tr_b16 v[228:229], v7 offset:2048
    ds_read_b64_tr_b16 v[230:231], v7 offset:2304
    v_mfma_f32_32x32x16_bf16 v[96:111], v[168:171], v[160:163], v[96:111]
    ds_read_b64_tr_b16 v[232:233], v7 offset:6144
    ds_read_b64_tr_b16 v[234:235], v7 offset:6400
    ds_read_b64_tr_b16 v[236:237], v7 offset:10240
    ds_read_b64_tr_b16 v[238:239], v7 offset:10496
    v_mfma_f32_32x32x16_bf16 v[112:127], v[172:175], v[160:163], v[112:127]
    v_dot2c_f32_bf16 v60, s31, v160
    v_dot2c_f32_bf16 v62, v160, v160
    v_dot2c_f32_bf16 v61, s31, v161
    v_dot2c_f32_bf16 v63, v161, v161
    v_dot2c_f32_bf16 v60, s31, v162
    v_dot2c_f32_bf16 v62, v162, v162
    v_dot2c_f32_bf16 v61, s31, v163
    v_dot2c_f32_bf16 v63, v163, v163
    v_mfma_f32_32x32x16_bf16 v[80:95], v[180:183], v[176:179], v[80:95]
    s_waitcnt lgkmcnt(8)
    ds_read_b128 v[240:243], v15
    ds_read_b64_tr_b16 v[244:245], v7 offset:3072
    ds_read_b64_tr_b16 v[246:247], v7 offset:3328
    v_mfma_f32_32x32x16_bf16 v[96:111], v[184:187], v[176:179], v[96:111]
    ds_read_b64_tr_b16 v[248:249], v7 offset:7168
    ds_read_b64_tr_b16 v[250:251], v7 offset:7424
    ds_read_b64_tr_b16 v[252:253], v7 offset:11264
    ds_read_b64_tr_b16 v[254:255], v7 offset:11520
    v_mfma_f32_32x32x16_bf16 v[112:127], v[188:191], v[176:179], v[112:127]
    v_dot2c_f32_bf16 v60, s31, v176
    v_dot2c_f32_bf16 v62, v176, v176
    v_dot2c_f32_bf16 v61, s31, v177
    v_dot2c_f32_bf16 v63, v177, v177
    v_dot2c_f32_bf16 v60, s31, v178
    v_dot2c_f32_bf16 v62, v178, v178
    v_dot2c_f32_bf16 v61, s31, v179
    v_dot2c_f32_bf16 v63, v179, v179
    s_waitcnt lgkmcnt(9)
    ds_read_b64_tr_b16 v[48:49], v11 offset:0
    ds_read_b64_tr_b16 v[50:51], v11 offset:256
    ds_read_b64_tr_b16 v[52:53], v11 offset:4096
    ds_read_b64_tr_b16 v[54:55], v11 offset:4352
    ds_read_b64_tr_b16 v[56:57], v11 offset:8192
    ds_read_b64_tr_b16 v[58:59], v11 offset:8448
    s_waitcnt lgkmcnt(0)
    v_mfma_f32_32x32x16_bf16 v[80:95], v[196:199], v[192:195], v[80:95]
    v_mfma_f32_32x32x16_bf16 v[96:111], v[200:203], v[192:195], v[96:111]
    v_mfma_f32_32x32x16_bf16 v[112:127], v[204:207], v[192:195], v[112:127]
    v_dot2c_f32_bf16 v64, s31, v48
    v_dot2c_f32_bf16 v65, s31, v49
    v_dot2c_f32_bf16 v64, s31, v50
    v_dot2c_f32_bf16 v65, s31, v51
    v_dot2c_f32_bf16 v66, s31, v52
    v_dot2c_f32_bf16 v67, s31, v53
    v_dot2c_f32_bf16 v66, s31, v54
    v_dot2c_f32_bf16 v67, s31, v55
    v_dot2c_f32_bf16 v68, s31, v56
    v_dot2c_f32_bf16 v69, s31, v57
    v_dot2c_f32_bf16 v68, s31, v58
    v_dot2c_f32_bf16 v69, s31, v59
    v_dot2c_f32_bf16 v60, s31, v192
    v_dot2c_f32_bf16 v62, v192, v192
    v_dot2c_f32_bf16 v61, s31, v193
    v_dot2c_f32_bf16 v63, v193, v193
    v_dot2c_f32_bf16 v60, s31, v194
    v_dot2c_f32_bf16 v62, v194, v194
    v_dot2c_f32_bf16 v61, s31, v195
    v_dot2c_f32_bf16 v63, v195, v195
    v_add_f32 v64, v64, v65
    v_add_f32 v66, v66, v67
    v_add_f32 v68, v68, v69
    v_mov_b32 v72, v64
    v_mov_b32 v73, v66
    v_mov_b32 v74, v68
    v_permlane32_swap_b32 v64, v72
    v_permlane32_swap_b32 v66, v73
    v_permlane32_swap_b32 v68, v74
    v_add_f32 v64, v64, v72
    v_add_f32 v66, v66, v73
    v_add_f32 v68, v68, v74
    s_mul_i32 s30, s22, 384
    s_add_u32 s30, s30, 144384
    v_add_u32 v9, s30, v44
    ds_write_b32 v9, v64 offset:0
    ds_write_b32 v9, v66 offset:128
    ds_write_b32 v9, v68 offset:256
    v_mfma_f32_32x32x16_bf16 v[80:95], v[212:215], v[208:211], v[80:95]
    v_mfma_f32_32x32x16_bf16 v[96:111], v[216:219], v[208:211], v[96:111]
    v_mfma_f32_32x32x16_bf16 v[112:127], v[220:223], v[208:211], v[112:127]
    v_dot2c_f32_bf16 v60, s31, v208
    v_dot2c_f32_bf16 v62, v208, v208
    v_dot2c_f32_bf16 v61, s31, v209
    v_dot2c_f32_bf16 v63, v209, v209
    v_dot2c_f32_bf16 v60, s31, v210
    v_dot2c_f32_bf16 v62, v210, v210
    v_dot2c_f32_bf16 v61, s31, v211
    v_dot2c_f32_bf16 v63, v211, v211
    s_waitcnt lgkmcnt(0)
    s_barrier
    v_lshlrev_b32 v10, 2, v1
    v_add_u32 v10, 144384, v10
    ds_read_b32 v64, v10 offset:0
    ds_read_b32 v65, v10 offset:384
    ds_read_b32 v66, v10 offset:768
    ds_read_b32 v67, v10 offset:1152
    v_add_u32 v9, 144640, v44
    ds_read_b32 v68, v9 offset:0
    ds_read_b32 v69, v9 offset:384
    ds_read_b32 v70, v9 offset:768
    ds_read_b32 v71, v9 offset:1152
    v_mfma_f32_32x32x16_bf16 v[80:95], v[228:231], v[224:227], v[80:95]
    v_mfma_f32_32x32x16_bf16 v[96:111], v[232:235], v[224:227], v[96:111]
    v_mfma_f32_32x32x16_bf16 v[112:127], v[236:239], v[224:227], v[112:127]
    v_dot2c_f32_bf16 v60, s31, v224
    v_dot2c_f32_bf16 v62, v224, v224
    v_dot2c_f32_bf16 v61, s31, v225
    v_dot2c_f32_bf16 v63, v225, v225
    v_dot2c_f32_bf16 v60, s31, v226
    v_dot2c_f32_bf16 v62, v226, v226
    v_dot2c_f32_bf16 v61, s31, v227
    v_dot2c_f32_bf16 v63, v227, v227
    s_waitcnt lgkmcnt(0)
    v_add_f32 v64, v64, v65
    v_add_f32 v66, v66, v67
    v_add_f32 v68, v68, v69
    v_add_f32 v70, v70, v71
    v_add_f32 v64, v64, v66
    v_add_f32 v68, v68, v70
    s_lshl_b32 s30, s22, 9
    s_add_u32 s30, s30, 146432
    v_lshlrev_b32 v10, 2, v1
    v_add_u32 v10, s30, v10
    ds_write_b32 v10, v64
    v_add_u32 v9, s30, v44
    ds_write_b32 v9, v68 offset:256
    v_lshrrev_b32 v9, 5, v1
    v_lshlrev_b32 v9, 4, v9
    v_add_u32 v9, s30, v9
    s_waitcnt lgkmcnt(0)
    ds_read_b128 v[160:163], v9 offset:256
    ds_read_b128 v[164:167], v9 offset:288
    ds_read_b128 v[168:171], v9 offset:320
    ds_read_b128 v[172:175], v9 offset:352
    ds_read_b128 v[128:131], v9 offset:0
    ds_read_b128 v[132:135], v9 offset:32
    ds_read_b128 v[136:139], v9 offset:64
    ds_read_b128 v[140:143], v9 offset:96
    ds_read_b128 v[144:147], v9 offset:128
    ds_read_b128 v[148:151], v9 offset:160
    ds_read_b128 v[152:155], v9 offset:192
    ds_read_b128 v[156:159], v9 offset:224
    v_mfma_f32_32x32x16_bf16 v[80:95], v[244:247], v[240:243], v[80:95]
    v_mfma_f32_32x32x16_bf16 v[96:111], v[248:251], v[240:243], v[96:111]
    v_mfma_f32_32x32x16_bf16 v[112:127], v[252:255], v[240:243], v[112:127]
    v_dot2c_f32_bf16 v60, s31, v240
    v_dot2c_f32_bf16 v62, v240, v240
    v_dot2c_f32_bf16 v61, s31, v241
    v_dot2c_f32_bf16 v63, v241, v241
    v_dot2c_f32_bf16 v60, s31, v242
    v_dot2c_f32_bf16 v62, v242, v242
    v_dot2c_f32_bf16 v61, s31, v243
    v_dot2c_f32_bf16 v63, v243, v243
    s_nop 1
    v_add_f32 v60, v60, v61
    v_add_f32 v62, v62, v63
    v_mov_b32 v70, v60
    v_mov_b32 v71, v62
    s_nop 0
    v_permlane32_swap_b32 v60, v70
    v_permlane32_swap_b32 v62, v71
    v_add_f32 v60, v60, v70
    v_add_f32 v62, v62, v71
    s_mov_b32 s30, 0x3b000000
    v_mul_f32 v60, s30, v60
    v_mul_f32 v62, s30, v62
    v_fma_f32 v62, -v60, v60, v62
    v_max_f32 v62, 0, v62
    v_add_f32 v62, 0x3727c5ac, v62
    v_rsq_f32 v62, v62
    v_sub_f32 v60, 0, v60
    v_mov_b32 v61, v60
    v_mov_b32 v63, v62
    v_mul_f32 v74, 0x3eb8aa3b, v62
    v_mov_b32 v75, v74
    s_waitcnt lgkmcnt(0)
    v_pk_fma_f32 v[112:113], v[160:161], v[60:61], v[112:113]
    v_pk_fma_f32 v[114:115], v[162:163], v[60:61], v[114:115]
    v_pk_fma_f32 v[116:117], v[164:165], v[60:61], v[116:117]
    v_pk_fma_f32 v[118:119], v[166:167], v[60:61], v[118:119]
    v_pk_fma_f32 v[120:121], v[168:169], v[60:61], v[120:121]
    v_pk_fma_f32 v[122:123], v[170:171], v[60:61], v[122:123]
    v_pk_fma_f32 v[124:125], v[172:173], v[60:61], v[124:125]
    v_pk_fma_f32 v[126:127], v[174:175], v[60:61], v[126:127]
    v_pk_mul_f32 v[112:113], v[112:113], v[62:63]
    v_pk_mul_f32 v[114:115], v[114:115], v[62:63]
    v_pk_mul_f32 v[116:117], v[116:117], v[62:63]
    v_pk_mul_f32 v[118:119], v[118:119], v[62:63]
    v_pk_mul_f32 v[120:121], v[120:121], v[62:63]
    v_pk_mul_f32 v[122:123], v[122:123], v[62:63]
    v_pk_mul_f32 v[124:125], v[124:125], v[62:63]
    v_pk_mul_f32 v[126:127], v[126:127], v[62:63]
    v_cvt_pk_bf16_f32 v200, v112, v113
    v_cvt_pk_bf16_f32 v201, v114, v115
    v_cvt_pk_bf16_f32 v202, v116, v117
    v_cvt_pk_bf16_f32 v203, v118, v119
    v_cvt_pk_bf16_f32 v204, v120, v121
    v_cvt_pk_bf16_f32 v205, v122, v123
    v_cvt_pk_bf16_f32 v206, v124, v125
    v_cvt_pk_bf16_f32 v207, v126, v127
    v_mfma_f32_32x32x16_bf16 v[208:223], v[200:203], v[34:37], 0
    s_nop 0
    v_mfma_f32_32x32x16_bf16 v[208:223], v[204:207], v[38:41], v[208:223]
    v_pk_fma_f32 v[80:81], v[128:129], v[60:61], v[80:81]
    v_pk_fma_f32 v[82:83], v[130:131], v[60:61], v[82:83]
    v_pk_fma_f32 v[84:85], v[132:133], v[60:61], v[84:85]
    v_pk_fma_f32 v[86:87], v[134:135], v[60:61], v[86:87]
    v_pk_fma_f32 v[88:89], v[136:137], v[60:61], v[88:89]
    v_pk_fma_f32 v[90:91], v[138:139], v[60:61], v[90:91]
    v_pk_fma_f32 v[92:93], v[140:141], v[60:61], v[92:93]
    v_pk_fma_f32 v[94:95], v[142:143], v[60:61], v[94:95]
    v_pk_mul_f32 v[80:81], v[80:81], v[74:75]
    v_pk_mul_f32 v[82:83], v[82:83], v[74:75]
    v_pk_mul_f32 v[84:85], v[84:85], v[74:75]
    v_pk_mul_f32 v[86:87], v[86:87], v[74:75]
    v_pk_mul_f32 v[88:89], v[88:89], v[74:75]
    v_pk_mul_f32 v[90:91], v[90:91], v[74:75]
    v_pk_mul_f32 v[92:93], v[92:93], v[74:75]
    v_pk_mul_f32 v[94:95], v[94:95], v[74:75]
    v_cvt_pk_bf16_f32 v184, v80, v81
    v_cvt_pk_bf16_f32 v185, v82, v83
    v_cvt_pk_bf16_f32 v186, v84, v85
    v_cvt_pk_bf16_f32 v187, v86, v87
    v_cvt_pk_bf16_f32 v188, v88, v89
    v_cvt_pk_bf16_f32 v189, v90, v91
    v_cvt_pk_bf16_f32 v190, v92, v93
    v_cvt_pk_bf16_f32 v191, v94, v95
    s_lshl_b32 s29, s23, 2
    s_add_u32 s29, s29, s22
    s_lshl_b32 s30, s24, 7
    s_add_u32 s30, s30, s29
    v_lshlrev_b32 v8, 4, v1
    s_lshl_b32 s32, s30, 10
    s_add_u32 s32, s32, 0
    s_add_u32 s33, s32, 65536
    buffer_store_dwordx4 v[184:187], v8, s[16:19], s32 offen sc1
    buffer_store_dwordx4 v[188:191], v8, s[16:19], s33 offen sc1
    v_pk_fma_f32 v[96:97], v[144:145], v[60:61], v[96:97]
    v_pk_fma_f32 v[98:99], v[146:147], v[60:61], v[98:99]
    v_pk_fma_f32 v[100:101], v[148:149], v[60:61], v[100:101]
    v_pk_fma_f32 v[102:103], v[150:151], v[60:61], v[102:103]
    v_pk_fma_f32 v[104:105], v[152:153], v[60:61], v[104:105]
    v_pk_fma_f32 v[106:107], v[154:155], v[60:61], v[106:107]
    v_pk_fma_f32 v[108:109], v[156:157], v[60:61], v[108:109]
    v_pk_fma_f32 v[110:111], v[158:159], v[60:61], v[110:111]
    v_pk_mul_f32 v[96:97], v[96:97], v[62:63]
    v_pk_mul_f32 v[98:99], v[98:99], v[62:63]
    v_pk_mul_f32 v[100:101], v[100:101], v[62:63]
    v_pk_mul_f32 v[102:103], v[102:103], v[62:63]
    v_pk_mul_f32 v[104:105], v[104:105], v[62:63]
    v_pk_mul_f32 v[106:107], v[106:107], v[62:63]
    v_pk_mul_f32 v[108:109], v[108:109], v[62:63]
    v_pk_mul_f32 v[110:111], v[110:111], v[62:63]
    v_cvt_pk_bf16_f32 v192, v96, v97
    v_cvt_pk_bf16_f32 v193, v98, v99
    v_cvt_pk_bf16_f32 v194, v100, v101
    v_cvt_pk_bf16_f32 v195, v102, v103
    v_cvt_pk_bf16_f32 v196, v104, v105
    v_cvt_pk_bf16_f32 v197, v106, v107
    v_cvt_pk_bf16_f32 v198, v108, v109
    v_cvt_pk_bf16_f32 v199, v110, v111
    s_lshl_b32 s30, s38, 7
    s_add_u32 s30, s30, s29
    s_lshl_b32 s32, s30, 11
    s_add_u32 s32, s32, 2097152
    s_add_u32 s33, s32, 131072
    buffer_store_dwordx4 v[192:195], v8, s[16:19], s32 offen sc1
    buffer_store_dwordx4 v[196:199], v8, s[16:19], s33 offen sc1
    v_cvt_pk_bf16_f32 v200, v208, v209
    v_cvt_pk_bf16_f32 v201, v210, v211
    v_cvt_pk_bf16_f32 v202, v212, v213
    v_cvt_pk_bf16_f32 v203, v214, v215
    v_cvt_pk_bf16_f32 v204, v216, v217
    v_cvt_pk_bf16_f32 v205, v218, v219
    v_cvt_pk_bf16_f32 v206, v220, v221
    v_cvt_pk_bf16_f32 v207, v222, v223
    v_bfe_u32 v9, v1, 4, 1
    v_lshlrev_b32 v9, 17, v9
    v_lshrrev_b32 v10, 5, v1
    v_lshl_add_u32 v9, v10, 8, v9
    v_and_b32 v10, 15, v1
    v_lshl_add_u32 v9, v10, 4, v9
    s_lshl_b32 s30, s39, 7
    s_add_u32 s30, s30, s29
    s_lshl_b32 s32, s30, 11
    s_add_u32 s32, s32, 2097152
    buffer_store_dwordx4 v[200:203], v9, s[16:19], s32 offen offset:1024 sc1
    buffer_store_dwordx4 v[204:207], v9, s[16:19], s32 offen offset:1536 sc1
    v_mul_f32 v64, v80, v80
    v_mul_f32 v65, v88, v88
    v_mul_f32 v66, v96, v96
    v_mul_f32 v67, v104, v104
    v_fma_f32 v64, v81, v81, v64
    v_fma_f32 v65, v89, v89, v65
    v_fma_f32 v66, v97, v97, v66
    v_fma_f32 v67, v105, v105, v67
    v_fma_f32 v64, v82, v82, v64
    v_fma_f32 v65, v90, v90, v65
    v_fma_f32 v66, v98, v98, v66
    v_fma_f32 v67, v106, v106, v67
    v_fma_f32 v64, v83, v83, v64
    v_fma_f32 v65, v91, v91, v65
    v_fma_f32 v66, v99, v99, v66
    v_fma_f32 v67, v107, v107, v67
    v_fma_f32 v64, v84, v84, v64
    v_fma_f32 v65, v92, v92, v65
    v_fma_f32 v66, v100, v100, v66
    v_fma_f32 v67, v108, v108, v67
    v_fma_f32 v64, v85, v85, v64
    v_fma_f32 v65, v93, v93, v65
    v_fma_f32 v66, v101, v101, v66
    v_fma_f32 v67, v109, v109, v67
    v_fma_f32 v64, v86, v86, v64
    v_fma_f32 v65, v94, v94, v65
    v_fma_f32 v66, v102, v102, v66
    v_fma_f32 v67, v110, v110, v67
    v_fma_f32 v64, v87, v87, v64
    v_fma_f32 v65, v95, v95, v65
    v_fma_f32 v66, v103, v103, v66
    v_fma_f32 v67, v111, v111, v67
    v_mov_b32 v70, v64
    v_mov_b32 v71, v65
    v_mov_b32 v72, v66
    v_mov_b32 v73, v67
    v_permlane32_swap_b32 v64, v70
    v_permlane32_swap_b32 v65, v71
    v_permlane32_swap_b32 v66, v72
    v_permlane32_swap_b32 v67, v73
    v_add_f32 v64, v64, v70
    v_add_f32 v65, v65, v71
    v_add_f32 v66, v66, v72
    v_add_f32 v67, v67, v73
    v_max_u32_dpp v64, v64, v64 row_ror:1 row_mask:0xf bank_mask:0xf
    v_max_u32_dpp v65, v65, v65 row_ror:1 row_mask:0xf bank_mask:0xf
    v_max_u32_dpp v66, v66, v66 row_ror:1 row_mask:0xf bank_mask:0xf
    v_max_u32_dpp v67, v67, v67 row_ror:1 row_mask:0xf bank_mask:0xf
    v_max_u32_dpp v64, v64, v64 row_ror:2 row_mask:0xf bank_mask:0xf
    v_max_u32_dpp v65, v65, v65 row_ror:2 row_mask:0xf bank_mask:0xf
    v_max_u32_dpp v66, v66, v66 row_ror:2 row_mask:0xf bank_mask:0xf
    v_max_u32_dpp v67, v67, v67 row_ror:2 row_mask:0xf bank_mask:0xf
    v_max_u32_dpp v64, v64, v64 row_ror:4 row_mask:0xf bank_mask:0xf
    v_max_u32_dpp v65, v65, v65 row_ror:4 row_mask:0xf bank_mask:0xf
    v_max_u32_dpp v66, v66, v66 row_ror:4 row_mask:0xf bank_mask:0xf
    v_max_u32_dpp v67, v67, v67 row_ror:4 row_mask:0xf bank_mask:0xf
    v_max_u32_dpp v64, v64, v64 row_ror:8 row_mask:0xf bank_mask:0xf
    v_max_u32_dpp v65, v65, v65 row_ror:8 row_mask:0xf bank_mask:0xf
    v_max_u32_dpp v66, v66, v66 row_ror:8 row_mask:0xf bank_mask:0xf
    v_max_u32_dpp v67, v67, v67 row_ror:8 row_mask:0xf bank_mask:0xf
    s_lshl_b32 s32, s23, 3
    s_lshl_b32 s33, s22, 1
    s_add_u32 s32, s32, s33
    s_lshl_b32 s33, s38, 8
    s_add_u32 s33, s33, s32
    s_lshl_b32 s33, s33, 2
    s_add_u32 s33, s33, 6307840
    s_lshl_b32 s30, s24, 8
    s_add_u32 s32, s32, s30
    s_lshl_b32 s32, s32, 2
    s_add_u32 s32, s32, 6291456
    v_lshrrev_b32 v10, 4, v1
    v_lshlrev_b32 v10, 2, v10
    s_mov_b32 exec_lo, 0x00010001
    s_mov_b32 exec_hi, 0
    buffer_store_dword v64, v10, s[16:19], s32 offen offset:0 sc1
    buffer_store_dword v66, v10, s[16:19], s33 offen offset:0 sc1
    buffer_store_dword v65, v10, s[16:19], s32 offen offset:512 sc1
    buffer_store_dword v67, v10, s[16:19], s33 offen offset:512 sc1
    s_mov_b64 exec, -1
    v_mov_b32 v20, 0
    s_waitcnt vmcnt(0)
    s_barrier
    s_cmp_lg_u32 s22, 0
    s_cbranch_scc1 L_A_arrived
    s_mov_b32 s37, 262144
L_A_ck:
    v_readfirstlane_b32 s36, v22
    s_nop 3
    s_cmp_ge_u32 s36, 16
    s_cbranch_scc1 L_A_go
    s_sub_u32 s37, s37, 1
    s_cmp_eq_u32 s37, 0
    s_cbranch_scc1 L_A_go
    global_load_dword v22, v20, s[84:85] sc1
    s_waitcnt vmcnt(0)
    s_branch L_A_ck
L_A_go:
    s_lshl_b32 s36, s24, 8
    s_add_u32 s36, s36, 6356992
    v_mov_b32 v21, 1
    s_mov_b64 exec, 1
    buffer_atomic_add v21, v20, s[16:19], s36 offen sc1
    s_mov_b64 exec, -1
L_A_arrived:
    s_and_b32 s70, s2, 1
    s_lshl_b32 s70, s70, 2
    s_lshr_b32 s68, s2, 3
    s_and_b32 s69, s68, 3
    s_add_u32 s70, s70, s69
    s_bfe_u32 s71, s2, 0x20001
    s_mul_i32 s71, s71, 7
    s_lshr_b32 s69, s68, 2
    s_add_u32 s71, s71, s69
    s_and_b32 s72, s2, 1
    s_lshl_b32 s72, s72, 2
    s_lshr_b32 s68, s2, 3
    s_and_b32 s69, s68, 3
    s_add_u32 s72, s72, s69
    s_bfe_u32 s73, s2, 0x20001
    s_lshl_b32 s73, s73, 3
    s_lshr_b32 s69, s68, 2
    s_and_b32 s68, s69, 3
    s_cmp_eq_u32 s68, 3
    s_cselect_b32 s68, 4, 0
    s_xor_b32 s69, s69, s68
    s_add_u32 s73, s73, s69
    s_mul_i32 s74, s22, 1835008
    s_lshl_b32 s69, s71, 7
    s_add_u32 s74, s74, s69
    s_mul_i32 s75, s22, 1835008
    s_lshl_b32 s69, s73, 7
    s_add_u32 s75, s75, s69
    v_lshlrev_b32 v2, 4, v1
    s_and_b32 s23, s2, 31
    s_lshr_b32 s24, s2, 5
    s_lshr_b32 s25, s22, 1
    s_and_b32 s26, s22, 1
    s_lshl_b32 s27, s24, 3
    s_lshl_b32 s28, s25, 2
    s_add_u32 s27, s27, s28
    s_lshl_b32 s31, s26, 16
    s_lshl_b32 s28, s25, 13
    s_add_u32 s31, s31, s28
    s_lshl_b32 s30, s23, 17
    s_add_u32 s30, s30, s31
    s_add_u32 s30, s30, 2097152
    s_and_b32 s33, s2, 1
    s_lshl_b32 s33, s33, 2
    s_lshr_b32 s68, s2, 3
    s_and_b32 s69, s68, 3
    s_add_u32 s33, s33, s69
    s_bfe_u32 s34, s2, 0x20001
    s_mul_i32 s34, s34, 7
    s_lshr_b32 s69, s68, 2
    s_add_u32 s34, s34, s69
    s_mov_b32 s8, s50
    s_and_b32 s9, s51, 0xffff
    s_mov_b32 s10, 3584
    s_mov_b32 s11, 0x00020000
    v_lshrrev_b32 v3, 5, v1
    v_lshlrev_b32 v3, 3, v3
    s_lshl_b32 s35, s34, 7
    s_lshl_b32 s36, s26, 6
    s_add_u32 s35, s35, s36
    buffer_load_dwordx2 v[224:225], v3, s[8:11], s35 offen offset:0
    buffer_load_dwordx2 v[226:227], v3, s[8:11], s35 offen offset:16
    buffer_load_dwordx2 v[228:229], v3, s[8:11], s35 offen offset:32
    buffer_load_dwordx2 v[230:231], v3, s[8:11], s35 offen offset:48
    s_and_b32 s35, s2, 1
    s_lshl_b32 s35, s35, 2
    s_lshr_b32 s68, s2, 3
    s_and_b32 s69, s68, 3
    s_add_u32 s35, s35, s69
    s_bfe_u32 s36, s2, 0x20001
    s_lshl_b32 s36, s36, 3
    s_lshr_b32 s69, s68, 2
    s_and_b32 s68, s69, 3
    s_cmp_eq_u32 s68, 3
    s_cselect_b32 s68, 4, 0
    s_xor_b32 s69, s69, s68
    s_add_u32 s36, s36, s69
    s_mov_b32 s12, s54
    s_and_b32 s13, s55, 0xffff
    s_mov_b32 s14, 4096
    s_mov_b32 s15, 0x00020000
    v_and_b32 v3, 31, v1
    v_lshlrev_b32 v3, 1, v3
    s_lshl_b32 s37, s36, 7
    s_lshl_b32 s38, s25, 6
    s_add_u32 s37, s37, s38
    buffer_load_ushort v232, v3, s[12:15], s37 offen
    s_mov_b32 s8, s48
    s_and_b32 s9, s49, 0xffff
    s_mov_b32 s10, 7340032
    s_mov_b32 s11, 0x00020000
    s_mov_b32 s12, s52
    s_and_b32 s13, s53, 0xffff
    s_mov_b32 s14, 7340032
    s_mov_b32 s15, 0x00020000
    s_mov_b32 s4, s44
    s_and_b32 s5, s45, 0xffff
    s_mov_b32 s6, 524288
    s_mov_b32 s7, 0x00020000
    v_mov_b32 v28, 0x3f803f80
    v_mov_b32 v29, 0x3f803f80
    v_mov_b32 v30, 0x3f803f80
    v_mov_b32 v31, 0x3f803f80
    v_mov_b32 v32, 0x3f803f80
    v_mov_b32 v33, 0x3f803f80
    v_mov_b32 v34, 0x3f803f80
    v_mov_b32 v35, 0x3f803f80
    v_mov_b32 v36, 0x3f803f80
    v_mov_b32 v37, 0x3f803f80
    v_mov_b32 v38, 0x3f803f80
    v_mov_b32 v39, 0x3f803f80
    v_mov_b32 v40, 0x3f803f80
    v_mov_b32 v41, 0x3f803f80
    v_mov_b32 v42, 0x3f803f80
    v_mov_b32 v43, 0x3f803f80
    v_and_b32 v3, 31, v1
    v_cmp_eq_u32 vcc, 16, v3
    v_cmp_eq_u32 s[58:59], 20, v3
    s_nop 3
    s_or_b64 vcc, vcc, s[58:59]
    v_cndmask_b32 v28, 0, v28, vcc
    v_cndmask_b32 v29, 0, v29, vcc
    v_cndmask_b32 v30, 0, v30, vcc
    v_cndmask_b32 v31, 0, v31, vcc
    v_cndmask_b32 v32, 0, v32, vcc
    v_cndmask_b32 v33, 0, v33, vcc
    v_cndmask_b32 v34, 0, v34, vcc
    v_cndmask_b32 v35, 0, v35, vcc
    v_cndmask_b32 v36, 0, v36, vcc
    v_cndmask_b32 v37, 0, v37, vcc
    v_cndmask_b32 v38, 0, v38, vcc
    v_cndmask_b32 v39, 0, v39, vcc
    v_cndmask_b32 v40, 0, v40, vcc
    v_cndmask_b32 v41, 0, v41, vcc
    v_cndmask_b32 v42, 0, v42, vcc
    v_cndmask_b32 v43, 0, v43, vcc
    v_mov_b32 v76, 0
    v_mov_b32 v77, 0
    v_mov_b32 v78, 0
    v_mov_b32 v79, 0
    v_mov_b32 v80, 0
    v_mov_b32 v81, 0
    v_mov_b32 v82, 0
    v_mov_b32 v83, 0
    v_mov_b32 v84, 0
    v_mov_b32 v85, 0
    v_mov_b32 v86, 0
    v_mov_b32 v87, 0
    v_mov_b32 v88, 0
    v_mov_b32 v89, 0
    v_mov_b32 v90, 0
    v_mov_b32 v91, 0
    v_mov_b32 v92, 0
    v_mov_b32 v93, 0
    v_mov_b32 v94, 0
    v_mov_b32 v95, 0
    v_mov_b32 v96, 0
    v_mov_b32 v97, 0
    v_mov_b32 v98, 0
    v_mov_b32 v99, 0
    v_mov_b32 v100, 0
    v_mov_b32 v101, 0
    v_mov_b32 v102, 0
    v_mov_b32 v103, 0
    v_mov_b32 v104, 0
    v_mov_b32 v105, 0
    v_mov_b32 v106, 0
    v_mov_b32 v107, 0
    v_mov_b32 v108, 0
    v_mov_b32 v109, 0
    v_mov_b32 v110, 0
    v_mov_b32 v111, 0
    v_mov_b32 v112, 0
    v_mov_b32 v113, 0
    v_mov_b32 v114, 0
    v_mov_b32 v115, 0
    v_mov_b32 v116, 0
    v_mov_b32 v117, 0
    v_mov_b32 v118, 0
    v_mov_b32 v119, 0
    v_mov_b32 v120, 0
    v_mov_b32 v121, 0
    v_mov_b32 v122, 0
    v_mov_b32 v123, 0
    v_mov_b32 v124, 0
    v_mov_b32 v125, 0
    v_mov_b32 v126, 0
    v_mov_b32 v127, 0
    v_mov_b32 v128, 0
    v_mov_b32 v129, 0
    v_mov_b32 v130, 0
    v_mov_b32 v131, 0
    v_mov_b32 v132, 0
    v_mov_b32 v133, 0
    v_mov_b32 v134, 0
    v_mov_b32 v135, 0
    v_mov_b32 v136, 0
    v_mov_b32 v137, 0
    v_mov_b32 v138, 0
    v_mov_b32 v139, 0
    v_mov_b32 v140, 0
    v_mov_b32 v141, 0
    v_mov_b32 v142, 0
    v_mov_b32 v143, 0
    v_mov_b32 v144, 0
    v_mov_b32 v145, 0
    v_mov_b32 v146, 0
    v_mov_b32 v147, 0
    s_lshl_b32 s28, s26, 16
    v_add_u32 v212, s28, v2
    v_lshrrev_b32 v213, 5, v1
    v_lshlrev_b32 v213, 8, v213
    v_and_b32 v3, 15, v1
    v_lshl_add_u32 v213, v3, 4, v213
    s_add_u32 s28, s28, 1024
    v_add_u32 v213, s28, v213
    s_mov_b32 s58, 0x0000ffff
    s_mov_b32 s59, 0x0000ffff
    s_cmp_lg_u32 s22, 0
    s_cbranch_scc1 L_B_polled
    s_lshr_b32 s28, s23, 1
    v_min_u32 v3, 2, v1
    v_mul_u32_u24 v3, 11, v3
    v_add_u32 v3, s28, v3
    v_and_b32 v3, 15, v3
    v_lshlrev_b32 v3, 8, v3
    s_mov_b32 s37, 262144
    s_mov_b32 s29, 6356992
L_B_poll:
    buffer_load_dword v218, v3, s[16:19], s29 offen sc1
    s_waitcnt vmcnt(0)
    v_cmp_gt_u32 vcc, 16, v218
    s_sub_u32 s37, s37, 1
    s_cmp_eq_u32 s37, 0
    s_cbranch_scc1 L_B_polled
    s_cbranch_vccnz L_B_poll
L_B_polled:
    s_barrier
    s_lshl_b32 s28, s23, 9
    s_add_u32 s28, s28, 6291456
    v_lshlrev_b32 v3, 3, v1
    s_add_u32 s29, s28, 16384
    buffer_load_dwordx2 v[218:219], v3, s[16:19], s28 offen sc1
    buffer_load_dwordx2 v[220:221], v3, s[16:19], s29 offen sc1
    s_lshl_b32 s28, s27, 10
    s_lshl_b32 s29, s23, 16
    s_add_u32 s28, s28, s29
    s_add_u32 s28, s28, 0
    buffer_load_dwordx4 v[4:7], v2, s[16:19], s28 offen offset:0 sc1
    buffer_load_dwordx4 v[8:11], v2, s[16:19], s28 offen offset:1024 sc1
    buffer_load_dwordx4 v[12:15], v2, s[16:19], s28 offen offset:2048 sc1
    buffer_load_dwordx4 v[16:19], v2, s[16:19], s28 offen offset:3072 sc1
    s_mov_b32 m0, s31
    s_add_u32 s32, s30, 4096
    buffer_load_dwordx4 v2, s[16:19], s30 offen offset:0 sc1 lds
    buffer_load_dwordx4 v2, s[16:19], s30 offen offset:1024 sc1 lds
    buffer_load_dwordx4 v2, s[16:19], s30 offen offset:2048 sc1 lds
    buffer_load_dwordx4 v2, s[16:19], s30 offen offset:3072 sc1 lds
    s_add_u32 m0, s31, 4096
    s_add_u32 s30, s30, 16384
    buffer_load_dwordx4 v2, s[16:19], s32 offen offset:0 sc1 lds
    buffer_load_dwordx4 v2, s[16:19], s32 offen offset:1024 sc1 lds
    buffer_load_dwordx4 v2, s[16:19], s32 offen offset:2048 sc1 lds
    buffer_load_dwordx4 v2, s[16:19], s32 offen offset:3072 sc1 lds
    s_add_u32 s31, s31, 16384
    s_waitcnt vmcnt(12)
    v_max_u32 v218, v218, v219
    v_max_u32 v220, v220, v221
    s_nop 0
    v_max_u32_dpp v218, v218, v218 row_ror:1 row_mask:0xf bank_mask:0xf
    v_max_u32_dpp v220, v220, v220 row_ror:1 row_mask:0xf bank_mask:0xf
    s_nop 0
    v_max_u32_dpp v218, v218, v218 row_ror:2 row_mask:0xf bank_mask:0xf
    v_max_u32_dpp v220, v220, v220 row_ror:2 row_mask:0xf bank_mask:0xf
    s_nop 0
    v_max_u32_dpp v218, v218, v218 row_ror:4 row_mask:0xf bank_mask:0xf
    v_max_u32_dpp v220, v220, v220 row_ror:4 row_mask:0xf bank_mask:0xf
    s_nop 0
    v_max_u32_dpp v218, v218, v218 row_ror:8 row_mask:0xf bank_mask:0xf
    v_max_u32_dpp v220, v220, v220 row_ror:8 row_mask:0xf bank_mask:0xf
    v_readlane_b32 s60, v218, 0
    v_readlane_b32 s61, v218, 16
    v_readlane_b32 s62, v218, 32
    v_readlane_b32 s63, v218, 48
    v_readlane_b32 s64, v220, 0
    v_readlane_b32 s65, v220, 16
    v_readlane_b32 s66, v220, 32
    v_readlane_b32 s67, v220, 48
    s_max_u32 s60, s60, s61
    s_max_u32 s62, s62, s63
    s_max_u32 s60, s60, s62
    s_max_u32 s64, s64, s65
    s_max_u32 s66, s66, s67
    s_max_u32 s64, s64, s66
    v_mov_b32 v218, s60
    v_mul_f32 v218, s64, v218
    s_mov_b32 s61, 0x44c22cbd
    v_cmp_ge_f32 vcc, s61, v218
    s_nop 3
    s_cmp_eq_u64 vcc, 0
    s_cbranch_scc1 L_kb_slow
    s_waitcnt vmcnt(0)
    s_barrier
    v_lshrrev_b32 v222, 3, v1
    s_mov_b32 s69, 1024
    v_mul_lo_u32 v222, v222, s69
    v_bfe_u32 v223, v1, 4, 1
    v_lshlrev_b32 v223, 2, v223
    v_and_b32 v218, 7, v1
    v_xor_b32 v223, v223, v218
    v_lshl_add_u32 v218, v223, 4, v222
    v_add_u32 v219, 7168, v218
    v_add_u32 v220, 14336, v218
    v_add_u32 v221, 21504, v218
    s_lshl_b32 s37, s26, 8
    s_lshl_b32 s38, s25, 5
    s_add_u32 s37, s37, s38
    s_lshl_b32 s37, s37, 10
    s_lshl_b32 s28, s35, 7
    s_add_u32 s37, s37, s28
    s_lshl_b32 s28, s26, 16
    s_lshl_b32 s38, s38, 7
    s_add_u32 s38, s38, s28
    ds_read_b128 v[20:23], v212
    s_mov_b64 exec, s[58:59]
    ds_read_b128 v[28:31], v213
    ds_read_b128 v[32:35], v213 offset:512
    s_mov_b64 exec, -1
    s_waitcnt lgkmcnt(0)
    v_mfma_f32_32x32x16_bf16 v[44:59], v[20:23], v[4:7], 0
    s_nop 11
    v_exp_f32 v44, v44
    v_exp_f32 v45, v45
    v_mfma_f32_32x32x16_bf16 v[132:147], v[40:43], v[80:83], v[132:147]
    ds_read_b128 v[24:27], v212 offset:2048
    v_exp_f32 v46, v46
    v_exp_f32 v47, v47
    s_mov_b64 exec, s[58:59]
    ds_read_b128 v[36:39], v213 offset:2048
    ds_read_b128 v[40:43], v213 offset:2560
    s_mov_b64 exec, -1
    v_exp_f32 v48, v48
    v_exp_f32 v49, v49
    v_exp_f32 v50, v50
    v_mfma_f32_32x32x16_bf16 v[60:75], v[20:23], v[8:11], 0
    s_add_u32 m0, s31, 0
    s_add_u32 s32, s30, 0
    buffer_load_dwordx4 v2, s[16:19], s32 offen offset:0 sc1 lds
    v_exp_f32 v51, v51
    v_cvt_pk_bf16_f32 v76, v44, v45
    v_cvt_pk_bf16_f32 v77, v46, v47
    v_cvt_pk_bf16_f32 v78, v48, v49
    v_cvt_pk_bf16_f32 v79, v50, v51
    v_exp_f32 v52, v52
    v_exp_f32 v53, v53
    v_exp_f32 v54, v54
    v_mfma_f32_32x32x16_bf16 v[84:99], v[28:31], v[76:79], v[84:99]
    v_exp_f32 v55, v55
    v_exp_f32 v56, v56
    v_exp_f32 v57, v57
    v_exp_f32 v58, v58
    v_exp_f32 v59, v59
    v_cvt_pk_bf16_f32 v80, v52, v53
    v_cvt_pk_bf16_f32 v81, v54, v55
    v_cvt_pk_bf16_f32 v82, v56, v57
    v_cvt_pk_bf16_f32 v83, v58, v59
    v_exp_f32 v60, v60
    v_exp_f32 v61, v61
    v_mfma_f32_32x32x16_bf16 v[84:99], v[32:35], v[80:83], v[84:99]
    v_exp_f32 v62, v62
    v_exp_f32 v63, v63
    v_exp_f32 v64, v64
    v_exp_f32 v65, v65
    v_exp_f32 v66, v66
    v_mfma_f32_32x32x16_bf16 v[44:59], v[20:23], v[12:15], 0
    buffer_load_dwordx4 v2, s[16:19], s32 offen offset:1024 sc1 lds
    v_exp_f32 v67, v67
    v_cvt_pk_bf16_f32 v76, v60, v61
    v_cvt_pk_bf16_f32 v77, v62, v63
    v_cvt_pk_bf16_f32 v78, v64, v65
    v_cvt_pk_bf16_f32 v79, v66, v67
    v_exp_f32 v68, v68
    v_exp_f32 v69, v69
    v_exp_f32 v70, v70
    v_mfma_f32_32x32x16_bf16 v[100:115], v[28:31], v[76:79], v[100:115]
    v_exp_f32 v71, v71
    v_exp_f32 v72, v72
    v_exp_f32 v73, v73
    v_exp_f32 v74, v74
    v_exp_f32 v75, v75
    v_cvt_pk_bf16_f32 v80, v68, v69
    v_cvt_pk_bf16_f32 v81, v70, v71
    v_cvt_pk_bf16_f32 v82, v72, v73
    v_cvt_pk_bf16_f32 v83, v74, v75
    v_exp_f32 v44, v44
    v_exp_f32 v45, v45
    v_mfma_f32_32x32x16_bf16 v[100:115], v[32:35], v[80:83], v[100:115]
    v_exp_f32 v46, v46
    v_exp_f32 v47, v47
    v_exp_f32 v48, v48
    v_exp_f32 v49, v49
    v_exp_f32 v50, v50
    v_mfma_f32_32x32x16_bf16 v[60:75], v[20:23], v[16:19], 0
    buffer_load_dwordx4 v2, s[16:19], s32 offen offset:2048 sc1 lds
    v_exp_f32 v51, v51
    v_cvt_pk_bf16_f32 v76, v44, v45
    v_cvt_pk_bf16_f32 v77, v46, v47
    v_cvt_pk_bf16_f32 v78, v48, v49
    v_cvt_pk_bf16_f32 v79, v50, v51
    v_exp_f32 v52, v52
    v_exp_f32 v53, v53
    v_exp_f32 v54, v54
    v_mfma_f32_32x32x16_bf16 v[116:131], v[28:31], v[76:79], v[116:131]
    v_exp_f32 v55, v55
    v_exp_f32 v56, v56
    v_exp_f32 v57, v57
    v_exp_f32 v58, v58
    v_exp_f32 v59, v59
    v_cvt_pk_bf16_f32 v80, v52, v53
    v_cvt_pk_bf16_f32 v81, v54, v55
    v_cvt_pk_bf16_f32 v82, v56, v57
    v_cvt_pk_bf16_f32 v83, v58, v59
    v_exp_f32 v60, v60
    v_exp_f32 v61, v61
    v_mfma_f32_32x32x16_bf16 v[116:131], v[32:35], v[80:83], v[116:131]
    v_exp_f32 v62, v62
    v_exp_f32 v63, v63
    v_exp_f32 v64, v64
    v_exp_f32 v65, v65
    v_exp_f32 v66, v66
    s_waitcnt lgkmcnt(0)
    v_mfma_f32_32x32x16_bf16 v[44:59], v[24:27], v[4:7], 0
    buffer_load_dwordx4 v2, s[16:19], s32 offen offset:3072 sc1 lds
    v_exp_f32 v67, v67
    v_cvt_pk_bf16_f32 v76, v60, v61
    v_cvt_pk_bf16_f32 v77, v62, v63
    v_cvt_pk_bf16_f32 v78, v64, v65
    v_cvt_pk_bf16_f32 v79, v66, v67
    v_exp_f32 v68, v68
    v_exp_f32 v69, v69
    v_exp_f32 v70, v70
    v_mfma_f32_32x32x16_bf16 v[132:147], v[28:31], v[76:79], v[132:147]
    v_exp_f32 v71, v71
    v_exp_f32 v72, v72
    v_exp_f32 v73, v73
    v_exp_f32 v74, v74
    v_exp_f32 v75, v75
    v_cvt_pk_bf16_f32 v80, v68, v69
    v_cvt_pk_bf16_f32 v81, v70, v71
    v_cvt_pk_bf16_f32 v82, v72, v73
    v_cvt_pk_bf16_f32 v83, v74, v75
    v_exp_f32 v44, v44
    v_exp_f32 v45, v45
    v_mfma_f32_32x32x16_bf16 v[132:147], v[32:35], v[80:83], v[132:147]
    ds_read_b128 v[20:23], v212 offset:4096
    v_exp_f32 v46, v46
    v_exp_f32 v47, v47
    s_mov_b64 exec, s[58:59]
    ds_read_b128 v[28:31], v213 offset:4096
    ds_read_b128 v[32:35], v213 offset:4608
    s_mov_b64 exec, -1
    v_exp_f32 v48, v48
    v_exp_f32 v49, v49
    v_exp_f32 v50, v50
    v_mfma_f32_32x32x16_bf16 v[60:75], v[24:27], v[8:11], 0
    s_add_u32 m0, s31, 4096
    s_add_u32 s32, s30, 4096
    buffer_load_dwordx4 v2, s[16:19], s32 offen offset:0 sc1 lds
    v_exp_f32 v51, v51
    v_cvt_pk_bf16_f32 v76, v44, v45
    v_cvt_pk_bf16_f32 v77, v46, v47
    v_cvt_pk_bf16_f32 v78, v48, v49
    v_cvt_pk_bf16_f32 v79, v50, v51
    v_exp_f32 v52, v52
    v_exp_f32 v53, v53
    v_exp_f32 v54, v54
    v_mfma_f32_32x32x16_bf16 v[84:99], v[36:39], v[76:79], v[84:99]
    v_exp_f32 v55, v55
    v_exp_f32 v56, v56
    v_exp_f32 v57, v57
    v_exp_f32 v58, v58
    v_exp_f32 v59, v59
    v_cvt_pk_bf16_f32 v80, v52, v53
    v_cvt_pk_bf16_f32 v81, v54, v55
    v_cvt_pk_bf16_f32 v82, v56, v57
    v_cvt_pk_bf16_f32 v83, v58, v59
    v_exp_f32 v60, v60
    v_exp_f32 v61, v61
    v_mfma_f32_32x32x16_bf16 v[84:99], v[40:43], v[80:83], v[84:99]
    v_exp_f32 v62, v62
    v_exp_f32 v63, v63
    v_exp_f32 v64, v64
    v_exp_f32 v65, v65
    v_exp_f32 v66, v66
    v_mfma_f32_32x32x16_bf16 v[44:59], v[24:27], v[12:15], 0
    buffer_load_dwordx4 v2, s[16:19], s32 offen offset:1024 sc1 lds
    v_exp_f32 v67, v67
    v_cvt_pk_bf16_f32 v76, v60, v61
    v_cvt_pk_bf16_f32 v77, v62, v63
    v_cvt_pk_bf16_f32 v78, v64, v65
    v_cvt_pk_bf16_f32 v79, v66, v67
    v_exp_f32 v68, v68
    v_exp_f32 v69, v69
    v_exp_f32 v70, v70
    v_mfma_f32_32x32x16_bf16 v[100:115], v[36:39], v[76:79], v[100:115]
    v_exp_f32 v71, v71
    v_exp_f32 v72, v72
    v_exp_f32 v73, v73
    v_exp_f32 v74, v74
    v_exp_f32 v75, v75
    v_cvt_pk_bf16_f32 v80, v68, v69
    v_cvt_pk_bf16_f32 v81, v70, v71
    v_cvt_pk_bf16_f32 v82, v72, v73
    v_cvt_pk_bf16_f32 v83, v74, v75
    v_exp_f32 v44, v44
    v_exp_f32 v45, v45
    v_mfma_f32_32x32x16_bf16 v[100:115], v[40:43], v[80:83], v[100:115]
    v_exp_f32 v46, v46
    v_exp_f32 v47, v47
    v_exp_f32 v48, v48
    v_exp_f32 v49, v49
    v_exp_f32 v50, v50
    v_mfma_f32_32x32x16_bf16 v[60:75], v[24:27], v[16:19], 0
    buffer_load_dwordx4 v2, s[16:19], s32 offen offset:2048 sc1 lds
    v_exp_f32 v51, v51
    v_cvt_pk_bf16_f32 v76, v44, v45
    v_cvt_pk_bf16_f32 v77, v46, v47
    v_cvt_pk_bf16_f32 v78, v48, v49
    v_cvt_pk_bf16_f32 v79, v50, v51
    v_exp_f32 v52, v52
    v_exp_f32 v53, v53
    v_exp_f32 v54, v54
    v_mfma_f32_32x32x16_bf16 v[116:131], v[36:39], v[76:79], v[116:131]
    v_exp_f32 v55, v55
    v_exp_f32 v56, v56
    v_exp_f32 v57, v57
    v_exp_f32 v58, v58
    v_exp_f32 v59, v59
    v_cvt_pk_bf16_f32 v80, v52, v53
    v_cvt_pk_bf16_f32 v81, v54, v55
    v_cvt_pk_bf16_f32 v82, v56, v57
    v_cvt_pk_bf16_f32 v83, v58, v59
    v_exp_f32 v60, v60
    v_exp_f32 v61, v61
    v_mfma_f32_32x32x16_bf16 v[116:131], v[40:43], v[80:83], v[116:131]
    v_exp_f32 v62, v62
    v_exp_f32 v63, v63
    v_exp_f32 v64, v64
    v_exp_f32 v65, v65
    v_exp_f32 v66, v66
    s_waitcnt lgkmcnt(0)
    v_mfma_f32_32x32x16_bf16 v[44:59], v[20:23], v[4:7], 0
    buffer_load_dwordx4 v2, s[16:19], s32 offen offset:3072 sc1 lds
    v_exp_f32 v67, v67
    v_cvt_pk_bf16_f32 v76, v60, v61
    v_cvt_pk_bf16_f32 v77, v62, v63
    v_cvt_pk_bf16_f32 v78, v64, v65
    v_cvt_pk_bf16_f32 v79, v66, v67
    v_exp_f32 v68, v68
    v_exp_f32 v69, v69
    v_exp_f32 v70, v70
    v_mfma_f32_32x32x16_bf16 v[132:147], v[36:39], v[76:79], v[132:147]
    v_exp_f32 v71, v71
    v_exp_f32 v72, v72
    v_exp_f32 v73, v73
    v_exp_f32 v74, v74
    v_exp_f32 v75, v75
    v_cvt_pk_bf16_f32 v80, v68, v69
    v_cvt_pk_bf16_f32 v81, v70, v71
    v_cvt_pk_bf16_f32 v82, v72, v73
    v_cvt_pk_bf16_f32 v83, v74, v75
    v_exp_f32 v44, v44
    v_exp_f32 v45, v45
    v_mfma_f32_32x32x16_bf16 v[132:147], v[40:43], v[80:83], v[132:147]
    ds_read_b128 v[24:27], v212 offset:6144
    v_exp_f32 v46, v46
    v_exp_f32 v47, v47
    s_mov_b64 exec, s[58:59]
    ds_read_b128 v[36:39], v213 offset:6144
    ds_read_b128 v[40:43], v213 offset:6656
    s_mov_b64 exec, -1
    v_exp_f32 v48, v48
    v_exp_f32 v49, v49
    v_exp_f32 v50, v50
    v_mfma_f32_32x32x16_bf16 v[60:75], v[20:23], v[8:11], 0
    s_add_u32 m0, s31, 16384
    s_add_u32 s32, s30, 16384
    buffer_load_dwordx4 v2, s[16:19], s32 offen offset:0 sc1 lds
    v_exp_f32 v51, v51
    v_cvt_pk_bf16_f32 v76, v44, v45
    v_cvt_pk_bf16_f32 v77, v46, v47
    v_cvt_pk_bf16_f32 v78, v48, v49
    v_cvt_pk_bf16_f32 v79, v50, v51
    v_exp_f32 v52, v52
    v_exp_f32 v53, v53
    v_exp_f32 v54, v54
    v_mfma_f32_32x32x16_bf16 v[84:99], v[28:31], v[76:79], v[84:99]
    v_exp_f32 v55, v55
    v_exp_f32 v56, v56
    v_exp_f32 v57, v57
    v_exp_f32 v58, v58
    v_exp_f32 v59, v59
    v_cvt_pk_bf16_f32 v80, v52, v53
    v_cvt_pk_bf16_f32 v81, v54, v55
    v_cvt_pk_bf16_f32 v82, v56, v57
    v_cvt_pk_bf16_f32 v83, v58, v59
    v_exp_f32 v60, v60
    v_exp_f32 v61, v61
    v_mfma_f32_32x32x16_bf16 v[84:99], v[32:35], v[80:83], v[84:99]
    v_exp_f32 v62, v62
    v_exp_f32 v63, v63
    v_exp_f32 v64, v64
    v_exp_f32 v65, v65
    v_exp_f32 v66, v66
    v_mfma_f32_32x32x16_bf16 v[44:59], v[20:23], v[12:15], 0
    buffer_load_dwordx4 v2, s[16:19], s32 offen offset:1024 sc1 lds
    v_exp_f32 v67, v67
    v_cvt_pk_bf16_f32 v76, v60, v61
    v_cvt_pk_bf16_f32 v77, v62, v63
    v_cvt_pk_bf16_f32 v78, v64, v65
    v_cvt_pk_bf16_f32 v79, v66, v67
    v_exp_f32 v68, v68
    v_exp_f32 v69, v69
    v_exp_f32 v70, v70
    v_mfma_f32_32x32x16_bf16 v[100:115], v[28:31], v[76:79], v[100:115]
    v_exp_f32 v71, v71
    v_exp_f32 v72, v72
    v_exp_f32 v73, v73
    v_exp_f32 v74, v74
    v_exp_f32 v75, v75
    v_cvt_pk_bf16_f32 v80, v68, v69
    v_cvt_pk_bf16_f32 v81, v70, v71
    v_cvt_pk_bf16_f32 v82, v72, v73
    v_cvt_pk_bf16_f32 v83, v74, v75
    v_exp_f32 v44, v44
    v_exp_f32 v45, v45
    v_mfma_f32_32x32x16_bf16 v[100:115], v[32:35], v[80:83], v[100:115]
    v_exp_f32 v46, v46
    v_exp_f32 v47, v47
    v_exp_f32 v48, v48
    v_exp_f32 v49, v49
    v_exp_f32 v50, v50
    v_mfma_f32_32x32x16_bf16 v[60:75], v[20:23], v[16:19], 0
    buffer_load_dwordx4 v2, s[16:19], s32 offen offset:2048 sc1 lds
    v_exp_f32 v51, v51
    v_cvt_pk_bf16_f32 v76, v44, v45
    v_cvt_pk_bf16_f32 v77, v46, v47
    v_cvt_pk_bf16_f32 v78, v48, v49
    v_cvt_pk_bf16_f32 v79, v50, v51
    v_exp_f32 v52, v52
    v_exp_f32 v53, v53
    v_exp_f32 v54, v54
    v_mfma_f32_32x32x16_bf16 v[116:131], v[28:31], v[76:79], v[116:131]
    v_exp_f32 v55, v55
    v_exp_f32 v56, v56
    v_exp_f32 v57, v57
    v_exp_f32 v58, v58
    v_exp_f32 v59, v59
    v_cvt_pk_bf16_f32 v80, v52, v53
    v_cvt_pk_bf16_f32 v81, v54, v55
    v_cvt_pk_bf16_f32 v82, v56, v57
    v_cvt_pk_bf16_f32 v83, v58, v59
    v_exp_f32 v60, v60
    v_exp_f32 v61, v61
    v_mfma_f32_32x32x16_bf16 v[116:131], v[32:35], v[80:83], v[116:131]
    v_exp_f32 v62, v62
    v_exp_f32 v63, v63
    v_exp_f32 v64, v64
    v_exp_f32 v65, v65
    v_exp_f32 v66, v66
    s_waitcnt lgkmcnt(0)
    v_mfma_f32_32x32x16_bf16 v[44:59], v[24:27], v[4:7], 0
    buffer_load_dwordx4 v2, s[16:19], s32 offen offset:3072 sc1 lds
    v_exp_f32 v67, v67
    v_cvt_pk_bf16_f32 v76, v60, v61
    v_cvt_pk_bf16_f32 v77, v62, v63
    v_cvt_pk_bf16_f32 v78, v64, v65
    v_cvt_pk_bf16_f32 v79, v66, v67
    v_exp_f32 v68, v68
    v_exp_f32 v69, v69
    v_exp_f32 v70, v70
    v_mfma_f32_32x32x16_bf16 v[132:147], v[28:31], v[76:79], v[132:147]
    v_exp_f32 v71, v71
    v_exp_f32 v72, v72
    v_exp_f32 v73, v73
    v_exp_f32 v74, v74
    v_exp_f32 v75, v75
    v_cvt_pk_bf16_f32 v80, v68, v69
    v_cvt_pk_bf16_f32 v81, v70, v71
    v_cvt_pk_bf16_f32 v82, v72, v73
    v_cvt_pk_bf16_f32 v83, v74, v75
    v_exp_f32 v44, v44
    v_exp_f32 v45, v45
    v_mfma_f32_32x32x16_bf16 v[132:147], v[32:35], v[80:83], v[132:147]
    ds_read_b128 v[20:23], v212 offset:8192
    v_exp_f32 v46, v46
    v_exp_f32 v47, v47
    s_mov_b64 exec, s[58:59]
    ds_read_b128 v[28:31], v213 offset:8192
    ds_read_b128 v[32:35], v213 offset:8704
    s_mov_b64 exec, -1
    v_exp_f32 v48, v48
    v_exp_f32 v49, v49
    v_exp_f32 v50, v50
    v_mfma_f32_32x32x16_bf16 v[60:75], v[24:27], v[8:11], 0
    s_add_u32 m0, s31, 20480
    s_add_u32 s32, s30, 20480
    buffer_load_dwordx4 v2, s[16:19], s32 offen offset:0 sc1 lds
    v_exp_f32 v51, v51
    v_cvt_pk_bf16_f32 v76, v44, v45
    v_cvt_pk_bf16_f32 v77, v46, v47
    v_cvt_pk_bf16_f32 v78, v48, v49
    v_cvt_pk_bf16_f32 v79, v50, v51
    v_exp_f32 v52, v52
    v_exp_f32 v53, v53
    v_exp_f32 v54, v54
    v_mfma_f32_32x32x16_bf16 v[84:99], v[36:39], v[76:79], v[84:99]
    v_exp_f32 v55, v55
    v_exp_f32 v56, v56
    v_exp_f32 v57, v57
    v_exp_f32 v58, v58
    v_exp_f32 v59, v59
    v_cvt_pk_bf16_f32 v80, v52, v53
    v_cvt_pk_bf16_f32 v81, v54, v55
    v_cvt_pk_bf16_f32 v82, v56, v57
    v_cvt_pk_bf16_f32 v83, v58, v59
    v_exp_f32 v60, v60
    v_exp_f32 v61, v61
    v_mfma_f32_32x32x16_bf16 v[84:99], v[40:43], v[80:83], v[84:99]
    v_exp_f32 v62, v62
    v_exp_f32 v63, v63
    v_exp_f32 v64, v64
    v_exp_f32 v65, v65
    v_exp_f32 v66, v66
    v_mfma_f32_32x32x16_bf16 v[44:59], v[24:27], v[12:15], 0
    buffer_load_dwordx4 v2, s[16:19], s32 offen offset:1024 sc1 lds
    v_exp_f32 v67, v67
    v_cvt_pk_bf16_f32 v76, v60, v61
    v_cvt_pk_bf16_f32 v77, v62, v63
    v_cvt_pk_bf16_f32 v78, v64, v65
    v_cvt_pk_bf16_f32 v79, v66, v67
    v_exp_f32 v68, v68
    v_exp_f32 v69, v69
    v_exp_f32 v70, v70
    v_mfma_f32_32x32x16_bf16 v[100:115], v[36:39], v[76:79], v[100:115]
    v_exp_f32 v71, v71
    v_exp_f32 v72, v72
    v_exp_f32 v73, v73
    v_exp_f32 v74, v74
    v_exp_f32 v75, v75
    v_cvt_pk_bf16_f32 v80, v68, v69
    v_cvt_pk_bf16_f32 v81, v70, v71
    v_cvt_pk_bf16_f32 v82, v72, v73
    v_cvt_pk_bf16_f32 v83, v74, v75
    v_exp_f32 v44, v44
    v_exp_f32 v45, v45
    v_mfma_f32_32x32x16_bf16 v[100:115], v[40:43], v[80:83], v[100:115]
    v_exp_f32 v46, v46
    v_exp_f32 v47, v47
    v_exp_f32 v48, v48
    v_exp_f32 v49, v49
    v_exp_f32 v50, v50
    v_mfma_f32_32x32x16_bf16 v[60:75], v[24:27], v[16:19], 0
    buffer_load_dwordx4 v2, s[16:19], s32 offen offset:2048 sc1 lds
    v_exp_f32 v51, v51
    v_cvt_pk_bf16_f32 v76, v44, v45
    v_cvt_pk_bf16_f32 v77, v46, v47
    v_cvt_pk_bf16_f32 v78, v48, v49
    v_cvt_pk_bf16_f32 v79, v50, v51
    v_exp_f32 v52, v52
    v_exp_f32 v53, v53
    v_exp_f32 v54, v54
    v_mfma_f32_32x32x16_bf16 v[116:131], v[36:39], v[76:79], v[116:131]
    v_exp_f32 v55, v55
    v_exp_f32 v56, v56
    v_exp_f32 v57, v57
    v_exp_f32 v58, v58
    v_exp_f32 v59, v59
    v_cvt_pk_bf16_f32 v80, v52, v53
    v_cvt_pk_bf16_f32 v81, v54, v55
    v_cvt_pk_bf16_f32 v82, v56, v57
    v_cvt_pk_bf16_f32 v83, v58, v59
    v_exp_f32 v60, v60
    v_exp_f32 v61, v61
    v_mfma_f32_32x32x16_bf16 v[116:131], v[40:43], v[80:83], v[116:131]
    v_exp_f32 v62, v62
    v_exp_f32 v63, v63
    v_exp_f32 v64, v64
    v_exp_f32 v65, v65
    v_exp_f32 v66, v66
    s_waitcnt lgkmcnt(0)
    v_mfma_f32_32x32x16_bf16 v[44:59], v[20:23], v[4:7], 0
    buffer_load_dwordx4 v2, s[16:19], s32 offen offset:3072 sc1 lds
    v_exp_f32 v67, v67
    v_cvt_pk_bf16_f32 v76, v60, v61
    v_cvt_pk_bf16_f32 v77, v62, v63
    v_cvt_pk_bf16_f32 v78, v64, v65
    v_cvt_pk_bf16_f32 v79, v66, v67
    v_exp_f32 v68, v68
    v_exp_f32 v69, v69
    v_exp_f32 v70, v70
    v_mfma_f32_32x32x16_bf16 v[132:147], v[36:39], v[76:79], v[132:147]
    v_exp_f32 v71, v71
    v_exp_f32 v72, v72
    v_exp_f32 v73, v73
    v_exp_f32 v74, v74
    v_exp_f32 v75, v75
    v_cvt_pk_bf16_f32 v80, v68, v69
    v_cvt_pk_bf16_f32 v81, v70, v71
    v_cvt_pk_bf16_f32 v82, v72, v73
    v_cvt_pk_bf16_f32 v83, v74, v75
    v_exp_f32 v44, v44
    v_exp_f32 v45, v45
    v_mfma_f32_32x32x16_bf16 v[132:147], v[40:43], v[80:83], v[132:147]
    ds_read_b128 v[24:27], v212 offset:10240
    v_exp_f32 v46, v46
    v_exp_f32 v47, v47
    s_mov_b64 exec, s[58:59]
    ds_read_b128 v[36:39], v213 offset:10240
    ds_read_b128 v[40:43], v213 offset:10752
    s_mov_b64 exec, -1
    v_exp_f32 v48, v48
    v_exp_f32 v49, v49
    v_exp_f32 v50, v50
    v_mfma_f32_32x32x16_bf16 v[60:75], v[20:23], v[8:11], 0
    s_add_u32 m0, s31, 32768
    s_add_u32 s32, s30, 32768
    buffer_load_dwordx4 v2, s[16:19], s32 offen offset:0 sc1 lds
    v_exp_f32 v51, v51
    v_cvt_pk_bf16_f32 v76, v44, v45
    v_cvt_pk_bf16_f32 v77, v46, v47
    v_cvt_pk_bf16_f32 v78, v48, v49
    v_cvt_pk_bf16_f32 v79, v50, v51
    v_exp_f32 v52, v52
    v_exp_f32 v53, v53
    v_exp_f32 v54, v54
    v_mfma_f32_32x32x16_bf16 v[84:99], v[28:31], v[76:79], v[84:99]
    v_exp_f32 v55, v55
    v_exp_f32 v56, v56
    v_exp_f32 v57, v57
    v_exp_f32 v58, v58
    v_exp_f32 v59, v59
    v_cvt_pk_bf16_f32 v80, v52, v53
    v_cvt_pk_bf16_f32 v81, v54, v55
    v_cvt_pk_bf16_f32 v82, v56, v57
    v_cvt_pk_bf16_f32 v83, v58, v59
    v_exp_f32 v60, v60
    v_exp_f32 v61, v61
    v_mfma_f32_32x32x16_bf16 v[84:99], v[32:35], v[80:83], v[84:99]
    v_exp_f32 v62, v62
    v_exp_f32 v63, v63
    v_exp_f32 v64, v64
    v_exp_f32 v65, v65
    v_exp_f32 v66, v66
    v_mfma_f32_32x32x16_bf16 v[44:59], v[20:23], v[12:15], 0
    buffer_load_dwordx4 v2, s[16:19], s32 offen offset:1024 sc1 lds
    v_exp_f32 v67, v67
    v_cvt_pk_bf16_f32 v76, v60, v61
    v_cvt_pk_bf16_f32 v77, v62, v63
    v_cvt_pk_bf16_f32 v78, v64, v65
    v_cvt_pk_bf16_f32 v79, v66, v67
    v_exp_f32 v68, v68
    v_exp_f32 v69, v69
    v_exp_f32 v70, v70
    v_mfma_f32_32x32x16_bf16 v[100:115], v[28:31], v[76:79], v[100:115]
    v_exp_f32 v71, v71
    v_exp_f32 v72, v72
    v_exp_f32 v73, v73
    v_exp_f32 v74, v74
    v_exp_f32 v75, v75
    v_cvt_pk_bf16_f32 v80, v68, v69
    v_cvt_pk_bf16_f32 v81, v70, v71
    v_cvt_pk_bf16_f32 v82, v72, v73
    v_cvt_pk_bf16_f32 v83, v74, v75
    v_exp_f32 v44, v44
    v_exp_f32 v45, v45
    v_mfma_f32_32x32x16_bf16 v[100:115], v[32:35], v[80:83], v[100:115]
    v_exp_f32 v46, v46
    v_exp_f32 v47, v47
    v_exp_f32 v48, v48
    v_exp_f32 v49, v49
    v_exp_f32 v50, v50
    v_mfma_f32_32x32x16_bf16 v[60:75], v[20:23], v[16:19], 0
    buffer_load_dwordx4 v2, s[16:19], s32 offen offset:2048 sc1 lds
    v_exp_f32 v51, v51
    v_cvt_pk_bf16_f32 v76, v44, v45
    v_cvt_pk_bf16_f32 v77, v46, v47
    v_cvt_pk_bf16_f32 v78, v48, v49
    v_cvt_pk_bf16_f32 v79, v50, v51
    v_exp_f32 v52, v52
    v_exp_f32 v53, v53
    v_exp_f32 v54, v54
    v_mfma_f32_32x32x16_bf16 v[116:131], v[28:31], v[76:79], v[116:131]
    v_exp_f32 v55, v55
    v_exp_f32 v56, v56
    v_exp_f32 v57, v57
    v_exp_f32 v58, v58
    v_exp_f32 v59, v59
    v_cvt_pk_bf16_f32 v80, v52, v53
    v_cvt_pk_bf16_f32 v81, v54, v55
    v_cvt_pk_bf16_f32 v82, v56, v57
    v_cvt_pk_bf16_f32 v83, v58, v59
    v_exp_f32 v60, v60
    v_exp_f32 v61, v61
    v_mfma_f32_32x32x16_bf16 v[116:131], v[32:35], v[80:83], v[116:131]
    v_exp_f32 v62, v62
    v_exp_f32 v63, v63
    v_exp_f32 v64, v64
    v_exp_f32 v65, v65
    v_exp_f32 v66, v66
    s_waitcnt lgkmcnt(0)
    v_mfma_f32_32x32x16_bf16 v[44:59], v[24:27], v[4:7], 0
    buffer_load_dwordx4 v2, s[16:19], s32 offen offset:3072 sc1 lds
    v_exp_f32 v67, v67
    v_cvt_pk_bf16_f32 v76, v60, v61
    v_cvt_pk_bf16_f32 v77, v62, v63
    v_cvt_pk_bf16_f32 v78, v64, v65
    v_cvt_pk_bf16_f32 v79, v66, v67
    v_exp_f32 v68, v68
    v_exp_f32 v69, v69
    v_exp_f32 v70, v70
    v_mfma_f32_32x32x16_bf16 v[132:147], v[28:31], v[76:79], v[132:147]
    v_exp_f32 v71, v71
    v_exp_f32 v72, v72
    v_exp_f32 v73, v73
    v_exp_f32 v74, v74
    v_exp_f32 v75, v75
    v_cvt_pk_bf16_f32 v80, v68, v69
    v_cvt_pk_bf16_f32 v81, v70, v71
    v_cvt_pk_bf16_f32 v82, v72, v73
    v_cvt_pk_bf16_f32 v83, v74, v75
    v_exp_f32 v44, v44
    v_exp_f32 v45, v45
    v_mfma_f32_32x32x16_bf16 v[132:147], v[32:35], v[80:83], v[132:147]
    ds_read_b128 v[20:23], v212 offset:12288
    v_exp_f32 v46, v46
    v_exp_f32 v47, v47
    s_mov_b64 exec, s[58:59]
    ds_read_b128 v[28:31], v213 offset:12288
    ds_read_b128 v[32:35], v213 offset:12800
    s_mov_b64 exec, -1
    v_exp_f32 v48, v48
    v_exp_f32 v49, v49
    v_exp_f32 v50, v50
    v_mfma_f32_32x32x16_bf16 v[60:75], v[24:27], v[8:11], 0
    s_add_u32 m0, s31, 36864
    s_add_u32 s32, s30, 36864
    buffer_load_dwordx4 v2, s[16:19], s32 offen offset:0 sc1 lds
    v_exp_f32 v51, v51
    v_cvt_pk_bf16_f32 v76, v44, v45
    v_cvt_pk_bf16_f32 v77, v46, v47
    v_cvt_pk_bf16_f32 v78, v48, v49
    v_cvt_pk_bf16_f32 v79, v50, v51
    v_exp_f32 v52, v52
    v_exp_f32 v53, v53
    v_exp_f32 v54, v54
    v_mfma_f32_32x32x16_bf16 v[84:99], v[36:39], v[76:79], v[84:99]
    v_exp_f32 v55, v55
    v_exp_f32 v56, v56
    v_exp_f32 v57, v57
    v_exp_f32 v58, v58
    v_exp_f32 v59, v59
    v_cvt_pk_bf16_f32 v80, v52, v53
    v_cvt_pk_bf16_f32 v81, v54, v55
    v_cvt_pk_bf16_f32 v82, v56, v57
    v_cvt_pk_bf16_f32 v83, v58, v59
    v_exp_f32 v60, v60
    v_exp_f32 v61, v61
    v_mfma_f32_32x32x16_bf16 v[84:99], v[40:43], v[80:83], v[84:99]
    v_exp_f32 v62, v62
    v_exp_f32 v63, v63
    v_exp_f32 v64, v64
    v_exp_f32 v65, v65
    v_exp_f32 v66, v66
    v_mfma_f32_32x32x16_bf16 v[44:59], v[24:27], v[12:15], 0
    buffer_load_dwordx4 v2, s[16:19], s32 offen offset:1024 sc1 lds
    v_exp_f32 v67, v67
    v_cvt_pk_bf16_f32 v76, v60, v61
    v_cvt_pk_bf16_f32 v77, v62, v63
    v_cvt_pk_bf16_f32 v78, v64, v65
    v_cvt_pk_bf16_f32 v79, v66, v67
    v_exp_f32 v68, v68
    v_exp_f32 v69, v69
    v_exp_f32 v70, v70
    v_mfma_f32_32x32x16_bf16 v[100:115], v[36:39], v[76:79], v[100:115]
    v_exp_f32 v71, v71
    v_exp_f32 v72, v72
    v_exp_f32 v73, v73
    v_exp_f32 v74, v74
    v_exp_f32 v75, v75
    v_cvt_pk_bf16_f32 v80, v68, v69
    v_cvt_pk_bf16_f32 v81, v70, v71
    v_cvt_pk_bf16_f32 v82, v72, v73
    v_cvt_pk_bf16_f32 v83, v74, v75
    v_exp_f32 v44, v44
    v_exp_f32 v45, v45
    v_mfma_f32_32x32x16_bf16 v[100:115], v[40:43], v[80:83], v[100:115]
    v_exp_f32 v46, v46
    v_exp_f32 v47, v47
    v_exp_f32 v48, v48
    v_exp_f32 v49, v49
    v_exp_f32 v50, v50
    v_mfma_f32_32x32x16_bf16 v[60:75], v[24:27], v[16:19], 0
    buffer_load_dwordx4 v2, s[16:19], s32 offen offset:2048 sc1 lds
    v_exp_f32 v51, v51
    v_cvt_pk_bf16_f32 v76, v44, v45
    v_cvt_pk_bf16_f32 v77, v46, v47
    v_cvt_pk_bf16_f32 v78, v48, v49
    v_cvt_pk_bf16_f32 v79, v50, v51
    v_exp_f32 v52, v52
    v_exp_f32 v53, v53
    v_exp_f32 v54, v54
    v_mfma_f32_32x32x16_bf16 v[116:131], v[36:39], v[76:79], v[116:131]
    v_exp_f32 v55, v55
    v_exp_f32 v56, v56
    v_exp_f32 v57, v57
    v_exp_f32 v58, v58
    v_exp_f32 v59, v59
    v_cvt_pk_bf16_f32 v80, v52, v53
    v_cvt_pk_bf16_f32 v81, v54, v55
    v_cvt_pk_bf16_f32 v82, v56, v57
    v_cvt_pk_bf16_f32 v83, v58, v59
    v_exp_f32 v60, v60
    v_exp_f32 v61, v61
    v_mfma_f32_32x32x16_bf16 v[116:131], v[40:43], v[80:83], v[116:131]
    v_exp_f32 v62, v62
    v_exp_f32 v63, v63
    v_exp_f32 v64, v64
    v_exp_f32 v65, v65
    v_exp_f32 v66, v66
    s_waitcnt lgkmcnt(0)
    v_mfma_f32_32x32x16_bf16 v[44:59], v[20:23], v[4:7], 0
    buffer_load_dwordx4 v2, s[16:19], s32 offen offset:3072 sc1 lds
    v_exp_f32 v67, v67
    v_cvt_pk_bf16_f32 v76, v60, v61
    v_cvt_pk_bf16_f32 v77, v62, v63
    v_cvt_pk_bf16_f32 v78, v64, v65
    v_cvt_pk_bf16_f32 v79, v66, v67
    v_exp_f32 v68, v68
    v_exp_f32 v69, v69
    v_exp_f32 v70, v70
    v_mfma_f32_32x32x16_bf16 v[132:147], v[36:39], v[76:79], v[132:147]
    v_exp_f32 v71, v71
    v_exp_f32 v72, v72
    v_exp_f32 v73, v73
    v_exp_f32 v74, v74
    v_exp_f32 v75, v75
    v_cvt_pk_bf16_f32 v80, v68, v69
    v_cvt_pk_bf16_f32 v81, v70, v71
    v_cvt_pk_bf16_f32 v82, v72, v73
    v_cvt_pk_bf16_f32 v83, v74, v75
    v_exp_f32 v44, v44
    v_exp_f32 v45, v45
    v_mfma_f32_32x32x16_bf16 v[132:147], v[40:43], v[80:83], v[132:147]
    ds_read_b128 v[24:27], v212 offset:14336
    v_exp_f32 v46, v46
    v_exp_f32 v47, v47
    s_mov_b64 exec, s[58:59]
    ds_read_b128 v[36:39], v213 offset:14336
    ds_read_b128 v[40:43], v213 offset:14848
    s_mov_b64 exec, -1
    v_exp_f32 v48, v48
    v_exp_f32 v49, v49
    v_exp_f32 v50, v50
    v_mfma_f32_32x32x16_bf16 v[60:75], v[20:23], v[8:11], 0
    v_lshlrev_b32 v214, 7, v1
    v_and_b32 v215, 3, v1
    v_lshlrev_b32 v215, 7, v215
    s_mul_i32 s60, s2, 28672
    s_lshl_b32 s61, s22, 13
    s_add_u32 s60, s60, s61
    s_lshl_b32 s62, s2, 11
    s_lshl_b32 s63, s22, 9
    s_add_u32 s62, s62, s63
    buffer_load_dword v216, v215, s[4:7], s62 offen
    v_exp_f32 v51, v51
    v_cvt_pk_bf16_f32 v76, v44, v45
    v_cvt_pk_bf16_f32 v77, v46, v47
    v_cvt_pk_bf16_f32 v78, v48, v49
    v_cvt_pk_bf16_f32 v79, v50, v51
    v_exp_f32 v52, v52
    v_exp_f32 v53, v53
    v_exp_f32 v54, v54
    v_mfma_f32_32x32x16_bf16 v[84:99], v[28:31], v[76:79], v[84:99]
    v_exp_f32 v55, v55
    v_exp_f32 v56, v56
    v_exp_f32 v57, v57
    v_exp_f32 v58, v58
    v_exp_f32 v59, v59
    v_cvt_pk_bf16_f32 v80, v52, v53
    v_cvt_pk_bf16_f32 v81, v54, v55
    v_cvt_pk_bf16_f32 v82, v56, v57
    v_cvt_pk_bf16_f32 v83, v58, v59
    v_exp_f32 v60, v60
    v_exp_f32 v61, v61
    v_mfma_f32_32x32x16_bf16 v[84:99], v[32:35], v[80:83], v[84:99]
    v_exp_f32 v62, v62
    v_exp_f32 v63, v63
    v_exp_f32 v64, v64
    v_exp_f32 v65, v65
    v_exp_f32 v66, v66
    v_mfma_f32_32x32x16_bf16 v[44:59], v[20:23], v[12:15], 0
    v_exp_f32 v67, v67
    v_cvt_pk_bf16_f32 v76, v60, v61
    v_cvt_pk_bf16_f32 v77, v62, v63
    v_cvt_pk_bf16_f32 v78, v64, v65
    v_cvt_pk_bf16_f32 v79, v66, v67
    v_exp_f32 v68, v68
    v_exp_f32 v69, v69
    v_exp_f32 v70, v70
    v_mfma_f32_32x32x16_bf16 v[100:115], v[28:31], v[76:79], v[100:115]
    v_exp_f32 v71, v71
    v_exp_f32 v72, v72
    v_exp_f32 v73, v73
    v_exp_f32 v74, v74
    v_exp_f32 v75, v75
    v_cvt_pk_bf16_f32 v80, v68, v69
    v_cvt_pk_bf16_f32 v81, v70, v71
    v_cvt_pk_bf16_f32 v82, v72, v73
    v_cvt_pk_bf16_f32 v83, v74, v75
    v_exp_f32 v44, v44
    v_exp_f32 v45, v45
    v_mfma_f32_32x32x16_bf16 v[100:115], v[32:35], v[80:83], v[100:115]
    v_exp_f32 v46, v46
    v_exp_f32 v47, v47
    v_exp_f32 v48, v48
    v_exp_f32 v49, v49
    v_exp_f32 v50, v50
    v_mfma_f32_32x32x16_bf16 v[60:75], v[20:23], v[16:19], 0
    v_exp_f32 v51, v51
    v_cvt_pk_bf16_f32 v76, v44, v45
    v_cvt_pk_bf16_f32 v77, v46, v47
    v_cvt_pk_bf16_f32 v78, v48, v49
    v_cvt_pk_bf16_f32 v79, v50, v51
    v_exp_f32 v52, v52
    v_exp_f32 v53, v53
    v_exp_f32 v54, v54
    v_mfma_f32_32x32x16_bf16 v[116:131], v[28:31], v[76:79], v[116:131]
    v_exp_f32 v55, v55
    v_exp_f32 v56, v56
    v_exp_f32 v57, v57
    v_exp_f32 v58, v58
    v_exp_f32 v59, v59
    v_cvt_pk_bf16_f32 v80, v52, v53
    v_cvt_pk_bf16_f32 v81, v54, v55
    v_cvt_pk_bf16_f32 v82, v56, v57
    v_cvt_pk_bf16_f32 v83, v58, v59
    v_exp_f32 v60, v60
    v_exp_f32 v61, v61
    v_mfma_f32_32x32x16_bf16 v[116:131], v[32:35], v[80:83], v[116:131]
    v_exp_f32 v62, v62
    v_exp_f32 v63, v63
    v_exp_f32 v64, v64
    v_exp_f32 v65, v65
    v_exp_f32 v66, v66
    s_waitcnt lgkmcnt(0)
    v_mfma_f32_32x32x16_bf16 v[44:59], v[24:27], v[4:7], 0
    v_exp_f32 v67, v67
    v_cvt_pk_bf16_f32 v76, v60, v61
    v_cvt_pk_bf16_f32 v77, v62, v63
    v_cvt_pk_bf16_f32 v78, v64, v65
    v_cvt_pk_bf16_f32 v79, v66, v67
    v_exp_f32 v68, v68
    v_exp_f32 v69, v69
    v_exp_f32 v70, v70
    v_mfma_f32_32x32x16_bf16 v[132:147], v[28:31], v[76:79], v[132:147]
    v_exp_f32 v71, v71
    v_exp_f32 v72, v72
    v_exp_f32 v73, v73
    v_exp_f32 v74, v74
    v_exp_f32 v75, v75
    v_cvt_pk_bf16_f32 v80, v68, v69
    v_cvt_pk_bf16_f32 v81, v70, v71
    v_cvt_pk_bf16_f32 v82, v72, v73
    v_cvt_pk_bf16_f32 v83, v74, v75
    s_waitcnt vmcnt(1)
    s_barrier
    v_exp_f32 v44, v44
    v_exp_f32 v45, v45
    v_mfma_f32_32x32x16_bf16 v[132:147], v[32:35], v[80:83], v[132:147]
    ds_read_b128 v[20:23], v212 offset:16384
    v_exp_f32 v46, v46
    v_exp_f32 v47, v47
    s_mov_b64 exec, s[58:59]
    ds_read_b128 v[28:31], v213 offset:16384
    ds_read_b128 v[32:35], v213 offset:16896
    s_mov_b64 exec, -1
    v_exp_f32 v48, v48
    v_exp_f32 v49, v49
    v_exp_f32 v50, v50
    v_mfma_f32_32x32x16_bf16 v[60:75], v[24:27], v[8:11], 0
    v_exp_f32 v51, v51
    v_cvt_pk_bf16_f32 v76, v44, v45
    v_cvt_pk_bf16_f32 v77, v46, v47
    v_cvt_pk_bf16_f32 v78, v48, v49
    v_cvt_pk_bf16_f32 v79, v50, v51
    v_exp_f32 v52, v52
    v_exp_f32 v53, v53
    v_exp_f32 v54, v54
    v_mfma_f32_32x32x16_bf16 v[84:99], v[36:39], v[76:79], v[84:99]
    v_exp_f32 v55, v55
    v_exp_f32 v56, v56
    v_exp_f32 v57, v57
    v_exp_f32 v58, v58
    v_exp_f32 v59, v59
    v_cvt_pk_bf16_f32 v80, v52, v53
    v_cvt_pk_bf16_f32 v81, v54, v55
    v_cvt_pk_bf16_f32 v82, v56, v57
    v_cvt_pk_bf16_f32 v83, v58, v59
    v_exp_f32 v60, v60
    v_exp_f32 v61, v61
    v_mfma_f32_32x32x16_bf16 v[84:99], v[40:43], v[80:83], v[84:99]
    v_exp_f32 v62, v62
    v_exp_f32 v63, v63
    v_exp_f32 v64, v64
    v_exp_f32 v65, v65
    v_exp_f32 v66, v66
    v_mfma_f32_32x32x16_bf16 v[44:59], v[24:27], v[12:15], 0
    v_exp_f32 v67, v67
    v_cvt_pk_bf16_f32 v76, v60, v61
    v_cvt_pk_bf16_f32 v77, v62, v63
    v_cvt_pk_bf16_f32 v78, v64, v65
    v_cvt_pk_bf16_f32 v79, v66, v67
    v_exp_f32 v68, v68
    v_exp_f32 v69, v69
    v_exp_f32 v70, v70
    v_mfma_f32_32x32x16_bf16 v[100:115], v[36:39], v[76:79], v[100:115]
    v_exp_f32 v71, v71
    v_exp_f32 v72, v72
    v_exp_f32 v73, v73
    v_exp_f32 v74, v74
    v_exp_f32 v75, v75
    v_cvt_pk_bf16_f32 v80, v68, v69
    v_cvt_pk_bf16_f32 v81, v70, v71
    v_cvt_pk_bf16_f32 v82, v72, v73
    v_cvt_pk_bf16_f32 v83, v74, v75
    v_exp_f32 v44, v44
    v_exp_f32 v45, v45
    v_mfma_f32_32x32x16_bf16 v[100:115], v[40:43], v[80:83], v[100:115]
    v_exp_f32 v46, v46
    v_exp_f32 v47, v47
    v_exp_f32 v48, v48
    v_exp_f32 v49, v49
    v_exp_f32 v50, v50
    v_mfma_f32_32x32x16_bf16 v[60:75], v[24:27], v[16:19], 0
    v_exp_f32 v51, v51
    v_cvt_pk_bf16_f32 v76, v44, v45
    v_cvt_pk_bf16_f32 v77, v46, v47
    v_cvt_pk_bf16_f32 v78, v48, v49
    v_cvt_pk_bf16_f32 v79, v50, v51
    v_exp_f32 v52, v52
    v_exp_f32 v53, v53
    v_exp_f32 v54, v54
    v_mfma_f32_32x32x16_bf16 v[116:131], v[36:39], v[76:79], v[116:131]
    v_exp_f32 v55, v55
    v_exp_f32 v56, v56
    v_exp_f32 v57, v57
    v_exp_f32 v58, v58
    v_exp_f32 v59, v59
    v_cvt_pk_bf16_f32 v80, v52, v53
    v_cvt_pk_bf16_f32 v81, v54, v55
    v_cvt_pk_bf16_f32 v82, v56, v57
    v_cvt_pk_bf16_f32 v83, v58, v59
    v_exp_f32 v60, v60
    v_exp_f32 v61, v61
    v_mfma_f32_32x32x16_bf16 v[116:131], v[40:43], v[80:83], v[116:131]
    v_exp_f32 v62, v62
    v_exp_f32 v63, v63
    v_exp_f32 v64, v64
    v_exp_f32 v65, v65
    v_exp_f32 v66, v66
    s_waitcnt lgkmcnt(0)
    v_mfma_f32_32x32x16_bf16 v[44:59], v[20:23], v[4:7], 0
    v_exp_f32 v67, v67
    v_cvt_pk_bf16_f32 v76, v60, v61
    v_cvt_pk_bf16_f32 v77, v62, v63
    v_cvt_pk_bf16_f32 v78, v64, v65
    v_cvt_pk_bf16_f32 v79, v66, v67
    v_exp_f32 v68, v68
    v_exp_f32 v69, v69
    v_exp_f32 v70, v70
    v_mfma_f32_32x32x16_bf16 v[132:147], v[36:39], v[76:79], v[132:147]
    v_exp_f32 v71, v71
    v_exp_f32 v72, v72
    v_exp_f32 v73, v73
    v_exp_f32 v74, v74
    v_exp_f32 v75, v75
    v_cvt_pk_bf16_f32 v80, v68, v69
    v_cvt_pk_bf16_f32 v81, v70, v71
    v_cvt_pk_bf16_f32 v82, v72, v73
    v_cvt_pk_bf16_f32 v83, v74, v75
    v_exp_f32 v44, v44
    v_exp_f32 v45, v45
    v_mfma_f32_32x32x16_bf16 v[132:147], v[40:43], v[80:83], v[132:147]
    ds_read_b128 v[24:27], v212 offset:18432
    v_exp_f32 v46, v46
    v_exp_f32 v47, v47
    s_mov_b64 exec, s[58:59]
    ds_read_b128 v[36:39], v213 offset:18432
    ds_read_b128 v[40:43], v213 offset:18944
    s_mov_b64 exec, -1
    v_exp_f32 v48, v48
    v_exp_f32 v49, v49
    v_exp_f32 v50, v50
    v_mfma_f32_32x32x16_bf16 v[60:75], v[20:23], v[8:11], 0
    v_mov_b32 v148, -1
    v_mov_b32 v149, -1
    v_mov_b32 v150, -1
    v_mov_b32 v151, -1
    v_lshlrev_b32 v152, 2, v1
    s_lshl_b32 s64, s2, 13
    s_lshl_b32 s65, s22, 11
    s_add_u32 s64, s64, s65
    s_lshl_b32 s66, s2, 10
    s_lshl_b32 s65, s22, 8
    s_add_u32 s66, s66, s65
    s_add_u32 s66, s66, 9437184
    s_add_u32 s65, s64, 7340032
    buffer_store_dwordx4 v[148:151], v2, s[16:19], s65 offen offset:0 sc1
    v_exp_f32 v51, v51
    v_cvt_pk_bf16_f32 v76, v44, v45
    v_cvt_pk_bf16_f32 v77, v46, v47
    v_cvt_pk_bf16_f32 v78, v48, v49
    v_cvt_pk_bf16_f32 v79, v50, v51
    v_exp_f32 v52, v52
    v_exp_f32 v53, v53
    v_exp_f32 v54, v54
    v_mfma_f32_32x32x16_bf16 v[84:99], v[28:31], v[76:79], v[84:99]
    v_exp_f32 v55, v55
    v_exp_f32 v56, v56
    v_exp_f32 v57, v57
    v_exp_f32 v58, v58
    v_exp_f32 v59, v59
    v_cvt_pk_bf16_f32 v80, v52, v53
    v_cvt_pk_bf16_f32 v81, v54, v55
    v_cvt_pk_bf16_f32 v82, v56, v57
    v_cvt_pk_bf16_f32 v83, v58, v59
    v_exp_f32 v60, v60
    v_exp_f32 v61, v61
    v_mfma_f32_32x32x16_bf16 v[84:99], v[32:35], v[80:83], v[84:99]
    v_exp_f32 v62, v62
    v_exp_f32 v63, v63
    v_exp_f32 v64, v64
    v_exp_f32 v65, v65
    v_exp_f32 v66, v66
    v_mfma_f32_32x32x16_bf16 v[44:59], v[20:23], v[12:15], 0
    v_exp_f32 v67, v67
    v_cvt_pk_bf16_f32 v76, v60, v61
    v_cvt_pk_bf16_f32 v77, v62, v63
    v_cvt_pk_bf16_f32 v78, v64, v65
    v_cvt_pk_bf16_f32 v79, v66, v67
    v_exp_f32 v68, v68
    v_exp_f32 v69, v69
    v_exp_f32 v70, v70
    v_mfma_f32_32x32x16_bf16 v[100:115], v[28:31], v[76:79], v[100:115]
    v_exp_f32 v71, v71
    v_exp_f32 v72, v72
    v_exp_f32 v73, v73
    v_exp_f32 v74, v74
    v_exp_f32 v75, v75
    v_cvt_pk_bf16_f32 v80, v68, v69
    v_cvt_pk_bf16_f32 v81, v70, v71
    v_cvt_pk_bf16_f32 v82, v72, v73
    v_cvt_pk_bf16_f32 v83, v74, v75
    v_exp_f32 v44, v44
    v_exp_f32 v45, v45
    v_mfma_f32_32x32x16_bf16 v[100:115], v[32:35], v[80:83], v[100:115]
    v_exp_f32 v46, v46
    v_exp_f32 v47, v47
    v_exp_f32 v48, v48
    v_exp_f32 v49, v49
    v_exp_f32 v50, v50
    v_mfma_f32_32x32x16_bf16 v[60:75], v[20:23], v[16:19], 0
    v_exp_f32 v51, v51
    v_cvt_pk_bf16_f32 v76, v44, v45
    v_cvt_pk_bf16_f32 v77, v46, v47
    v_cvt_pk_bf16_f32 v78, v48, v49
    v_cvt_pk_bf16_f32 v79, v50, v51
    v_exp_f32 v52, v52
    v_exp_f32 v53, v53
    v_exp_f32 v54, v54
    v_mfma_f32_32x32x16_bf16 v[116:131], v[28:31], v[76:79], v[116:131]
    v_exp_f32 v55, v55
    v_exp_f32 v56, v56
    v_exp_f32 v57, v57
    v_exp_f32 v58, v58
    v_exp_f32 v59, v59
    v_cvt_pk_bf16_f32 v80, v52, v53
    v_cvt_pk_bf16_f32 v81, v54, v55
    v_cvt_pk_bf16_f32 v82, v56, v57
    v_cvt_pk_bf16_f32 v83, v58, v59
    v_exp_f32 v60, v60
    v_exp_f32 v61, v61
    v_mfma_f32_32x32x16_bf16 v[116:131], v[32:35], v[80:83], v[116:131]
    v_exp_f32 v62, v62
    v_exp_f32 v63, v63
    v_exp_f32 v64, v64
    v_exp_f32 v65, v65
    v_exp_f32 v66, v66
    s_waitcnt lgkmcnt(0)
    v_mfma_f32_32x32x16_bf16 v[44:59], v[24:27], v[4:7], 0
    s_add_u32 s65, s64, 7340032
    buffer_store_dwordx4 v[148:151], v2, s[16:19], s65 offen offset:1024 sc1
    v_exp_f32 v67, v67
    v_cvt_pk_bf16_f32 v76, v60, v61
    v_cvt_pk_bf16_f32 v77, v62, v63
    v_cvt_pk_bf16_f32 v78, v64, v65
    v_cvt_pk_bf16_f32 v79, v66, v67
    v_exp_f32 v68, v68
    v_exp_f32 v69, v69
    v_exp_f32 v70, v70
    v_mfma_f32_32x32x16_bf16 v[132:147], v[28:31], v[76:79], v[132:147]
    v_exp_f32 v71, v71
    v_exp_f32 v72, v72
    v_exp_f32 v73, v73
    v_exp_f32 v74, v74
    v_exp_f32 v75, v75
    v_cvt_pk_bf16_f32 v80, v68, v69
    v_cvt_pk_bf16_f32 v81, v70, v71
    v_cvt_pk_bf16_f32 v82, v72, v73
    v_cvt_pk_bf16_f32 v83, v74, v75
    v_exp_f32 v44, v44
    v_exp_f32 v45, v45
    v_mfma_f32_32x32x16_bf16 v[132:147], v[32:35], v[80:83], v[132:147]
    ds_read_b128 v[20:23], v212 offset:20480
    v_exp_f32 v46, v46
    v_exp_f32 v47, v47
    s_mov_b64 exec, s[58:59]
    ds_read_b128 v[28:31], v213 offset:20480
    ds_read_b128 v[32:35], v213 offset:20992
    s_mov_b64 exec, -1
    v_exp_f32 v48, v48
    v_exp_f32 v49, v49
    v_exp_f32 v50, v50
    v_mfma_f32_32x32x16_bf16 v[60:75], v[24:27], v[8:11], 0
    v_exp_f32 v51, v51
    v_cvt_pk_bf16_f32 v76, v44, v45
    v_cvt_pk_bf16_f32 v77, v46, v47
    v_cvt_pk_bf16_f32 v78, v48, v49
    v_cvt_pk_bf16_f32 v79, v50, v51
    v_exp_f32 v52, v52
    v_exp_f32 v53, v53
    v_exp_f32 v54, v54
    v_mfma_f32_32x32x16_bf16 v[84:99], v[36:39], v[76:79], v[84:99]
    v_exp_f32 v55, v55
    v_exp_f32 v56, v56
    v_exp_f32 v57, v57
    v_exp_f32 v58, v58
    v_exp_f32 v59, v59
    v_cvt_pk_bf16_f32 v80, v52, v53
    v_cvt_pk_bf16_f32 v81, v54, v55
    v_cvt_pk_bf16_f32 v82, v56, v57
    v_cvt_pk_bf16_f32 v83, v58, v59
    v_exp_f32 v60, v60
    v_exp_f32 v61, v61
    v_mfma_f32_32x32x16_bf16 v[84:99], v[40:43], v[80:83], v[84:99]
    v_exp_f32 v62, v62
    v_exp_f32 v63, v63
    v_exp_f32 v64, v64
    v_exp_f32 v65, v65
    v_exp_f32 v66, v66
    v_mfma_f32_32x32x16_bf16 v[44:59], v[24:27], v[12:15], 0
    v_exp_f32 v67, v67
    v_cvt_pk_bf16_f32 v76, v60, v61
    v_cvt_pk_bf16_f32 v77, v62, v63
    v_cvt_pk_bf16_f32 v78, v64, v65
    v_cvt_pk_bf16_f32 v79, v66, v67
    v_exp_f32 v68, v68
    v_exp_f32 v69, v69
    v_exp_f32 v70, v70
    v_mfma_f32_32x32x16_bf16 v[100:115], v[36:39], v[76:79], v[100:115]
    v_exp_f32 v71, v71
    v_exp_f32 v72, v72
    v_exp_f32 v73, v73
    v_exp_f32 v74, v74
    v_exp_f32 v75, v75
    v_cvt_pk_bf16_f32 v80, v68, v69
    v_cvt_pk_bf16_f32 v81, v70, v71
    v_cvt_pk_bf16_f32 v82, v72, v73
    v_cvt_pk_bf16_f32 v83, v74, v75
    v_exp_f32 v44, v44
    v_exp_f32 v45, v45
    v_mfma_f32_32x32x16_bf16 v[100:115], v[40:43], v[80:83], v[100:115]
    v_exp_f32 v46, v46
    v_exp_f32 v47, v47
    v_exp_f32 v48, v48
    v_exp_f32 v49, v49
    v_exp_f32 v50, v50
    v_mfma_f32_32x32x16_bf16 v[60:75], v[24:27], v[16:19], 0
    s_add_u32 s65, s64, 12582912
    buffer_store_dwordx4 v[148:151], v2, s[16:19], s65 offen offset:0 sc1
    v_exp_f32 v51, v51
    v_cvt_pk_bf16_f32 v76, v44, v45
    v_cvt_pk_bf16_f32 v77, v46, v47
    v_cvt_pk_bf16_f32 v78, v48, v49
    v_cvt_pk_bf16_f32 v79, v50, v51
    v_exp_f32 v52, v52
    v_exp_f32 v53, v53
    v_exp_f32 v54, v54
    v_mfma_f32_32x32x16_bf16 v[116:131], v[36:39], v[76:79], v[116:131]
    v_exp_f32 v55, v55
    v_exp_f32 v56, v56
    v_exp_f32 v57, v57
    v_exp_f32 v58, v58
    v_exp_f32 v59, v59
    v_cvt_pk_bf16_f32 v80, v52, v53
    v_cvt_pk_bf16_f32 v81, v54, v55
    v_cvt_pk_bf16_f32 v82, v56, v57
    v_cvt_pk_bf16_f32 v83, v58, v59
    v_exp_f32 v60, v60
    v_exp_f32 v61, v61
    v_mfma_f32_32x32x16_bf16 v[116:131], v[40:43], v[80:83], v[116:131]
    v_exp_f32 v62, v62
    v_exp_f32 v63, v63
    v_exp_f32 v64, v64
    v_exp_f32 v65, v65
    v_exp_f32 v66, v66
    s_waitcnt lgkmcnt(0)
    v_mfma_f32_32x32x16_bf16 v[44:59], v[20:23], v[4:7], 0
    v_exp_f32 v67, v67
    v_cvt_pk_bf16_f32 v76, v60, v61
    v_cvt_pk_bf16_f32 v77, v62, v63
    v_cvt_pk_bf16_f32 v78, v64, v65
    v_cvt_pk_bf16_f32 v79, v66, v67
    v_exp_f32 v68, v68
    v_exp_f32 v69, v69
    v_exp_f32 v70, v70
    v_mfma_f32_32x32x16_bf16 v[132:147], v[36:39], v[76:79], v[132:147]
    v_exp_f32 v71, v71
    v_exp_f32 v72, v72
    v_exp_f32 v73, v73
    v_exp_f32 v74, v74
    v_exp_f32 v75, v75
    v_cvt_pk_bf16_f32 v80, v68, v69
    v_cvt_pk_bf16_f32 v81, v70, v71
    v_cvt_pk_bf16_f32 v82, v72, v73
    v_cvt_pk_bf16_f32 v83, v74, v75
    v_exp_f32 v44, v44
    v_exp_f32 v45, v45
    v_mfma_f32_32x32x16_bf16 v[132:147], v[40:43], v[80:83], v[132:147]
    ds_read_b128 v[24:27], v212 offset:22528
    v_exp_f32 v46, v46
    v_exp_f32 v47, v47
    s_mov_b64 exec, s[58:59]
    ds_read_b128 v[36:39], v213 offset:22528
    ds_read_b128 v[40:43], v213 offset:23040
    s_mov_b64 exec, -1
    v_exp_f32 v48, v48
    v_exp_f32 v49, v49
    v_exp_f32 v50, v50
    v_mfma_f32_32x32x16_bf16 v[60:75], v[20:23], v[8:11], 0
    v_exp_f32 v51, v51
    v_cvt_pk_bf16_f32 v76, v44, v45
    v_cvt_pk_bf16_f32 v77, v46, v47
    v_cvt_pk_bf16_f32 v78, v48, v49
    v_cvt_pk_bf16_f32 v79, v50, v51
    v_exp_f32 v52, v52
    v_exp_f32 v53, v53
    v_exp_f32 v54, v54
    v_mfma_f32_32x32x16_bf16 v[84:99], v[28:31], v[76:79], v[84:99]
    v_exp_f32 v55, v55
    v_exp_f32 v56, v56
    v_exp_f32 v57, v57
    v_exp_f32 v58, v58
    v_exp_f32 v59, v59
    v_cvt_pk_bf16_f32 v80, v52, v53
    v_cvt_pk_bf16_f32 v81, v54, v55
    v_cvt_pk_bf16_f32 v82, v56, v57
    v_cvt_pk_bf16_f32 v83, v58, v59
    v_exp_f32 v60, v60
    v_exp_f32 v61, v61
    v_mfma_f32_32x32x16_bf16 v[84:99], v[32:35], v[80:83], v[84:99]
    v_exp_f32 v62, v62
    v_exp_f32 v63, v63
    v_exp_f32 v64, v64
    v_exp_f32 v65, v65
    v_exp_f32 v66, v66
    v_mfma_f32_32x32x16_bf16 v[44:59], v[20:23], v[12:15], 0
    s_add_u32 s65, s64, 12582912
    buffer_store_dwordx4 v[148:151], v2, s[16:19], s65 offen offset:1024 sc1
    v_exp_f32 v67, v67
    v_cvt_pk_bf16_f32 v76, v60, v61
    v_cvt_pk_bf16_f32 v77, v62, v63
    v_cvt_pk_bf16_f32 v78, v64, v65
    v_cvt_pk_bf16_f32 v79, v66, v67
    v_exp_f32 v68, v68
    v_exp_f32 v69, v69
    v_exp_f32 v70, v70
    v_mfma_f32_32x32x16_bf16 v[100:115], v[28:31], v[76:79], v[100:115]
    v_exp_f32 v71, v71
    v_exp_f32 v72, v72
    v_exp_f32 v73, v73
    v_exp_f32 v74, v74
    v_exp_f32 v75, v75
    v_cvt_pk_bf16_f32 v80, v68, v69
    v_cvt_pk_bf16_f32 v81, v70, v71
    v_cvt_pk_bf16_f32 v82, v72, v73
    v_cvt_pk_bf16_f32 v83, v74, v75
    v_exp_f32 v44, v44
    v_exp_f32 v45, v45
    v_mfma_f32_32x32x16_bf16 v[100:115], v[32:35], v[80:83], v[100:115]
    v_exp_f32 v46, v46
    v_exp_f32 v47, v47
    v_exp_f32 v48, v48
    v_exp_f32 v49, v49
    v_exp_f32 v50, v50
    v_mfma_f32_32x32x16_bf16 v[60:75], v[20:23], v[16:19], 0
    v_exp_f32 v51, v51
    v_cvt_pk_bf16_f32 v76, v44, v45
    v_cvt_pk_bf16_f32 v77, v46, v47
    v_cvt_pk_bf16_f32 v78, v48, v49
    v_cvt_pk_bf16_f32 v79, v50, v51
    v_exp_f32 v52, v52
    v_exp_f32 v53, v53
    v_exp_f32 v54, v54
    v_mfma_f32_32x32x16_bf16 v[116:131], v[28:31], v[76:79], v[116:131]
    v_exp_f32 v55, v55
    v_exp_f32 v56, v56
    v_exp_f32 v57, v57
    v_exp_f32 v58, v58
    v_exp_f32 v59, v59
    v_cvt_pk_bf16_f32 v80, v52, v53
    v_cvt_pk_bf16_f32 v81, v54, v55
    v_cvt_pk_bf16_f32 v82, v56, v57
    v_cvt_pk_bf16_f32 v83, v58, v59
    v_exp_f32 v60, v60
    v_exp_f32 v61, v61
    v_mfma_f32_32x32x16_bf16 v[116:131], v[32:35], v[80:83], v[116:131]
    v_exp_f32 v62, v62
    v_exp_f32 v63, v63
    v_exp_f32 v64, v64
    v_exp_f32 v65, v65
    v_exp_f32 v66, v66
    s_waitcnt lgkmcnt(0)
    v_mfma_f32_32x32x16_bf16 v[44:59], v[24:27], v[4:7], 0
    v_exp_f32 v67, v67
    v_cvt_pk_bf16_f32 v76, v60, v61
    v_cvt_pk_bf16_f32 v77, v62, v63
    v_cvt_pk_bf16_f32 v78, v64, v65
    v_cvt_pk_bf16_f32 v79, v66, v67
    v_exp_f32 v68, v68
    v_exp_f32 v69, v69
    v_exp_f32 v70, v70
    v_mfma_f32_32x32x16_bf16 v[132:147], v[28:31], v[76:79], v[132:147]
    v_exp_f32 v71, v71
    v_exp_f32 v72, v72
    v_exp_f32 v73, v73
    v_exp_f32 v74, v74
    v_exp_f32 v75, v75
    v_cvt_pk_bf16_f32 v80, v68, v69
    v_cvt_pk_bf16_f32 v81, v70, v71
    v_cvt_pk_bf16_f32 v82, v72, v73
    v_cvt_pk_bf16_f32 v83, v74, v75
    v_exp_f32 v44, v44
    v_exp_f32 v45, v45
    v_mfma_f32_32x32x16_bf16 v[132:147], v[32:35], v[80:83], v[132:147]
    ds_read_b128 v[20:23], v212 offset:24576
    v_exp_f32 v46, v46
    v_exp_f32 v47, v47
    s_mov_b64 exec, s[58:59]
    ds_read_b128 v[28:31], v213 offset:24576
    ds_read_b128 v[32:35], v213 offset:25088
    s_mov_b64 exec, -1
    v_exp_f32 v48, v48
    v_exp_f32 v49, v49
    v_exp_f32 v50, v50
    v_mfma_f32_32x32x16_bf16 v[60:75], v[24:27], v[8:11], 0
    s_add_u32 s65, s64, 14680064
    buffer_store_dwordx4 v[148:151], v2, s[16:19], s65 offen offset:0 sc1
    v_exp_f32 v51, v51
    v_cvt_pk_bf16_f32 v76, v44, v45
    v_cvt_pk_bf16_f32 v77, v46, v47
    v_cvt_pk_bf16_f32 v78, v48, v49
    v_cvt_pk_bf16_f32 v79, v50, v51
    v_exp_f32 v52, v52
    v_exp_f32 v53, v53
    v_exp_f32 v54, v54
    v_mfma_f32_32x32x16_bf16 v[84:99], v[36:39], v[76:79], v[84:99]
    v_exp_f32 v55, v55
    v_exp_f32 v56, v56
    v_exp_f32 v57, v57
    v_exp_f32 v58, v58
    v_exp_f32 v59, v59
    v_cvt_pk_bf16_f32 v80, v52, v53
    v_cvt_pk_bf16_f32 v81, v54, v55
    v_cvt_pk_bf16_f32 v82, v56, v57
    v_cvt_pk_bf16_f32 v83, v58, v59
    v_exp_f32 v60, v60
    v_exp_f32 v61, v61
    v_mfma_f32_32x32x16_bf16 v[84:99], v[40:43], v[80:83], v[84:99]
    v_exp_f32 v62, v62
    v_exp_f32 v63, v63
    v_exp_f32 v64, v64
    v_exp_f32 v65, v65
    v_exp_f32 v66, v66
    v_mfma_f32_32x32x16_bf16 v[44:59], v[24:27], v[12:15], 0
    v_exp_f32 v67, v67
    v_cvt_pk_bf16_f32 v76, v60, v61
    v_cvt_pk_bf16_f32 v77, v62, v63
    v_cvt_pk_bf16_f32 v78, v64, v65
    v_cvt_pk_bf16_f32 v79, v66, v67
    v_exp_f32 v68, v68
    v_exp_f32 v69, v69
    v_exp_f32 v70, v70
    v_mfma_f32_32x32x16_bf16 v[100:115], v[36:39], v[76:79], v[100:115]
    v_exp_f32 v71, v71
    v_exp_f32 v72, v72
    v_exp_f32 v73, v73
    v_exp_f32 v74, v74
    v_exp_f32 v75, v75
    v_cvt_pk_bf16_f32 v80, v68, v69
    v_cvt_pk_bf16_f32 v81, v70, v71
    v_cvt_pk_bf16_f32 v82, v72, v73
    v_cvt_pk_bf16_f32 v83, v74, v75
    v_exp_f32 v44, v44
    v_exp_f32 v45, v45
    v_mfma_f32_32x32x16_bf16 v[100:115], v[40:43], v[80:83], v[100:115]
    v_exp_f32 v46, v46
    v_exp_f32 v47, v47
    v_exp_f32 v48, v48
    v_exp_f32 v49, v49
    v_exp_f32 v50, v50
    v_mfma_f32_32x32x16_bf16 v[60:75], v[24:27], v[16:19], 0
    v_exp_f32 v51, v51
    v_cvt_pk_bf16_f32 v76, v44, v45
    v_cvt_pk_bf16_f32 v77, v46, v47
    v_cvt_pk_bf16_f32 v78, v48, v49
    v_cvt_pk_bf16_f32 v79, v50, v51
    v_exp_f32 v52, v52
    v_exp_f32 v53, v53
    v_exp_f32 v54, v54
    v_mfma_f32_32x32x16_bf16 v[116:131], v[36:39], v[76:79], v[116:131]
    v_exp_f32 v55, v55
    v_exp_f32 v56, v56
    v_exp_f32 v57, v57
    v_exp_f32 v58, v58
    v_exp_f32 v59, v59
    v_cvt_pk_bf16_f32 v80, v52, v53
    v_cvt_pk_bf16_f32 v81, v54, v55
    v_cvt_pk_bf16_f32 v82, v56, v57
    v_cvt_pk_bf16_f32 v83, v58, v59
    v_exp_f32 v60, v60
    v_exp_f32 v61, v61
    v_mfma_f32_32x32x16_bf16 v[116:131], v[40:43], v[80:83], v[116:131]
    v_exp_f32 v62, v62
    v_exp_f32 v63, v63
    v_exp_f32 v64, v64
    v_exp_f32 v65, v65
    v_exp_f32 v66, v66
    s_waitcnt lgkmcnt(0)
    v_mfma_f32_32x32x16_bf16 v[44:59], v[20:23], v[4:7], 0
    s_add_u32 s65, s64, 14680064
    buffer_store_dwordx4 v[148:151], v2, s[16:19], s65 offen offset:1024 sc1
    v_exp_f32 v67, v67
    v_cvt_pk_bf16_f32 v76, v60, v61
    v_cvt_pk_bf16_f32 v77, v62, v63
    v_cvt_pk_bf16_f32 v78, v64, v65
    v_cvt_pk_bf16_f32 v79, v66, v67
    v_exp_f32 v68, v68
    v_exp_f32 v69, v69
    v_exp_f32 v70, v70
    v_mfma_f32_32x32x16_bf16 v[132:147], v[36:39], v[76:79], v[132:147]
    v_exp_f32 v71, v71
    v_exp_f32 v72, v72
    v_exp_f32 v73, v73
    v_exp_f32 v74, v74
    v_exp_f32 v75, v75
    v_cvt_pk_bf16_f32 v80, v68, v69
    v_cvt_pk_bf16_f32 v81, v70, v71
    v_cvt_pk_bf16_f32 v82, v72, v73
    v_cvt_pk_bf16_f32 v83, v74, v75
    v_exp_f32 v44, v44
    v_exp_f32 v45, v45
    v_mfma_f32_32x32x16_bf16 v[132:147], v[40:43], v[80:83], v[132:147]
    ds_read_b128 v[24:27], v212 offset:26624
    v_exp_f32 v46, v46
    v_exp_f32 v47, v47
    s_mov_b64 exec, s[58:59]
    ds_read_b128 v[36:39], v213 offset:26624
    ds_read_b128 v[40:43], v213 offset:27136
    s_mov_b64 exec, -1
    v_exp_f32 v48, v48
    v_exp_f32 v49, v49
    v_exp_f32 v50, v50
    v_mfma_f32_32x32x16_bf16 v[60:75], v[20:23], v[8:11], 0
    v_exp_f32 v51, v51
    v_cvt_pk_bf16_f32 v76, v44, v45
    v_cvt_pk_bf16_f32 v77, v46, v47
    v_cvt_pk_bf16_f32 v78, v48, v49
    v_cvt_pk_bf16_f32 v79, v50, v51
    v_exp_f32 v52, v52
    v_exp_f32 v53, v53
    v_exp_f32 v54, v54
    v_mfma_f32_32x32x16_bf16 v[84:99], v[28:31], v[76:79], v[84:99]
    v_exp_f32 v55, v55
    v_exp_f32 v56, v56
    v_exp_f32 v57, v57
    v_exp_f32 v58, v58
    v_exp_f32 v59, v59
    v_cvt_pk_bf16_f32 v80, v52, v53
    v_cvt_pk_bf16_f32 v81, v54, v55
    v_cvt_pk_bf16_f32 v82, v56, v57
    v_cvt_pk_bf16_f32 v83, v58, v59
    v_exp_f32 v60, v60
    v_exp_f32 v61, v61
    v_mfma_f32_32x32x16_bf16 v[84:99], v[32:35], v[80:83], v[84:99]
    v_exp_f32 v62, v62
    v_exp_f32 v63, v63
    v_exp_f32 v64, v64
    v_exp_f32 v65, v65
    v_exp_f32 v66, v66
    v_mfma_f32_32x32x16_bf16 v[44:59], v[20:23], v[12:15], 0
    v_exp_f32 v67, v67
    v_cvt_pk_bf16_f32 v76, v60, v61
    v_cvt_pk_bf16_f32 v77, v62, v63
    v_cvt_pk_bf16_f32 v78, v64, v65
    v_cvt_pk_bf16_f32 v79, v66, v67
    v_exp_f32 v68, v68
    v_exp_f32 v69, v69
    v_exp_f32 v70, v70
    v_mfma_f32_32x32x16_bf16 v[100:115], v[28:31], v[76:79], v[100:115]
    v_exp_f32 v71, v71
    v_exp_f32 v72, v72
    v_exp_f32 v73, v73
    v_exp_f32 v74, v74
    v_exp_f32 v75, v75
    v_cvt_pk_bf16_f32 v80, v68, v69
    v_cvt_pk_bf16_f32 v81, v70, v71
    v_cvt_pk_bf16_f32 v82, v72, v73
    v_cvt_pk_bf16_f32 v83, v74, v75
    v_exp_f32 v44, v44
    v_exp_f32 v45, v45
    v_mfma_f32_32x32x16_bf16 v[100:115], v[32:35], v[80:83], v[100:115]
    v_exp_f32 v46, v46
    v_exp_f32 v47, v47
    v_exp_f32 v48, v48
    v_exp_f32 v49, v49
    v_exp_f32 v50, v50
    v_mfma_f32_32x32x16_bf16 v[60:75], v[20:23], v[16:19], 0
    buffer_store_dword v148, v152, s[16:19], s66 offen sc1
    v_exp_f32 v51, v51
    v_cvt_pk_bf16_f32 v76, v44, v45
    v_cvt_pk_bf16_f32 v77, v46, v47
    v_cvt_pk_bf16_f32 v78, v48, v49
    v_cvt_pk_bf16_f32 v79, v50, v51
    v_exp_f32 v52, v52
    v_exp_f32 v53, v53
    v_exp_f32 v54, v54
    v_mfma_f32_32x32x16_bf16 v[116:131], v[28:31], v[76:79], v[116:131]
    v_exp_f32 v55, v55
    v_exp_f32 v56, v56
    v_exp_f32 v57, v57
    v_exp_f32 v58, v58
    v_exp_f32 v59, v59
    v_cvt_pk_bf16_f32 v80, v52, v53
    v_cvt_pk_bf16_f32 v81, v54, v55
    v_cvt_pk_bf16_f32 v82, v56, v57
    v_cvt_pk_bf16_f32 v83, v58, v59
    v_exp_f32 v60, v60
    v_exp_f32 v61, v61
    v_mfma_f32_32x32x16_bf16 v[116:131], v[32:35], v[80:83], v[116:131]
    v_exp_f32 v62, v62
    v_exp_f32 v63, v63
    v_exp_f32 v64, v64
    v_exp_f32 v65, v65
    v_exp_f32 v66, v66
    s_waitcnt lgkmcnt(0)
    v_mfma_f32_32x32x16_bf16 v[44:59], v[24:27], v[4:7], 0
    v_exp_f32 v67, v67
    v_cvt_pk_bf16_f32 v76, v60, v61
    v_cvt_pk_bf16_f32 v77, v62, v63
    v_cvt_pk_bf16_f32 v78, v64, v65
    v_cvt_pk_bf16_f32 v79, v66, v67
    v_exp_f32 v68, v68
    v_exp_f32 v69, v69
    v_exp_f32 v70, v70
    v_mfma_f32_32x32x16_bf16 v[132:147], v[28:31], v[76:79], v[132:147]
    v_exp_f32 v71, v71
    v_exp_f32 v72, v72
    v_exp_f32 v73, v73
    v_exp_f32 v74, v74
    v_exp_f32 v75, v75
    v_cvt_pk_bf16_f32 v80, v68, v69
    v_cvt_pk_bf16_f32 v81, v70, v71
    v_cvt_pk_bf16_f32 v82, v72, v73
    v_cvt_pk_bf16_f32 v83, v74, v75
    v_exp_f32 v44, v44
    v_exp_f32 v45, v45
    v_mfma_f32_32x32x16_bf16 v[132:147], v[32:35], v[80:83], v[132:147]
    ds_read_b128 v[20:23], v212 offset:28672
    v_exp_f32 v46, v46
    v_exp_f32 v47, v47
    s_mov_b64 exec, s[58:59]
    ds_read_b128 v[28:31], v213 offset:28672
    ds_read_b128 v[32:35], v213 offset:29184
    s_mov_b64 exec, -1
    v_exp_f32 v48, v48
    v_exp_f32 v49, v49
    v_exp_f32 v50, v50
    v_mfma_f32_32x32x16_bf16 v[60:75], v[24:27], v[8:11], 0
    v_exp_f32 v51, v51
    v_cvt_pk_bf16_f32 v76, v44, v45
    v_cvt_pk_bf16_f32 v77, v46, v47
    v_cvt_pk_bf16_f32 v78, v48, v49
    v_cvt_pk_bf16_f32 v79, v50, v51
    v_exp_f32 v52, v52
    v_exp_f32 v53, v53
    v_exp_f32 v54, v54
    v_mfma_f32_32x32x16_bf16 v[84:99], v[36:39], v[76:79], v[84:99]
    v_exp_f32 v55, v55
    v_exp_f32 v56, v56
    v_exp_f32 v57, v57
    v_exp_f32 v58, v58
    v_exp_f32 v59, v59
    v_cvt_pk_bf16_f32 v80, v52, v53
    v_cvt_pk_bf16_f32 v81, v54, v55
    v_cvt_pk_bf16_f32 v82, v56, v57
    v_cvt_pk_bf16_f32 v83, v58, v59
    v_exp_f32 v60, v60
    v_exp_f32 v61, v61
    v_mfma_f32_32x32x16_bf16 v[84:99], v[40:43], v[80:83], v[84:99]
    v_exp_f32 v62, v62
    v_exp_f32 v63, v63
    v_exp_f32 v64, v64
    v_exp_f32 v65, v65
    v_exp_f32 v66, v66
    v_mfma_f32_32x32x16_bf16 v[44:59], v[24:27], v[12:15], 0
    v_exp_f32 v67, v67
    v_cvt_pk_bf16_f32 v76, v60, v61
    v_cvt_pk_bf16_f32 v77, v62, v63
    v_cvt_pk_bf16_f32 v78, v64, v65
    v_cvt_pk_bf16_f32 v79, v66, v67
    v_exp_f32 v68, v68
    v_exp_f32 v69, v69
    v_exp_f32 v70, v70
    v_mfma_f32_32x32x16_bf16 v[100:115], v[36:39], v[76:79], v[100:115]
    v_exp_f32 v71, v71
    v_exp_f32 v72, v72
    v_exp_f32 v73, v73
    v_exp_f32 v74, v74
    v_exp_f32 v75, v75
    v_cvt_pk_bf16_f32 v80, v68, v69
    v_cvt_pk_bf16_f32 v81, v70, v71
    v_cvt_pk_bf16_f32 v82, v72, v73
    v_cvt_pk_bf16_f32 v83, v74, v75
    v_exp_f32 v44, v44
    v_exp_f32 v45, v45
    v_mfma_f32_32x32x16_bf16 v[100:115], v[40:43], v[80:83], v[100:115]
    v_exp_f32 v46, v46
    v_exp_f32 v47, v47
    v_exp_f32 v48, v48
    v_exp_f32 v49, v49
    v_exp_f32 v50, v50
    v_mfma_f32_32x32x16_bf16 v[60:75], v[24:27], v[16:19], 0
    v_exp_f32 v51, v51
    v_cvt_pk_bf16_f32 v76, v44, v45
    v_cvt_pk_bf16_f32 v77, v46, v47
    v_cvt_pk_bf16_f32 v78, v48, v49
    v_cvt_pk_bf16_f32 v79, v50, v51
    v_exp_f32 v52, v52
    v_exp_f32 v53, v53
    v_exp_f32 v54, v54
    v_mfma_f32_32x32x16_bf16 v[116:131], v[36:39], v[76:79], v[116:131]
    v_exp_f32 v55, v55
    v_exp_f32 v56, v56
    v_exp_f32 v57, v57
    v_exp_f32 v58, v58
    v_exp_f32 v59, v59
    v_cvt_pk_bf16_f32 v80, v52, v53
    v_cvt_pk_bf16_f32 v81, v54, v55
    v_cvt_pk_bf16_f32 v82, v56, v57
    v_cvt_pk_bf16_f32 v83, v58, v59
    v_exp_f32 v60, v60
    v_exp_f32 v61, v61
    v_mfma_f32_32x32x16_bf16 v[116:131], v[40:43], v[80:83], v[116:131]
    v_exp_f32 v62, v62
    v_exp_f32 v63, v63
    v_exp_f32 v64, v64
    v_exp_f32 v65, v65
    v_exp_f32 v66, v66
    s_waitcnt lgkmcnt(0)
    v_mfma_f32_32x32x16_bf16 v[44:59], v[20:23], v[4:7], 0
    v_exp_f32 v67, v67
    v_cvt_pk_bf16_f32 v76, v60, v61
    v_cvt_pk_bf16_f32 v77, v62, v63
    v_cvt_pk_bf16_f32 v78, v64, v65
    v_cvt_pk_bf16_f32 v79, v66, v67
    v_exp_f32 v68, v68
    v_exp_f32 v69, v69
    v_exp_f32 v70, v70
    v_mfma_f32_32x32x16_bf16 v[132:147], v[36:39], v[76:79], v[132:147]
    v_exp_f32 v71, v71
    v_exp_f32 v72, v72
    v_exp_f32 v73, v73
    v_exp_f32 v74, v74
    v_exp_f32 v75, v75
    v_cvt_pk_bf16_f32 v80, v68, v69
    v_cvt_pk_bf16_f32 v81, v70, v71
    v_cvt_pk_bf16_f32 v82, v72, v73
    v_cvt_pk_bf16_f32 v83, v74, v75
    v_exp_f32 v44, v44
    v_exp_f32 v45, v45
    v_mfma_f32_32x32x16_bf16 v[132:147], v[40:43], v[80:83], v[132:147]
    ds_read_b128 v[24:27], v212 offset:30720
    v_exp_f32 v46, v46
    v_exp_f32 v47, v47
    s_mov_b64 exec, s[58:59]
    ds_read_b128 v[36:39], v213 offset:30720
    ds_read_b128 v[40:43], v213 offset:31232
    s_mov_b64 exec, -1
    v_exp_f32 v48, v48
    v_exp_f32 v49, v49
    v_exp_f32 v50, v50
    v_mfma_f32_32x32x16_bf16 v[60:75], v[20:23], v[8:11], 0
    v_exp_f32 v51, v51
    v_cvt_pk_bf16_f32 v76, v44, v45
    v_cvt_pk_bf16_f32 v77, v46, v47
    v_cvt_pk_bf16_f32 v78, v48, v49
    v_cvt_pk_bf16_f32 v79, v50, v51
    v_exp_f32 v52, v52
    v_exp_f32 v53, v53
    v_exp_f32 v54, v54
    v_mfma_f32_32x32x16_bf16 v[84:99], v[28:31], v[76:79], v[84:99]
    v_exp_f32 v55, v55
    v_exp_f32 v56, v56
    v_exp_f32 v57, v57
    v_exp_f32 v58, v58
    v_exp_f32 v59, v59
    v_cvt_pk_bf16_f32 v80, v52, v53
    v_cvt_pk_bf16_f32 v81, v54, v55
    v_cvt_pk_bf16_f32 v82, v56, v57
    v_cvt_pk_bf16_f32 v83, v58, v59
    v_exp_f32 v60, v60
    v_exp_f32 v61, v61
    v_mfma_f32_32x32x16_bf16 v[84:99], v[32:35], v[80:83], v[84:99]
    v_exp_f32 v62, v62
    v_exp_f32 v63, v63
    v_exp_f32 v64, v64
    v_exp_f32 v65, v65
    v_exp_f32 v66, v66
    v_mfma_f32_32x32x16_bf16 v[44:59], v[20:23], v[12:15], 0
    v_exp_f32 v67, v67
    v_cvt_pk_bf16_f32 v76, v60, v61
    v_cvt_pk_bf16_f32 v77, v62, v63
    v_cvt_pk_bf16_f32 v78, v64, v65
    v_cvt_pk_bf16_f32 v79, v66, v67
    v_exp_f32 v68, v68
    v_exp_f32 v69, v69
    v_exp_f32 v70, v70
    v_mfma_f32_32x32x16_bf16 v[100:115], v[28:31], v[76:79], v[100:115]
    v_exp_f32 v71, v71
    v_exp_f32 v72, v72
    v_exp_f32 v73, v73
    v_exp_f32 v74, v74
    v_exp_f32 v75, v75
    v_cvt_pk_bf16_f32 v80, v68, v69
    v_cvt_pk_bf16_f32 v81, v70, v71
    v_cvt_pk_bf16_f32 v82, v72, v73
    v_cvt_pk_bf16_f32 v83, v74, v75
    v_exp_f32 v44, v44
    v_exp_f32 v45, v45
    v_mfma_f32_32x32x16_bf16 v[100:115], v[32:35], v[80:83], v[100:115]
    v_exp_f32 v46, v46
    v_exp_f32 v47, v47
    v_exp_f32 v48, v48
    v_exp_f32 v49, v49
    v_exp_f32 v50, v50
    v_mfma_f32_32x32x16_bf16 v[60:75], v[20:23], v[16:19], 0
    v_exp_f32 v51, v51
    v_cvt_pk_bf16_f32 v76, v44, v45
    v_cvt_pk_bf16_f32 v77, v46, v47
    v_cvt_pk_bf16_f32 v78, v48, v49
    v_cvt_pk_bf16_f32 v79, v50, v51
    v_exp_f32 v52, v52
    v_exp_f32 v53, v53
    v_exp_f32 v54, v54
    v_mfma_f32_32x32x16_bf16 v[116:131], v[28:31], v[76:79], v[116:131]
    v_exp_f32 v55, v55
    v_exp_f32 v56, v56
    v_exp_f32 v57, v57
    v_exp_f32 v58, v58
    v_exp_f32 v59, v59
    v_cvt_pk_bf16_f32 v80, v52, v53
    v_cvt_pk_bf16_f32 v81, v54, v55
    v_cvt_pk_bf16_f32 v82, v56, v57
    v_cvt_pk_bf16_f32 v83, v58, v59
    v_exp_f32 v60, v60
    v_exp_f32 v61, v61
    v_mfma_f32_32x32x16_bf16 v[116:131], v[32:35], v[80:83], v[116:131]
    v_exp_f32 v62, v62
    v_exp_f32 v63, v63
    v_exp_f32 v64, v64
    v_exp_f32 v65, v65
    v_exp_f32 v66, v66
    s_waitcnt lgkmcnt(0)
    v_mfma_f32_32x32x16_bf16 v[44:59], v[24:27], v[4:7], 0
    v_exp_f32 v67, v67
    v_cvt_pk_bf16_f32 v76, v60, v61
    v_cvt_pk_bf16_f32 v77, v62, v63
    v_cvt_pk_bf16_f32 v78, v64, v65
    v_cvt_pk_bf16_f32 v79, v66, v67
    v_exp_f32 v68, v68
    v_exp_f32 v69, v69
    v_exp_f32 v70, v70
    v_mfma_f32_32x32x16_bf16 v[132:147], v[28:31], v[76:79], v[132:147]
    v_exp_f32 v71, v71
    v_exp_f32 v72, v72
    v_exp_f32 v73, v73
    v_exp_f32 v74, v74
    v_exp_f32 v75, v75
    v_cvt_pk_bf16_f32 v80, v68, v69
    v_cvt_pk_bf16_f32 v81, v70, v71
    v_cvt_pk_bf16_f32 v82, v72, v73
    v_cvt_pk_bf16_f32 v83, v74, v75
    s_waitcnt vmcnt(0)
    s_barrier
    s_cmp_lg_u32 s22, 0
    s_cbranch_scc1 L_fa1
    s_and_b32 s65, s2, 15
    s_lshl_b32 s65, s65, 8
    s_add_u32 s65, s65, 6361088
    v_mov_b32 v153, 0
    v_mov_b32 v154, 1
    s_mov_b64 exec, 1
    buffer_atomic_add v154, v153, s[16:19], s65 offen sc1
    s_mov_b64 exec, -1
L_fa1:
    v_exp_f32 v44, v44
    v_exp_f32 v45, v45
    v_mfma_f32_32x32x16_bf16 v[132:147], v[32:35], v[80:83], v[132:147]
    ds_read_b128 v[20:23], v212 offset:32768
    v_exp_f32 v46, v46
    v_exp_f32 v47, v47
    s_mov_b64 exec, s[58:59]
    ds_read_b128 v[28:31], v213 offset:32768
    ds_read_b128 v[32:35], v213 offset:33280
    s_mov_b64 exec, -1
    v_exp_f32 v48, v48
    v_exp_f32 v49, v49
    v_exp_f32 v50, v50
    v_mfma_f32_32x32x16_bf16 v[60:75], v[24:27], v[8:11], 0
    v_exp_f32 v51, v51
    v_cvt_pk_bf16_f32 v76, v44, v45
    v_cvt_pk_bf16_f32 v77, v46, v47
    v_cvt_pk_bf16_f32 v78, v48, v49
    v_cvt_pk_bf16_f32 v79, v50, v51
    v_exp_f32 v52, v52
    v_exp_f32 v53, v53
    v_exp_f32 v54, v54
    v_mfma_f32_32x32x16_bf16 v[84:99], v[36:39], v[76:79], v[84:99]
    v_exp_f32 v55, v55
    v_exp_f32 v56, v56
    v_exp_f32 v57, v57
    v_exp_f32 v58, v58
    v_exp_f32 v59, v59
    v_cvt_pk_bf16_f32 v80, v52, v53
    v_cvt_pk_bf16_f32 v81, v54, v55
    v_cvt_pk_bf16_f32 v82, v56, v57
    v_cvt_pk_bf16_f32 v83, v58, v59
    v_exp_f32 v60, v60
    v_exp_f32 v61, v61
    v_mfma_f32_32x32x16_bf16 v[84:99], v[40:43], v[80:83], v[84:99]
    v_exp_f32 v62, v62
    v_exp_f32 v63, v63
    v_exp_f32 v64, v64
    v_exp_f32 v65, v65
    v_exp_f32 v66, v66
    v_mfma_f32_32x32x16_bf16 v[44:59], v[24:27], v[12:15], 0
    v_exp_f32 v67, v67
    v_cvt_pk_bf16_f32 v76, v60, v61
    v_cvt_pk_bf16_f32 v77, v62, v63
    v_cvt_pk_bf16_f32 v78, v64, v65
    v_cvt_pk_bf16_f32 v79, v66, v67
    v_exp_f32 v68, v68
    v_exp_f32 v69, v69
    v_exp_f32 v70, v70
    v_mfma_f32_32x32x16_bf16 v[100:115], v[36:39], v[76:79], v[100:115]
    v_exp_f32 v71, v71
    v_exp_f32 v72, v72
    v_exp_f32 v73, v73
    v_exp_f32 v74, v74
    v_exp_f32 v75, v75
    v_cvt_pk_bf16_f32 v80, v68, v69
    v_cvt_pk_bf16_f32 v81, v70, v71
    v_cvt_pk_bf16_f32 v82, v72, v73
    v_cvt_pk_bf16_f32 v83, v74, v75
    v_exp_f32 v44, v44
    v_exp_f32 v45, v45
    v_mfma_f32_32x32x16_bf16 v[100:115], v[40:43], v[80:83], v[100:115]
    v_exp_f32 v46, v46
    v_exp_f32 v47, v47
    v_exp_f32 v48, v48
    v_exp_f32 v49, v49
    v_exp_f32 v50, v50
    v_mfma_f32_32x32x16_bf16 v[60:75], v[24:27], v[16:19], 0
    v_exp_f32 v51, v51
    v_cvt_pk_bf16_f32 v76, v44, v45
    v_cvt_pk_bf16_f32 v77, v46, v47
    v_cvt_pk_bf16_f32 v78, v48, v49
    v_cvt_pk_bf16_f32 v79, v50, v51
    v_exp_f32 v52, v52
    v_exp_f32 v53, v53
    v_exp_f32 v54, v54
    v_mfma_f32_32x32x16_bf16 v[116:131], v[36:39], v[76:79], v[116:131]
    v_exp_f32 v55, v55
    v_exp_f32 v56, v56
    v_exp_f32 v57, v57
    v_exp_f32 v58, v58
    v_exp_f32 v59, v59
    v_cvt_pk_bf16_f32 v80, v52, v53
    v_cvt_pk_bf16_f32 v81, v54, v55
    v_cvt_pk_bf16_f32 v82, v56, v57
    v_cvt_pk_bf16_f32 v83, v58, v59
    v_exp_f32 v60, v60
    v_exp_f32 v61, v61
    v_mfma_f32_32x32x16_bf16 v[116:131], v[40:43], v[80:83], v[116:131]
    v_exp_f32 v62, v62
    v_exp_f32 v63, v63
    v_exp_f32 v64, v64
    v_exp_f32 v65, v65
    v_exp_f32 v66, v66
    s_waitcnt lgkmcnt(0)
    v_mfma_f32_32x32x16_bf16 v[44:59], v[20:23], v[4:7], 0
    v_exp_f32 v67, v67
    v_cvt_pk_bf16_f32 v76, v60, v61
    v_cvt_pk_bf16_f32 v77, v62, v63
    v_cvt_pk_bf16_f32 v78, v64, v65
    v_cvt_pk_bf16_f32 v79, v66, v67
    v_exp_f32 v68, v68
    v_exp_f32 v69, v69
    v_exp_f32 v70, v70
    v_mfma_f32_32x32x16_bf16 v[132:147], v[36:39], v[76:79], v[132:147]
    v_exp_f32 v71, v71
    v_exp_f32 v72, v72
    v_exp_f32 v73, v73
    v_exp_f32 v74, v74
    v_exp_f32 v75, v75
    v_cvt_pk_bf16_f32 v80, v68, v69
    v_cvt_pk_bf16_f32 v81, v70, v71
    v_cvt_pk_bf16_f32 v82, v72, v73
    v_cvt_pk_bf16_f32 v83, v74, v75
    v_exp_f32 v44, v44
    v_exp_f32 v45, v45
    v_mfma_f32_32x32x16_bf16 v[132:147], v[40:43], v[80:83], v[132:147]
    ds_read_b128 v[24:27], v212 offset:34816
    v_exp_f32 v46, v46
    v_exp_f32 v47, v47
    s_mov_b64 exec, s[58:59]
    ds_read_b128 v[36:39], v213 offset:34816
    ds_read_b128 v[40:43], v213 offset:35328
    s_mov_b64 exec, -1
    v_exp_f32 v48, v48
    v_exp_f32 v49, v49
    v_exp_f32 v50, v50
    v_mfma_f32_32x32x16_bf16 v[60:75], v[20:23], v[8:11], 0
    v_exp_f32 v51, v51
    v_cvt_pk_bf16_f32 v76, v44, v45
    v_cvt_pk_bf16_f32 v77, v46, v47
    v_cvt_pk_bf16_f32 v78, v48, v49
    v_cvt_pk_bf16_f32 v79, v50, v51
    v_exp_f32 v52, v52
    v_exp_f32 v53, v53
    v_exp_f32 v54, v54
    v_mfma_f32_32x32x16_bf16 v[84:99], v[28:31], v[76:79], v[84:99]
    v_exp_f32 v55, v55
    v_exp_f32 v56, v56
    v_exp_f32 v57, v57
    v_exp_f32 v58, v58
    v_exp_f32 v59, v59
    v_cvt_pk_bf16_f32 v80, v52, v53
    v_cvt_pk_bf16_f32 v81, v54, v55
    v_cvt_pk_bf16_f32 v82, v56, v57
    v_cvt_pk_bf16_f32 v83, v58, v59
    v_exp_f32 v60, v60
    v_exp_f32 v61, v61
    v_mfma_f32_32x32x16_bf16 v[84:99], v[32:35], v[80:83], v[84:99]
    v_exp_f32 v62, v62
    v_exp_f32 v63, v63
    v_exp_f32 v64, v64
    v_exp_f32 v65, v65
    v_exp_f32 v66, v66
    v_mfma_f32_32x32x16_bf16 v[44:59], v[20:23], v[12:15], 0
    s_add_u32 m0, s38, 0
    s_add_u32 s28, s37, 0
    buffer_load_dwordx4 v218, s[4:7], s28 offen offset:0 lds
    v_exp_f32 v67, v67
    v_cvt_pk_bf16_f32 v76, v60, v61
    v_cvt_pk_bf16_f32 v77, v62, v63
    v_cvt_pk_bf16_f32 v78, v64, v65
    v_cvt_pk_bf16_f32 v79, v66, v67
    v_exp_f32 v68, v68
    v_exp_f32 v69, v69
    v_exp_f32 v70, v70
    v_mfma_f32_32x32x16_bf16 v[100:115], v[28:31], v[76:79], v[100:115]
    v_exp_f32 v71, v71
    v_exp_f32 v72, v72
    v_exp_f32 v73, v73
    v_exp_f32 v74, v74
    v_exp_f32 v75, v75
    v_cvt_pk_bf16_f32 v80, v68, v69
    v_cvt_pk_bf16_f32 v81, v70, v71
    v_cvt_pk_bf16_f32 v82, v72, v73
    v_cvt_pk_bf16_f32 v83, v74, v75
    v_exp_f32 v44, v44
    v_exp_f32 v45, v45
    v_mfma_f32_32x32x16_bf16 v[100:115], v[32:35], v[80:83], v[100:115]
    v_exp_f32 v46, v46
    v_exp_f32 v47, v47
    v_exp_f32 v48, v48
    v_exp_f32 v49, v49
    v_exp_f32 v50, v50
    v_mfma_f32_32x32x16_bf16 v[60:75], v[20:23], v[16:19], 0
    buffer_load_dwordx4 v219, s[4:7], s28 offen offset:1024 lds
    v_exp_f32 v51, v51
    v_cvt_pk_bf16_f32 v76, v44, v45
    v_cvt_pk_bf16_f32 v77, v46, v47
    v_cvt_pk_bf16_f32 v78, v48, v49
    v_cvt_pk_bf16_f32 v79, v50, v51
    v_exp_f32 v52, v52
    v_exp_f32 v53, v53
    v_exp_f32 v54, v54
    v_mfma_f32_32x32x16_bf16 v[116:131], v[28:31], v[76:79], v[116:131]
    v_exp_f32 v55, v55
    v_exp_f32 v56, v56
    v_exp_f32 v57, v57
    v_exp_f32 v58, v58
    v_exp_f32 v59, v59
    v_cvt_pk_bf16_f32 v80, v52, v53
    v_cvt_pk_bf16_f32 v81, v54, v55
    v_cvt_pk_bf16_f32 v82, v56, v57
    v_cvt_pk_bf16_f32 v83, v58, v59
    v_exp_f32 v60, v60
    v_exp_f32 v61, v61
    v_mfma_f32_32x32x16_bf16 v[116:131], v[32:35], v[80:83], v[116:131]
    v_exp_f32 v62, v62
    v_exp_f32 v63, v63
    v_exp_f32 v64, v64
    v_exp_f32 v65, v65
    v_exp_f32 v66, v66
    s_waitcnt lgkmcnt(0)
    v_mfma_f32_32x32x16_bf16 v[44:59], v[24:27], v[4:7], 0
    buffer_load_dwordx4 v220, s[4:7], s28 offen offset:2048 lds
    v_exp_f32 v67, v67
    v_cvt_pk_bf16_f32 v76, v60, v61
    v_cvt_pk_bf16_f32 v77, v62, v63
    v_cvt_pk_bf16_f32 v78, v64, v65
    v_cvt_pk_bf16_f32 v79, v66, v67
    v_exp_f32 v68, v68
    v_exp_f32 v69, v69
    v_exp_f32 v70, v70
    v_mfma_f32_32x32x16_bf16 v[132:147], v[28:31], v[76:79], v[132:147]
    v_exp_f32 v71, v71
    v_exp_f32 v72, v72
    v_exp_f32 v73, v73
    v_exp_f32 v74, v74
    v_exp_f32 v75, v75
    v_cvt_pk_bf16_f32 v80, v68, v69
    v_cvt_pk_bf16_f32 v81, v70, v71
    v_cvt_pk_bf16_f32 v82, v72, v73
    v_cvt_pk_bf16_f32 v83, v74, v75
    v_exp_f32 v44, v44
    v_exp_f32 v45, v45
    v_mfma_f32_32x32x16_bf16 v[132:147], v[32:35], v[80:83], v[132:147]
    ds_read_b128 v[20:23], v212 offset:36864
    v_exp_f32 v46, v46
    v_exp_f32 v47, v47
    s_mov_b64 exec, s[58:59]
    ds_read_b128 v[28:31], v213 offset:36864
    ds_read_b128 v[32:35], v213 offset:37376
    s_mov_b64 exec, -1
    v_exp_f32 v48, v48
    v_exp_f32 v49, v49
    v_exp_f32 v50, v50
    v_mfma_f32_32x32x16_bf16 v[60:75], v[24:27], v[8:11], 0
    v_exp_f32 v51, v51
    v_cvt_pk_bf16_f32 v76, v44, v45
    v_cvt_pk_bf16_f32 v77, v46, v47
    v_cvt_pk_bf16_f32 v78, v48, v49
    v_cvt_pk_bf16_f32 v79, v50, v51
    v_exp_f32 v52, v52
    v_exp_f32 v53, v53
    v_exp_f32 v54, v54
    v_mfma_f32_32x32x16_bf16 v[84:99], v[36:39], v[76:79], v[84:99]
    v_exp_f32 v55, v55
    v_exp_f32 v56, v56
    v_exp_f32 v57, v57
    v_exp_f32 v58, v58
    v_exp_f32 v59, v59
    v_cvt_pk_bf16_f32 v80, v52, v53
    v_cvt_pk_bf16_f32 v81, v54, v55
    v_cvt_pk_bf16_f32 v82, v56, v57
    v_cvt_pk_bf16_f32 v83, v58, v59
    v_exp_f32 v60, v60
    v_exp_f32 v61, v61
    v_mfma_f32_32x32x16_bf16 v[84:99], v[40:43], v[80:83], v[84:99]
    v_exp_f32 v62, v62
    v_exp_f32 v63, v63
    v_exp_f32 v64, v64
    v_exp_f32 v65, v65
    v_exp_f32 v66, v66
    v_mfma_f32_32x32x16_bf16 v[44:59], v[24:27], v[12:15], 0
    buffer_load_dwordx4 v221, s[4:7], s28 offen offset:3072 lds
    v_exp_f32 v67, v67
    v_cvt_pk_bf16_f32 v76, v60, v61
    v_cvt_pk_bf16_f32 v77, v62, v63
    v_cvt_pk_bf16_f32 v78, v64, v65
    v_cvt_pk_bf16_f32 v79, v66, v67
    v_exp_f32 v68, v68
    v_exp_f32 v69, v69
    v_exp_f32 v70, v70
    v_mfma_f32_32x32x16_bf16 v[100:115], v[36:39], v[76:79], v[100:115]
    v_exp_f32 v71, v71
    v_exp_f32 v72, v72
    v_exp_f32 v73, v73
    v_exp_f32 v74, v74
    v_exp_f32 v75, v75
    v_cvt_pk_bf16_f32 v80, v68, v69
    v_cvt_pk_bf16_f32 v81, v70, v71
    v_cvt_pk_bf16_f32 v82, v72, v73
    v_cvt_pk_bf16_f32 v83, v74, v75
    v_exp_f32 v44, v44
    v_exp_f32 v45, v45
    v_mfma_f32_32x32x16_bf16 v[100:115], v[40:43], v[80:83], v[100:115]
    v_exp_f32 v46, v46
    v_exp_f32 v47, v47
    v_exp_f32 v48, v48
    v_exp_f32 v49, v49
    v_exp_f32 v50, v50
    v_mfma_f32_32x32x16_bf16 v[60:75], v[24:27], v[16:19], 0
    s_add_u32 m0, s38, 8192
    s_add_u32 s28, s37, 65536
    buffer_load_dwordx4 v218, s[4:7], s28 offen offset:0 lds
    v_exp_f32 v51, v51
    v_cvt_pk_bf16_f32 v76, v44, v45
    v_cvt_pk_bf16_f32 v77, v46, v47
    v_cvt_pk_bf16_f32 v78, v48, v49
    v_cvt_pk_bf16_f32 v79, v50, v51
    v_exp_f32 v52, v52
    v_exp_f32 v53, v53
    v_exp_f32 v54, v54
    v_mfma_f32_32x32x16_bf16 v[116:131], v[36:39], v[76:79], v[116:131]
    v_exp_f32 v55, v55
    v_exp_f32 v56, v56
    v_exp_f32 v57, v57
    v_exp_f32 v58, v58
    v_exp_f32 v59, v59
    v_cvt_pk_bf16_f32 v80, v52, v53
    v_cvt_pk_bf16_f32 v81, v54, v55
    v_cvt_pk_bf16_f32 v82, v56, v57
    v_cvt_pk_bf16_f32 v83, v58, v59
    v_exp_f32 v60, v60
    v_exp_f32 v61, v61
    v_mfma_f32_32x32x16_bf16 v[116:131], v[40:43], v[80:83], v[116:131]
    v_exp_f32 v62, v62
    v_exp_f32 v63, v63
    v_exp_f32 v64, v64
    v_exp_f32 v65, v65
    v_exp_f32 v66, v66
    s_waitcnt lgkmcnt(0)
    v_mfma_f32_32x32x16_bf16 v[44:59], v[20:23], v[4:7], 0
    buffer_load_dwordx4 v219, s[4:7], s28 offen offset:1024 lds
    v_exp_f32 v67, v67
    v_cvt_pk_bf16_f32 v76, v60, v61
    v_cvt_pk_bf16_f32 v77, v62, v63
    v_cvt_pk_bf16_f32 v78, v64, v65
    v_cvt_pk_bf16_f32 v79, v66, v67
    v_exp_f32 v68, v68
    v_exp_f32 v69, v69
    v_exp_f32 v70, v70
    v_mfma_f32_32x32x16_bf16 v[132:147], v[36:39], v[76:79], v[132:147]
    v_exp_f32 v71, v71
    v_exp_f32 v72, v72
    v_exp_f32 v73, v73
    v_exp_f32 v74, v74
    v_exp_f32 v75, v75
    v_cvt_pk_bf16_f32 v80, v68, v69
    v_cvt_pk_bf16_f32 v81, v70, v71
    v_cvt_pk_bf16_f32 v82, v72, v73
    v_cvt_pk_bf16_f32 v83, v74, v75
    v_exp_f32 v44, v44
    v_exp_f32 v45, v45
    v_mfma_f32_32x32x16_bf16 v[132:147], v[40:43], v[80:83], v[132:147]
    ds_read_b128 v[24:27], v212 offset:38912
    v_exp_f32 v46, v46
    v_exp_f32 v47, v47
    s_mov_b64 exec, s[58:59]
    ds_read_b128 v[36:39], v213 offset:38912
    ds_read_b128 v[40:43], v213 offset:39424
    s_mov_b64 exec, -1
    v_exp_f32 v48, v48
    v_exp_f32 v49, v49
    v_exp_f32 v50, v50
    v_mfma_f32_32x32x16_bf16 v[60:75], v[20:23], v[8:11], 0
    v_exp_f32 v51, v51
    v_cvt_pk_bf16_f32 v76, v44, v45
    v_cvt_pk_bf16_f32 v77, v46, v47
    v_cvt_pk_bf16_f32 v78, v48, v49
    v_cvt_pk_bf16_f32 v79, v50, v51
    v_exp_f32 v52, v52
    v_exp_f32 v53, v53
    v_exp_f32 v54, v54
    v_mfma_f32_32x32x16_bf16 v[84:99], v[28:31], v[76:79], v[84:99]
    v_exp_f32 v55, v55
    v_exp_f32 v56, v56
    v_exp_f32 v57, v57
    v_exp_f32 v58, v58
    v_exp_f32 v59, v59
    v_cvt_pk_bf16_f32 v80, v52, v53
    v_cvt_pk_bf16_f32 v81, v54, v55
    v_cvt_pk_bf16_f32 v82, v56, v57
    v_cvt_pk_bf16_f32 v83, v58, v59
    v_exp_f32 v60, v60
    v_exp_f32 v61, v61
    v_mfma_f32_32x32x16_bf16 v[84:99], v[32:35], v[80:83], v[84:99]
    v_exp_f32 v62, v62
    v_exp_f32 v63, v63
    v_exp_f32 v64, v64
    v_exp_f32 v65, v65
    v_exp_f32 v66, v66
    v_mfma_f32_32x32x16_bf16 v[44:59], v[20:23], v[12:15], 0
    buffer_load_dwordx4 v220, s[4:7], s28 offen offset:2048 lds
    v_exp_f32 v67, v67
    v_cvt_pk_bf16_f32 v76, v60, v61
    v_cvt_pk_bf16_f32 v77, v62, v63
    v_cvt_pk_bf16_f32 v78, v64, v65
    v_cvt_pk_bf16_f32 v79, v66, v67
    v_exp_f32 v68, v68
    v_exp_f32 v69, v69
    v_exp_f32 v70, v70
    v_mfma_f32_32x32x16_bf16 v[100:115], v[28:31], v[76:79], v[100:115]
    v_exp_f32 v71, v71
    v_exp_f32 v72, v72
    v_exp_f32 v73, v73
    v_exp_f32 v74, v74
    v_exp_f32 v75, v75
    v_cvt_pk_bf16_f32 v80, v68, v69
    v_cvt_pk_bf16_f32 v81, v70, v71
    v_cvt_pk_bf16_f32 v82, v72, v73
    v_cvt_pk_bf16_f32 v83, v74, v75
    v_exp_f32 v44, v44
    v_exp_f32 v45, v45
    v_mfma_f32_32x32x16_bf16 v[100:115], v[32:35], v[80:83], v[100:115]
    v_exp_f32 v46, v46
    v_exp_f32 v47, v47
    v_exp_f32 v48, v48
    v_exp_f32 v49, v49
    v_exp_f32 v50, v50
    v_mfma_f32_32x32x16_bf16 v[60:75], v[20:23], v[16:19], 0
    buffer_load_dwordx4 v221, s[4:7], s28 offen offset:3072 lds
    v_exp_f32 v51, v51
    v_cvt_pk_bf16_f32 v76, v44, v45
    v_cvt_pk_bf16_f32 v77, v46, v47
    v_cvt_pk_bf16_f32 v78, v48, v49
    v_cvt_pk_bf16_f32 v79, v50, v51
    v_exp_f32 v52, v52
    v_exp_f32 v53, v53
    v_exp_f32 v54, v54
    v_mfma_f32_32x32x16_bf16 v[116:131], v[28:31], v[76:79], v[116:131]
    v_exp_f32 v55, v55
    v_exp_f32 v56, v56
    v_exp_f32 v57, v57
    v_exp_f32 v58, v58
    v_exp_f32 v59, v59
    v_cvt_pk_bf16_f32 v80, v52, v53
    v_cvt_pk_bf16_f32 v81, v54, v55
    v_cvt_pk_bf16_f32 v82, v56, v57
    v_cvt_pk_bf16_f32 v83, v58, v59
    v_exp_f32 v60, v60
    v_exp_f32 v61, v61
    v_mfma_f32_32x32x16_bf16 v[116:131], v[32:35], v[80:83], v[116:131]
    v_exp_f32 v62, v62
    v_exp_f32 v63, v63
    v_exp_f32 v64, v64
    v_exp_f32 v65, v65
    v_exp_f32 v66, v66
    s_waitcnt lgkmcnt(0)
    v_mfma_f32_32x32x16_bf16 v[44:59], v[24:27], v[4:7], 0
    s_add_u32 m0, s38, 16384
    s_add_u32 s28, s37, 131072
    buffer_load_dwordx4 v218, s[4:7], s28 offen offset:0 lds
    v_exp_f32 v67, v67
    v_cvt_pk_bf16_f32 v76, v60, v61
    v_cvt_pk_bf16_f32 v77, v62, v63
    v_cvt_pk_bf16_f32 v78, v64, v65
    v_cvt_pk_bf16_f32 v79, v66, v67
    v_exp_f32 v68, v68
    v_exp_f32 v69, v69
    v_exp_f32 v70, v70
    v_mfma_f32_32x32x16_bf16 v[132:147], v[28:31], v[76:79], v[132:147]
    v_exp_f32 v71, v71
    v_exp_f32 v72, v72
    v_exp_f32 v73, v73
    v_exp_f32 v74, v74
    v_exp_f32 v75, v75
    v_cvt_pk_bf16_f32 v80, v68, v69
    v_cvt_pk_bf16_f32 v81, v70, v71
    v_cvt_pk_bf16_f32 v82, v72, v73
    v_cvt_pk_bf16_f32 v83, v74, v75
    v_exp_f32 v44, v44
    v_exp_f32 v45, v45
    v_mfma_f32_32x32x16_bf16 v[132:147], v[32:35], v[80:83], v[132:147]
    ds_read_b128 v[20:23], v212 offset:40960
    v_exp_f32 v46, v46
    v_exp_f32 v47, v47
    s_mov_b64 exec, s[58:59]
    ds_read_b128 v[28:31], v213 offset:40960
    ds_read_b128 v[32:35], v213 offset:41472
    s_mov_b64 exec, -1
    v_exp_f32 v48, v48
    v_exp_f32 v49, v49
    v_exp_f32 v50, v50
    v_mfma_f32_32x32x16_bf16 v[60:75], v[24:27], v[8:11], 0
    v_exp_f32 v51, v51
    v_cvt_pk_bf16_f32 v76, v44, v45
    v_cvt_pk_bf16_f32 v77, v46, v47
    v_cvt_pk_bf16_f32 v78, v48, v49
    v_cvt_pk_bf16_f32 v79, v50, v51
    v_exp_f32 v52, v52
    v_exp_f32 v53, v53
    v_exp_f32 v54, v54
    v_mfma_f32_32x32x16_bf16 v[84:99], v[36:39], v[76:79], v[84:99]
    v_exp_f32 v55, v55
    v_exp_f32 v56, v56
    v_exp_f32 v57, v57
    v_exp_f32 v58, v58
    v_exp_f32 v59, v59
    v_cvt_pk_bf16_f32 v80, v52, v53
    v_cvt_pk_bf16_f32 v81, v54, v55
    v_cvt_pk_bf16_f32 v82, v56, v57
    v_cvt_pk_bf16_f32 v83, v58, v59
    v_exp_f32 v60, v60
    v_exp_f32 v61, v61
    v_mfma_f32_32x32x16_bf16 v[84:99], v[40:43], v[80:83], v[84:99]
    v_exp_f32 v62, v62
    v_exp_f32 v63, v63
    v_exp_f32 v64, v64
    v_exp_f32 v65, v65
    v_exp_f32 v66, v66
    v_mfma_f32_32x32x16_bf16 v[44:59], v[24:27], v[12:15], 0
    buffer_load_dwordx4 v219, s[4:7], s28 offen offset:1024 lds
    v_exp_f32 v67, v67
    v_cvt_pk_bf16_f32 v76, v60, v61
    v_cvt_pk_bf16_f32 v77, v62, v63
    v_cvt_pk_bf16_f32 v78, v64, v65
    v_cvt_pk_bf16_f32 v79, v66, v67
    v_exp_f32 v68, v68
    v_exp_f32 v69, v69
    v_exp_f32 v70, v70
    v_mfma_f32_32x32x16_bf16 v[100:115], v[36:39], v[76:79], v[100:115]
    v_exp_f32 v71, v71
    v_exp_f32 v72, v72
    v_exp_f32 v73, v73
    v_exp_f32 v74, v74
    v_exp_f32 v75, v75
    v_cvt_pk_bf16_f32 v80, v68, v69
    v_cvt_pk_bf16_f32 v81, v70, v71
    v_cvt_pk_bf16_f32 v82, v72, v73
    v_cvt_pk_bf16_f32 v83, v74, v75
    v_exp_f32 v44, v44
    v_exp_f32 v45, v45
    v_mfma_f32_32x32x16_bf16 v[100:115], v[40:43], v[80:83], v[100:115]
    v_exp_f32 v46, v46
    v_exp_f32 v47, v47
    v_exp_f32 v48, v48
    v_exp_f32 v49, v49
    v_exp_f32 v50, v50
    v_mfma_f32_32x32x16_bf16 v[60:75], v[24:27], v[16:19], 0
    buffer_load_dwordx4 v220, s[4:7], s28 offen offset:2048 lds
    v_exp_f32 v51, v51
    v_cvt_pk_bf16_f32 v76, v44, v45
    v_cvt_pk_bf16_f32 v77, v46, v47
    v_cvt_pk_bf16_f32 v78, v48, v49
    v_cvt_pk_bf16_f32 v79, v50, v51
    v_exp_f32 v52, v52
    v_exp_f32 v53, v53
    v_exp_f32 v54, v54
    v_mfma_f32_32x32x16_bf16 v[116:131], v[36:39], v[76:79], v[116:131]
    v_exp_f32 v55, v55
    v_exp_f32 v56, v56
    v_exp_f32 v57, v57
    v_exp_f32 v58, v58
    v_exp_f32 v59, v59
    v_cvt_pk_bf16_f32 v80, v52, v53
    v_cvt_pk_bf16_f32 v81, v54, v55
    v_cvt_pk_bf16_f32 v82, v56, v57
    v_cvt_pk_bf16_f32 v83, v58, v59
    v_exp_f32 v60, v60
    v_exp_f32 v61, v61
    v_mfma_f32_32x32x16_bf16 v[116:131], v[40:43], v[80:83], v[116:131]
    v_exp_f32 v62, v62
    v_exp_f32 v63, v63
    v_exp_f32 v64, v64
    v_exp_f32 v65, v65
    v_exp_f32 v66, v66
    s_waitcnt lgkmcnt(0)
    v_mfma_f32_32x32x16_bf16 v[44:59], v[20:23], v[4:7], 0
    buffer_load_dwordx4 v221, s[4:7], s28 offen offset:3072 lds
    v_exp_f32 v67, v67
    v_cvt_pk_bf16_f32 v76, v60, v61
    v_cvt_pk_bf16_f32 v77, v62, v63
    v_cvt_pk_bf16_f32 v78, v64, v65
    v_cvt_pk_bf16_f32 v79, v66, v67
    v_exp_f32 v68, v68
    v_exp_f32 v69, v69
    v_exp_f32 v70, v70
    v_mfma_f32_32x32x16_bf16 v[132:147], v[36:39], v[76:79], v[132:147]
    v_exp_f32 v71, v71
    v_exp_f32 v72, v72
    v_exp_f32 v73, v73
    v_exp_f32 v74, v74
    v_exp_f32 v75, v75
    v_cvt_pk_bf16_f32 v80, v68, v69
    v_cvt_pk_bf16_f32 v81, v70, v71
    v_cvt_pk_bf16_f32 v82, v72, v73
    v_cvt_pk_bf16_f32 v83, v74, v75
    v_exp_f32 v44, v44
    v_exp_f32 v45, v45
    v_mfma_f32_32x32x16_bf16 v[132:147], v[40:43], v[80:83], v[132:147]
    ds_read_b128 v[24:27], v212 offset:43008
    v_exp_f32 v46, v46
    v_exp_f32 v47, v47
    s_mov_b64 exec, s[58:59]
    ds_read_b128 v[36:39], v213 offset:43008
    ds_read_b128 v[40:43], v213 offset:43520
    s_mov_b64 exec, -1
    v_exp_f32 v48, v48
    v_exp_f32 v49, v49
    v_exp_f32 v50, v50
    v_mfma_f32_32x32x16_bf16 v[60:75], v[20:23], v[8:11], 0
    v_exp_f32 v51, v51
    v_cvt_pk_bf16_f32 v76, v44, v45
    v_cvt_pk_bf16_f32 v77, v46, v47
    v_cvt_pk_bf16_f32 v78, v48, v49
    v_cvt_pk_bf16_f32 v79, v50, v51
    v_exp_f32 v52, v52
    v_exp_f32 v53, v53
    v_exp_f32 v54, v54
    v_mfma_f32_32x32x16_bf16 v[84:99], v[28:31], v[76:79], v[84:99]
    v_exp_f32 v55, v55
    v_exp_f32 v56, v56
    v_exp_f32 v57, v57
    v_exp_f32 v58, v58
    v_exp_f32 v59, v59
    v_cvt_pk_bf16_f32 v80, v52, v53
    v_cvt_pk_bf16_f32 v81, v54, v55
    v_cvt_pk_bf16_f32 v82, v56, v57
    v_cvt_pk_bf16_f32 v83, v58, v59
    v_exp_f32 v60, v60
    v_exp_f32 v61, v61
    v_mfma_f32_32x32x16_bf16 v[84:99], v[32:35], v[80:83], v[84:99]
    v_exp_f32 v62, v62
    v_exp_f32 v63, v63
    v_exp_f32 v64, v64
    v_exp_f32 v65, v65
    v_exp_f32 v66, v66
    v_mfma_f32_32x32x16_bf16 v[44:59], v[20:23], v[12:15], 0
    s_add_u32 m0, s38, 24576
    s_add_u32 s28, s37, 196608
    buffer_load_dwordx4 v218, s[4:7], s28 offen offset:0 lds
    v_exp_f32 v67, v67
    v_cvt_pk_bf16_f32 v76, v60, v61
    v_cvt_pk_bf16_f32 v77, v62, v63
    v_cvt_pk_bf16_f32 v78, v64, v65
    v_cvt_pk_bf16_f32 v79, v66, v67
    v_exp_f32 v68, v68
    v_exp_f32 v69, v69
    v_exp_f32 v70, v70
    v_mfma_f32_32x32x16_bf16 v[100:115], v[28:31], v[76:79], v[100:115]
    v_exp_f32 v71, v71
    v_exp_f32 v72, v72
    v_exp_f32 v73, v73
    v_exp_f32 v74, v74
    v_exp_f32 v75, v75
    v_cvt_pk_bf16_f32 v80, v68, v69
    v_cvt_pk_bf16_f32 v81, v70, v71
    v_cvt_pk_bf16_f32 v82, v72, v73
    v_cvt_pk_bf16_f32 v83, v74, v75
    v_exp_f32 v44, v44
    v_exp_f32 v45, v45
    v_mfma_f32_32x32x16_bf16 v[100:115], v[32:35], v[80:83], v[100:115]
    v_exp_f32 v46, v46
    v_exp_f32 v47, v47
    v_exp_f32 v48, v48
    v_exp_f32 v49, v49
    v_exp_f32 v50, v50
    v_mfma_f32_32x32x16_bf16 v[60:75], v[20:23], v[16:19], 0
    buffer_load_dwordx4 v219, s[4:7], s28 offen offset:1024 lds
    v_exp_f32 v51, v51
    v_cvt_pk_bf16_f32 v76, v44, v45
    v_cvt_pk_bf16_f32 v77, v46, v47
    v_cvt_pk_bf16_f32 v78, v48, v49
    v_cvt_pk_bf16_f32 v79, v50, v51
    v_exp_f32 v52, v52
    v_exp_f32 v53, v53
    v_exp_f32 v54, v54
    v_mfma_f32_32x32x16_bf16 v[116:131], v[28:31], v[76:79], v[116:131]
    v_exp_f32 v55, v55
    v_exp_f32 v56, v56
    v_exp_f32 v57, v57
    v_exp_f32 v58, v58
    v_exp_f32 v59, v59
    v_cvt_pk_bf16_f32 v80, v52, v53
    v_cvt_pk_bf16_f32 v81, v54, v55
    v_cvt_pk_bf16_f32 v82, v56, v57
    v_cvt_pk_bf16_f32 v83, v58, v59
    v_exp_f32 v60, v60
    v_exp_f32 v61, v61
    v_mfma_f32_32x32x16_bf16 v[116:131], v[32:35], v[80:83], v[116:131]
    v_exp_f32 v62, v62
    v_exp_f32 v63, v63
    v_exp_f32 v64, v64
    v_exp_f32 v65, v65
    v_exp_f32 v66, v66
    s_waitcnt lgkmcnt(0)
    v_mfma_f32_32x32x16_bf16 v[44:59], v[24:27], v[4:7], 0
    buffer_load_dwordx4 v220, s[4:7], s28 offen offset:2048 lds
    v_exp_f32 v67, v67
    v_cvt_pk_bf16_f32 v76, v60, v61
    v_cvt_pk_bf16_f32 v77, v62, v63
    v_cvt_pk_bf16_f32 v78, v64, v65
    v_cvt_pk_bf16_f32 v79, v66, v67
    v_exp_f32 v68, v68
    v_exp_f32 v69, v69
    v_exp_f32 v70, v70
    v_mfma_f32_32x32x16_bf16 v[132:147], v[28:31], v[76:79], v[132:147]
    v_exp_f32 v71, v71
    v_exp_f32 v72, v72
    v_exp_f32 v73, v73
    v_exp_f32 v74, v74
    v_exp_f32 v75, v75
    v_cvt_pk_bf16_f32 v80, v68, v69
    v_cvt_pk_bf16_f32 v81, v70, v71
    v_cvt_pk_bf16_f32 v82, v72, v73
    v_cvt_pk_bf16_f32 v83, v74, v75
    v_exp_f32 v44, v44
    v_exp_f32 v45, v45
    v_mfma_f32_32x32x16_bf16 v[132:147], v[32:35], v[80:83], v[132:147]
    ds_read_b128 v[20:23], v212 offset:45056
    v_exp_f32 v46, v46
    v_exp_f32 v47, v47
    s_mov_b64 exec, s[58:59]
    ds_read_b128 v[28:31], v213 offset:45056
    ds_read_b128 v[32:35], v213 offset:45568
    s_mov_b64 exec, -1
    v_exp_f32 v48, v48
    v_exp_f32 v49, v49
    v_exp_f32 v50, v50
    v_mfma_f32_32x32x16_bf16 v[60:75], v[24:27], v[8:11], 0
    v_exp_f32 v51, v51
    v_cvt_pk_bf16_f32 v76, v44, v45
    v_cvt_pk_bf16_f32 v77, v46, v47
    v_cvt_pk_bf16_f32 v78, v48, v49
    v_cvt_pk_bf16_f32 v79, v50, v51
    v_exp_f32 v52, v52
    v_exp_f32 v53, v53
    v_exp_f32 v54, v54
    v_mfma_f32_32x32x16_bf16 v[84:99], v[36:39], v[76:79], v[84:99]
    v_exp_f32 v55, v55
    v_exp_f32 v56, v56
    v_exp_f32 v57, v57
    v_exp_f32 v58, v58
    v_exp_f32 v59, v59
    v_cvt_pk_bf16_f32 v80, v52, v53
    v_cvt_pk_bf16_f32 v81, v54, v55
    v_cvt_pk_bf16_f32 v82, v56, v57
    v_cvt_pk_bf16_f32 v83, v58, v59
    v_exp_f32 v60, v60
    v_exp_f32 v61, v61
    v_mfma_f32_32x32x16_bf16 v[84:99], v[40:43], v[80:83], v[84:99]
    v_exp_f32 v62, v62
    v_exp_f32 v63, v63
    v_exp_f32 v64, v64
    v_exp_f32 v65, v65
    v_exp_f32 v66, v66
    v_mfma_f32_32x32x16_bf16 v[44:59], v[24:27], v[12:15], 0
    buffer_load_dwordx4 v221, s[4:7], s28 offen offset:3072 lds
    v_exp_f32 v67, v67
    v_cvt_pk_bf16_f32 v76, v60, v61
    v_cvt_pk_bf16_f32 v77, v62, v63
    v_cvt_pk_bf16_f32 v78, v64, v65
    v_cvt_pk_bf16_f32 v79, v66, v67
    v_exp_f32 v68, v68
    v_exp_f32 v69, v69
    v_exp_f32 v70, v70
    v_mfma_f32_32x32x16_bf16 v[100:115], v[36:39], v[76:79], v[100:115]
    v_exp_f32 v71, v71
    v_exp_f32 v72, v72
    v_exp_f32 v73, v73
    v_exp_f32 v74, v74
    v_exp_f32 v75, v75
    v_cvt_pk_bf16_f32 v80, v68, v69
    v_cvt_pk_bf16_f32 v81, v70, v71
    v_cvt_pk_bf16_f32 v82, v72, v73
    v_cvt_pk_bf16_f32 v83, v74, v75
    v_exp_f32 v44, v44
    v_exp_f32 v45, v45
    v_mfma_f32_32x32x16_bf16 v[100:115], v[40:43], v[80:83], v[100:115]
    v_exp_f32 v46, v46
    v_exp_f32 v47, v47
    v_exp_f32 v48, v48
    v_exp_f32 v49, v49
    v_exp_f32 v50, v50
    v_mfma_f32_32x32x16_bf16 v[60:75], v[24:27], v[16:19], 0
    v_exp_f32 v51, v51
    v_cvt_pk_bf16_f32 v76, v44, v45
    v_cvt_pk_bf16_f32 v77, v46, v47
    v_cvt_pk_bf16_f32 v78, v48, v49
    v_cvt_pk_bf16_f32 v79, v50, v51
    v_exp_f32 v52, v52
    v_exp_f32 v53, v53
    v_exp_f32 v54, v54
    v_mfma_f32_32x32x16_bf16 v[116:131], v[36:39], v[76:79], v[116:131]
    v_exp_f32 v55, v55
    v_exp_f32 v56, v56
    v_exp_f32 v57, v57
    v_exp_f32 v58, v58
    v_exp_f32 v59, v59
    v_cvt_pk_bf16_f32 v80, v52, v53
    v_cvt_pk_bf16_f32 v81, v54, v55
    v_cvt_pk_bf16_f32 v82, v56, v57
    v_cvt_pk_bf16_f32 v83, v58, v59
    v_exp_f32 v60, v60
    v_exp_f32 v61, v61
    v_mfma_f32_32x32x16_bf16 v[116:131], v[40:43], v[80:83], v[116:131]
    v_exp_f32 v62, v62
    v_exp_f32 v63, v63
    v_exp_f32 v64, v64
    v_exp_f32 v65, v65
    v_exp_f32 v66, v66
    s_waitcnt lgkmcnt(0)
    v_mfma_f32_32x32x16_bf16 v[44:59], v[20:23], v[4:7], 0
    v_exp_f32 v67, v67
    v_cvt_pk_bf16_f32 v76, v60, v61
    v_cvt_pk_bf16_f32 v77, v62, v63
    v_cvt_pk_bf16_f32 v78, v64, v65
    v_cvt_pk_bf16_f32 v79, v66, v67
    v_exp_f32 v68, v68
    v_exp_f32 v69, v69
    v_exp_f32 v70, v70
    v_mfma_f32_32x32x16_bf16 v[132:147], v[36:39], v[76:79], v[132:147]
    v_exp_f32 v71, v71
    v_exp_f32 v72, v72
    v_exp_f32 v73, v73
    v_exp_f32 v74, v74
    v_exp_f32 v75, v75
    v_cvt_pk_bf16_f32 v80, v68, v69
    v_cvt_pk_bf16_f32 v81, v70, v71
    v_cvt_pk_bf16_f32 v82, v72, v73
    v_cvt_pk_bf16_f32 v83, v74, v75
    v_exp_f32 v44, v44
    v_exp_f32 v45, v45
    v_mfma_f32_32x32x16_bf16 v[132:147], v[40:43], v[80:83], v[132:147]
    ds_read_b128 v[24:27], v212 offset:47104
    v_exp_f32 v46, v46
    v_exp_f32 v47, v47
    s_mov_b64 exec, s[58:59]
    ds_read_b128 v[36:39], v213 offset:47104
    ds_read_b128 v[40:43], v213 offset:47616
    s_mov_b64 exec, -1
    v_exp_f32 v48, v48
    v_exp_f32 v49, v49
    v_exp_f32 v50, v50
    v_mfma_f32_32x32x16_bf16 v[60:75], v[20:23], v[8:11], 0
    v_exp_f32 v51, v51
    v_cvt_pk_bf16_f32 v76, v44, v45
    v_cvt_pk_bf16_f32 v77, v46, v47
    v_cvt_pk_bf16_f32 v78, v48, v49
    v_cvt_pk_bf16_f32 v79, v50, v51
    v_exp_f32 v52, v52
    v_exp_f32 v53, v53
    v_exp_f32 v54, v54
    v_mfma_f32_32x32x16_bf16 v[84:99], v[28:31], v[76:79], v[84:99]
    v_exp_f32 v55, v55
    v_exp_f32 v56, v56
    v_exp_f32 v57, v57
    v_exp_f32 v58, v58
    v_exp_f32 v59, v59
    v_cvt_pk_bf16_f32 v80, v52, v53
    v_cvt_pk_bf16_f32 v81, v54, v55
    v_cvt_pk_bf16_f32 v82, v56, v57
    v_cvt_pk_bf16_f32 v83, v58, v59
    v_exp_f32 v60, v60
    v_exp_f32 v61, v61
    v_mfma_f32_32x32x16_bf16 v[84:99], v[32:35], v[80:83], v[84:99]
    v_exp_f32 v62, v62
    v_exp_f32 v63, v63
    v_exp_f32 v64, v64
    v_exp_f32 v65, v65
    v_exp_f32 v66, v66
    v_mfma_f32_32x32x16_bf16 v[44:59], v[20:23], v[12:15], 0
    v_exp_f32 v67, v67
    v_cvt_pk_bf16_f32 v76, v60, v61
    v_cvt_pk_bf16_f32 v77, v62, v63
    v_cvt_pk_bf16_f32 v78, v64, v65
    v_cvt_pk_bf16_f32 v79, v66, v67
    v_exp_f32 v68, v68
    v_exp_f32 v69, v69
    v_exp_f32 v70, v70
    v_mfma_f32_32x32x16_bf16 v[100:115], v[28:31], v[76:79], v[100:115]
    v_exp_f32 v71, v71
    v_exp_f32 v72, v72
    v_exp_f32 v73, v73
    v_exp_f32 v74, v74
    v_exp_f32 v75, v75
    v_cvt_pk_bf16_f32 v80, v68, v69
    v_cvt_pk_bf16_f32 v81, v70, v71
    v_cvt_pk_bf16_f32 v82, v72, v73
    v_cvt_pk_bf16_f32 v83, v74, v75
    v_exp_f32 v44, v44
    v_exp_f32 v45, v45
    v_mfma_f32_32x32x16_bf16 v[100:115], v[32:35], v[80:83], v[100:115]
    v_exp_f32 v46, v46
    v_exp_f32 v47, v47
    v_exp_f32 v48, v48
    v_exp_f32 v49, v49
    v_exp_f32 v50, v50
    v_mfma_f32_32x32x16_bf16 v[60:75], v[20:23], v[16:19], 0
    v_exp_f32 v51, v51
    v_cvt_pk_bf16_f32 v76, v44, v45
    v_cvt_pk_bf16_f32 v77, v46, v47
    v_cvt_pk_bf16_f32 v78, v48, v49
    v_cvt_pk_bf16_f32 v79, v50, v51
    v_exp_f32 v52, v52
    v_exp_f32 v53, v53
    v_exp_f32 v54, v54
    v_mfma_f32_32x32x16_bf16 v[116:131], v[28:31], v[76:79], v[116:131]
    v_exp_f32 v55, v55
    v_exp_f32 v56, v56
    v_exp_f32 v57, v57
    v_exp_f32 v58, v58
    v_exp_f32 v59, v59
    v_cvt_pk_bf16_f32 v80, v52, v53
    v_cvt_pk_bf16_f32 v81, v54, v55
    v_cvt_pk_bf16_f32 v82, v56, v57
    v_cvt_pk_bf16_f32 v83, v58, v59
    v_exp_f32 v60, v60
    v_exp_f32 v61, v61
    v_mfma_f32_32x32x16_bf16 v[116:131], v[32:35], v[80:83], v[116:131]
    v_exp_f32 v62, v62
    v_exp_f32 v63, v63
    v_exp_f32 v64, v64
    v_exp_f32 v65, v65
    v_exp_f32 v66, v66
    s_waitcnt lgkmcnt(0)
    v_mfma_f32_32x32x16_bf16 v[44:59], v[24:27], v[4:7], 0
    v_exp_f32 v67, v67
    v_cvt_pk_bf16_f32 v76, v60, v61
    v_cvt_pk_bf16_f32 v77, v62, v63
    v_cvt_pk_bf16_f32 v78, v64, v65
    v_cvt_pk_bf16_f32 v79, v66, v67
    v_exp_f32 v68, v68
    v_exp_f32 v69, v69
    v_exp_f32 v70, v70
    v_mfma_f32_32x32x16_bf16 v[132:147], v[28:31], v[76:79], v[132:147]
    v_exp_f32 v71, v71
    v_exp_f32 v72, v72
    v_exp_f32 v73, v73
    v_exp_f32 v74, v74
    v_exp_f32 v75, v75
    v_cvt_pk_bf16_f32 v80, v68, v69
    v_cvt_pk_bf16_f32 v81, v70, v71
    v_cvt_pk_bf16_f32 v82, v72, v73
    v_cvt_pk_bf16_f32 v83, v74, v75
    v_exp_f32 v44, v44
    v_exp_f32 v45, v45
    v_mfma_f32_32x32x16_bf16 v[132:147], v[32:35], v[80:83], v[132:147]
    ds_read_b128 v[20:23], v212 offset:49152
    v_exp_f32 v46, v46
    v_exp_f32 v47, v47
    s_mov_b64 exec, s[58:59]
    ds_read_b128 v[28:31], v213 offset:49152
    ds_read_b128 v[32:35], v213 offset:49664
    s_mov_b64 exec, -1
    v_exp_f32 v48, v48
    v_exp_f32 v49, v49
    v_exp_f32 v50, v50
    v_mfma_f32_32x32x16_bf16 v[60:75], v[24:27], v[8:11], 0
    v_exp_f32 v51, v51
    v_cvt_pk_bf16_f32 v76, v44, v45
    v_cvt_pk_bf16_f32 v77, v46, v47
    v_cvt_pk_bf16_f32 v78, v48, v49
    v_cvt_pk_bf16_f32 v79, v50, v51
    v_exp_f32 v52, v52
    v_exp_f32 v53, v53
    v_exp_f32 v54, v54
    v_mfma_f32_32x32x16_bf16 v[84:99], v[36:39], v[76:79], v[84:99]
    v_exp_f32 v55, v55
    v_exp_f32 v56, v56
    v_exp_f32 v57, v57
    v_exp_f32 v58, v58
    v_exp_f32 v59, v59
    v_cvt_pk_bf16_f32 v80, v52, v53
    v_cvt_pk_bf16_f32 v81, v54, v55
    v_cvt_pk_bf16_f32 v82, v56, v57
    v_cvt_pk_bf16_f32 v83, v58, v59
    v_exp_f32 v60, v60
    v_exp_f32 v61, v61
    v_mfma_f32_32x32x16_bf16 v[84:99], v[40:43], v[80:83], v[84:99]
    v_exp_f32 v62, v62
    v_exp_f32 v63, v63
    v_exp_f32 v64, v64
    v_exp_f32 v65, v65
    v_exp_f32 v66, v66
    v_mfma_f32_32x32x16_bf16 v[44:59], v[24:27], v[12:15], 0
    v_exp_f32 v67, v67
    v_cvt_pk_bf16_f32 v76, v60, v61
    v_cvt_pk_bf16_f32 v77, v62, v63
    v_cvt_pk_bf16_f32 v78, v64, v65
    v_cvt_pk_bf16_f32 v79, v66, v67
    v_exp_f32 v68, v68
    v_exp_f32 v69, v69
    v_exp_f32 v70, v70
    v_mfma_f32_32x32x16_bf16 v[100:115], v[36:39], v[76:79], v[100:115]
    v_exp_f32 v71, v71
    v_exp_f32 v72, v72
    v_exp_f32 v73, v73
    v_exp_f32 v74, v74
    v_exp_f32 v75, v75
    v_cvt_pk_bf16_f32 v80, v68, v69
    v_cvt_pk_bf16_f32 v81, v70, v71
    v_cvt_pk_bf16_f32 v82, v72, v73
    v_cvt_pk_bf16_f32 v83, v74, v75
    v_exp_f32 v44, v44
    v_exp_f32 v45, v45
    v_mfma_f32_32x32x16_bf16 v[100:115], v[40:43], v[80:83], v[100:115]
    v_exp_f32 v46, v46
    v_exp_f32 v47, v47
    v_exp_f32 v48, v48
    v_exp_f32 v49, v49
    v_exp_f32 v50, v50
    v_mfma_f32_32x32x16_bf16 v[60:75], v[24:27], v[16:19], 0
    v_exp_f32 v51, v51
    v_cvt_pk_bf16_f32 v76, v44, v45
    v_cvt_pk_bf16_f32 v77, v46, v47
    v_cvt_pk_bf16_f32 v78, v48, v49
    v_cvt_pk_bf16_f32 v79, v50, v51
    v_exp_f32 v52, v52
    v_exp_f32 v53, v53
    v_exp_f32 v54, v54
    v_mfma_f32_32x32x16_bf16 v[116:131], v[36:39], v[76:79], v[116:131]
    v_exp_f32 v55, v55
    v_exp_f32 v56, v56
    v_exp_f32 v57, v57
    v_exp_f32 v58, v58
    v_exp_f32 v59, v59
    v_cvt_pk_bf16_f32 v80, v52, v53
    v_cvt_pk_bf16_f32 v81, v54, v55
    v_cvt_pk_bf16_f32 v82, v56, v57
    v_cvt_pk_bf16_f32 v83, v58, v59
    v_exp_f32 v60, v60
    v_exp_f32 v61, v61
    v_mfma_f32_32x32x16_bf16 v[116:131], v[40:43], v[80:83], v[116:131]
    v_exp_f32 v62, v62
    v_exp_f32 v63, v63
    v_exp_f32 v64, v64
    v_exp_f32 v65, v65
    v_exp_f32 v66, v66
    s_waitcnt lgkmcnt(0)
    v_mfma_f32_32x32x16_bf16 v[44:59], v[20:23], v[4:7], 0
    v_exp_f32 v67, v67
    v_cvt_pk_bf16_f32 v76, v60, v61
    v_cvt_pk_bf16_f32 v77, v62, v63
    v_cvt_pk_bf16_f32 v78, v64, v65
    v_cvt_pk_bf16_f32 v79, v66, v67
    v_exp_f32 v68, v68
    v_exp_f32 v69, v69
    v_exp_f32 v70, v70
    v_mfma_f32_32x32x16_bf16 v[132:147], v[36:39], v[76:79], v[132:147]
    v_exp_f32 v71, v71
    v_exp_f32 v72, v72
    v_exp_f32 v73, v73
    v_exp_f32 v74, v74
    v_exp_f32 v75, v75
    v_cvt_pk_bf16_f32 v80, v68, v69
    v_cvt_pk_bf16_f32 v81, v70, v71
    v_cvt_pk_bf16_f32 v82, v72, v73
    v_cvt_pk_bf16_f32 v83, v74, v75
    v_exp_f32 v44, v44
    v_exp_f32 v45, v45
    v_mfma_f32_32x32x16_bf16 v[132:147], v[40:43], v[80:83], v[132:147]
    ds_read_b128 v[24:27], v212 offset:51200
    v_exp_f32 v46, v46
    v_exp_f32 v47, v47
    s_mov_b64 exec, s[58:59]
    ds_read_b128 v[36:39], v213 offset:51200
    ds_read_b128 v[40:43], v213 offset:51712
    s_mov_b64 exec, -1
    v_exp_f32 v48, v48
    v_exp_f32 v49, v49
    v_exp_f32 v50, v50
    v_mfma_f32_32x32x16_bf16 v[60:75], v[20:23], v[8:11], 0
    v_and_b32 v233, 15, v1
    v_lshlrev_b32 v233, 8, v233
    s_mov_b32 s65, 6361088
    buffer_load_dword v233, v233, s[16:19], s65 offen sc1
    v_exp_f32 v51, v51
    v_cvt_pk_bf16_f32 v76, v44, v45
    v_cvt_pk_bf16_f32 v77, v46, v47
    v_cvt_pk_bf16_f32 v78, v48, v49
    v_cvt_pk_bf16_f32 v79, v50, v51
    v_exp_f32 v52, v52
    v_exp_f32 v53, v53
    v_exp_f32 v54, v54
    v_mfma_f32_32x32x16_bf16 v[84:99], v[28:31], v[76:79], v[84:99]
    v_exp_f32 v55, v55
    v_exp_f32 v56, v56
    v_exp_f32 v57, v57
    v_exp_f32 v58, v58
    v_exp_f32 v59, v59
    v_cvt_pk_bf16_f32 v80, v52, v53
    v_cvt_pk_bf16_f32 v81, v54, v55
    v_cvt_pk_bf16_f32 v82, v56, v57
    v_cvt_pk_bf16_f32 v83, v58, v59
    v_exp_f32 v60, v60
    v_exp_f32 v61, v61
    v_mfma_f32_32x32x16_bf16 v[84:99], v[32:35], v[80:83], v[84:99]
    v_exp_f32 v62, v62
    v_exp_f32 v63, v63
    v_exp_f32 v64, v64
    v_exp_f32 v65, v65
    v_exp_f32 v66, v66
    v_mfma_f32_32x32x16_bf16 v[44:59], v[20:23], v[12:15], 0
    v_exp_f32 v67, v67
    v_cvt_pk_bf16_f32 v76, v60, v61
    v_cvt_pk_bf16_f32 v77, v62, v63
    v_cvt_pk_bf16_f32 v78, v64, v65
    v_cvt_pk_bf16_f32 v79, v66, v67
    v_exp_f32 v68, v68
    v_exp_f32 v69, v69
    v_exp_f32 v70, v70
    v_mfma_f32_32x32x16_bf16 v[100:115], v[28:31], v[76:79], v[100:115]
    v_exp_f32 v71, v71
    v_exp_f32 v72, v72
    v_exp_f32 v73, v73
    v_exp_f32 v74, v74
    v_exp_f32 v75, v75
    v_cvt_pk_bf16_f32 v80, v68, v69
    v_cvt_pk_bf16_f32 v81, v70, v71
    v_cvt_pk_bf16_f32 v82, v72, v73
    v_cvt_pk_bf16_f32 v83, v74, v75
    v_exp_f32 v44, v44
    v_exp_f32 v45, v45
    v_mfma_f32_32x32x16_bf16 v[100:115], v[32:35], v[80:83], v[100:115]
    v_exp_f32 v46, v46
    v_exp_f32 v47, v47
    v_exp_f32 v48, v48
    v_exp_f32 v49, v49
    v_exp_f32 v50, v50
    v_mfma_f32_32x32x16_bf16 v[60:75], v[20:23], v[16:19], 0
    v_exp_f32 v51, v51
    v_cvt_pk_bf16_f32 v76, v44, v45
    v_cvt_pk_bf16_f32 v77, v46, v47
    v_cvt_pk_bf16_f32 v78, v48, v49
    v_cvt_pk_bf16_f32 v79, v50, v51
    v_exp_f32 v52, v52
    v_exp_f32 v53, v53
    v_exp_f32 v54, v54
    v_mfma_f32_32x32x16_bf16 v[116:131], v[28:31], v[76:79], v[116:131]
    v_exp_f32 v55, v55
    v_exp_f32 v56, v56
    v_exp_f32 v57, v57
    v_exp_f32 v58, v58
    v_exp_f32 v59, v59
    v_cvt_pk_bf16_f32 v80, v52, v53
    v_cvt_pk_bf16_f32 v81, v54, v55
    v_cvt_pk_bf16_f32 v82, v56, v57
    v_cvt_pk_bf16_f32 v83, v58, v59
    v_exp_f32 v60, v60
    v_exp_f32 v61, v61
    v_mfma_f32_32x32x16_bf16 v[116:131], v[32:35], v[80:83], v[116:131]
    v_exp_f32 v62, v62
    v_exp_f32 v63, v63
    v_exp_f32 v64, v64
    v_exp_f32 v65, v65
    v_exp_f32 v66, v66
    s_waitcnt lgkmcnt(0)
    v_mfma_f32_32x32x16_bf16 v[44:59], v[24:27], v[4:7], 0
    v_exp_f32 v67, v67
    v_cvt_pk_bf16_f32 v76, v60, v61
    v_cvt_pk_bf16_f32 v77, v62, v63
    v_cvt_pk_bf16_f32 v78, v64, v65
    v_cvt_pk_bf16_f32 v79, v66, v67
    v_exp_f32 v68, v68
    v_exp_f32 v69, v69
    v_exp_f32 v70, v70
    v_mfma_f32_32x32x16_bf16 v[132:147], v[28:31], v[76:79], v[132:147]
    v_exp_f32 v71, v71
    v_exp_f32 v72, v72
    v_exp_f32 v73, v73
    v_exp_f32 v74, v74
    v_exp_f32 v75, v75
    v_cvt_pk_bf16_f32 v80, v68, v69
    v_cvt_pk_bf16_f32 v81, v70, v71
    v_cvt_pk_bf16_f32 v82, v72, v73
    v_cvt_pk_bf16_f32 v83, v74, v75
    v_exp_f32 v44, v44
    v_exp_f32 v45, v45
    v_mfma_f32_32x32x16_bf16 v[132:147], v[32:35], v[80:83], v[132:147]
    ds_read_b128 v[20:23], v212 offset:53248
    v_exp_f32 v46, v46
    v_exp_f32 v47, v47
    s_mov_b64 exec, s[58:59]
    ds_read_b128 v[28:31], v213 offset:53248
    ds_read_b128 v[32:35], v213 offset:53760
    s_mov_b64 exec, -1
    v_exp_f32 v48, v48
    v_exp_f32 v49, v49
    v_exp_f32 v50, v50
    v_mfma_f32_32x32x16_bf16 v[60:75], v[24:27], v[8:11], 0
    v_exp_f32 v51, v51
    v_cvt_pk_bf16_f32 v76, v44, v45
    v_cvt_pk_bf16_f32 v77, v46, v47
    v_cvt_pk_bf16_f32 v78, v48, v49
    v_cvt_pk_bf16_f32 v79, v50, v51
    v_exp_f32 v52, v52
    v_exp_f32 v53, v53
    v_exp_f32 v54, v54
    v_mfma_f32_32x32x16_bf16 v[84:99], v[36:39], v[76:79], v[84:99]
    v_exp_f32 v55, v55
    v_exp_f32 v56, v56
    v_exp_f32 v57, v57
    v_exp_f32 v58, v58
    v_exp_f32 v59, v59
    v_cvt_pk_bf16_f32 v80, v52, v53
    v_cvt_pk_bf16_f32 v81, v54, v55
    v_cvt_pk_bf16_f32 v82, v56, v57
    v_cvt_pk_bf16_f32 v83, v58, v59
    v_exp_f32 v60, v60
    v_exp_f32 v61, v61
    v_mfma_f32_32x32x16_bf16 v[84:99], v[40:43], v[80:83], v[84:99]
    v_exp_f32 v62, v62
    v_exp_f32 v63, v63
    v_exp_f32 v64, v64
    v_exp_f32 v65, v65
    v_exp_f32 v66, v66
    v_mfma_f32_32x32x16_bf16 v[44:59], v[24:27], v[12:15], 0
    v_exp_f32 v67, v67
    v_cvt_pk_bf16_f32 v76, v60, v61
    v_cvt_pk_bf16_f32 v77, v62, v63
    v_cvt_pk_bf16_f32 v78, v64, v65
    v_cvt_pk_bf16_f32 v79, v66, v67
    v_exp_f32 v68, v68
    v_exp_f32 v69, v69
    v_exp_f32 v70, v70
    v_mfma_f32_32x32x16_bf16 v[100:115], v[36:39], v[76:79], v[100:115]
    v_exp_f32 v71, v71
    v_exp_f32 v72, v72
    v_exp_f32 v73, v73
    v_exp_f32 v74, v74
    v_exp_f32 v75, v75
    v_cvt_pk_bf16_f32 v80, v68, v69
    v_cvt_pk_bf16_f32 v81, v70, v71
    v_cvt_pk_bf16_f32 v82, v72, v73
    v_cvt_pk_bf16_f32 v83, v74, v75
    v_exp_f32 v44, v44
    v_exp_f32 v45, v45
    v_mfma_f32_32x32x16_bf16 v[100:115], v[40:43], v[80:83], v[100:115]
    v_exp_f32 v46, v46
    v_exp_f32 v47, v47
    v_exp_f32 v48, v48
    v_exp_f32 v49, v49
    v_exp_f32 v50, v50
    v_mfma_f32_32x32x16_bf16 v[60:75], v[24:27], v[16:19], 0
    buffer_load_dword v216, v214, s[8:11], s60 offen
    v_exp_f32 v51, v51
    v_cvt_pk_bf16_f32 v76, v44, v45
    v_cvt_pk_bf16_f32 v77, v46, v47
    v_cvt_pk_bf16_f32 v78, v48, v49
    v_cvt_pk_bf16_f32 v79, v50, v51
    v_exp_f32 v52, v52
    v_exp_f32 v53, v53
    v_exp_f32 v54, v54
    v_mfma_f32_32x32x16_bf16 v[116:131], v[36:39], v[76:79], v[116:131]
    v_exp_f32 v55, v55
    v_exp_f32 v56, v56
    v_exp_f32 v57, v57
    v_exp_f32 v58, v58
    v_exp_f32 v59, v59
    v_cvt_pk_bf16_f32 v80, v52, v53
    v_cvt_pk_bf16_f32 v81, v54, v55
    v_cvt_pk_bf16_f32 v82, v56, v57
    v_cvt_pk_bf16_f32 v83, v58, v59
    v_exp_f32 v60, v60
    v_exp_f32 v61, v61
    v_mfma_f32_32x32x16_bf16 v[116:131], v[40:43], v[80:83], v[116:131]
    v_exp_f32 v62, v62
    v_exp_f32 v63, v63
    v_exp_f32 v64, v64
    v_exp_f32 v65, v65
    v_exp_f32 v66, v66
    s_waitcnt lgkmcnt(0)
    v_mfma_f32_32x32x16_bf16 v[44:59], v[20:23], v[4:7], 0
    v_exp_f32 v67, v67
    v_cvt_pk_bf16_f32 v76, v60, v61
    v_cvt_pk_bf16_f32 v77, v62, v63
    v_cvt_pk_bf16_f32 v78, v64, v65
    v_cvt_pk_bf16_f32 v79, v66, v67
    v_exp_f32 v68, v68
    v_exp_f32 v69, v69
    v_exp_f32 v70, v70
    v_mfma_f32_32x32x16_bf16 v[132:147], v[36:39], v[76:79], v[132:147]
    v_exp_f32 v71, v71
    v_exp_f32 v72, v72
    v_exp_f32 v73, v73
    v_exp_f32 v74, v74
    v_exp_f32 v75, v75
    v_cvt_pk_bf16_f32 v80, v68, v69
    v_cvt_pk_bf16_f32 v81, v70, v71
    v_cvt_pk_bf16_f32 v82, v72, v73
    v_cvt_pk_bf16_f32 v83, v74, v75
    v_exp_f32 v44, v44
    v_exp_f32 v45, v45
    v_mfma_f32_32x32x16_bf16 v[132:147], v[40:43], v[80:83], v[132:147]
    ds_read_b128 v[24:27], v212 offset:55296
    v_exp_f32 v46, v46
    v_exp_f32 v47, v47
    s_mov_b64 exec, s[58:59]
    ds_read_b128 v[36:39], v213 offset:55296
    ds_read_b128 v[40:43], v213 offset:55808
    s_mov_b64 exec, -1
    v_exp_f32 v48, v48
    v_exp_f32 v49, v49
    v_exp_f32 v50, v50
    v_mfma_f32_32x32x16_bf16 v[60:75], v[20:23], v[8:11], 0
    v_exp_f32 v51, v51
    v_cvt_pk_bf16_f32 v76, v44, v45
    v_cvt_pk_bf16_f32 v77, v46, v47
    v_cvt_pk_bf16_f32 v78, v48, v49
    v_cvt_pk_bf16_f32 v79, v50, v51
    v_exp_f32 v52, v52
    v_exp_f32 v53, v53
    v_exp_f32 v54, v54
    v_mfma_f32_32x32x16_bf16 v[84:99], v[28:31], v[76:79], v[84:99]
    v_exp_f32 v55, v55
    v_exp_f32 v56, v56
    v_exp_f32 v57, v57
    v_exp_f32 v58, v58
    v_exp_f32 v59, v59
    v_cvt_pk_bf16_f32 v80, v52, v53
    v_cvt_pk_bf16_f32 v81, v54, v55
    v_cvt_pk_bf16_f32 v82, v56, v57
    v_cvt_pk_bf16_f32 v83, v58, v59
    v_exp_f32 v60, v60
    v_exp_f32 v61, v61
    v_mfma_f32_32x32x16_bf16 v[84:99], v[32:35], v[80:83], v[84:99]
    v_exp_f32 v62, v62
    v_exp_f32 v63, v63
    v_exp_f32 v64, v64
    v_exp_f32 v65, v65
    v_exp_f32 v66, v66
    v_mfma_f32_32x32x16_bf16 v[44:59], v[20:23], v[12:15], 0
    v_exp_f32 v67, v67
    v_cvt_pk_bf16_f32 v76, v60, v61
    v_cvt_pk_bf16_f32 v77, v62, v63
    v_cvt_pk_bf16_f32 v78, v64, v65
    v_cvt_pk_bf16_f32 v79, v66, v67
    v_exp_f32 v68, v68
    v_exp_f32 v69, v69
    v_exp_f32 v70, v70
    v_mfma_f32_32x32x16_bf16 v[100:115], v[28:31], v[76:79], v[100:115]
    v_exp_f32 v71, v71
    v_exp_f32 v72, v72
    v_exp_f32 v73, v73
    v_exp_f32 v74, v74
    v_exp_f32 v75, v75
    v_cvt_pk_bf16_f32 v80, v68, v69
    v_cvt_pk_bf16_f32 v81, v70, v71
    v_cvt_pk_bf16_f32 v82, v72, v73
    v_cvt_pk_bf16_f32 v83, v74, v75
    v_exp_f32 v44, v44
    v_exp_f32 v45, v45
    v_mfma_f32_32x32x16_bf16 v[100:115], v[32:35], v[80:83], v[100:115]
    v_exp_f32 v46, v46
    v_exp_f32 v47, v47
    v_exp_f32 v48, v48
    v_exp_f32 v49, v49
    v_exp_f32 v50, v50
    v_mfma_f32_32x32x16_bf16 v[60:75], v[20:23], v[16:19], 0
    v_exp_f32 v51, v51
    v_cvt_pk_bf16_f32 v76, v44, v45
    v_cvt_pk_bf16_f32 v77, v46, v47
    v_cvt_pk_bf16_f32 v78, v48, v49
    v_cvt_pk_bf16_f32 v79, v50, v51
    v_exp_f32 v52, v52
    v_exp_f32 v53, v53
    v_exp_f32 v54, v54
    v_mfma_f32_32x32x16_bf16 v[116:131], v[28:31], v[76:79], v[116:131]
    v_exp_f32 v55, v55
    v_exp_f32 v56, v56
    v_exp_f32 v57, v57
    v_exp_f32 v58, v58
    v_exp_f32 v59, v59
    v_cvt_pk_bf16_f32 v80, v52, v53
    v_cvt_pk_bf16_f32 v81, v54, v55
    v_cvt_pk_bf16_f32 v82, v56, v57
    v_cvt_pk_bf16_f32 v83, v58, v59
    v_exp_f32 v60, v60
    v_exp_f32 v61, v61
    v_mfma_f32_32x32x16_bf16 v[116:131], v[32:35], v[80:83], v[116:131]
    v_exp_f32 v62, v62
    v_exp_f32 v63, v63
    v_exp_f32 v64, v64
    v_exp_f32 v65, v65
    v_exp_f32 v66, v66
    s_waitcnt lgkmcnt(0)
    v_mfma_f32_32x32x16_bf16 v[44:59], v[24:27], v[4:7], 0
    v_exp_f32 v67, v67
    v_cvt_pk_bf16_f32 v76, v60, v61
    v_cvt_pk_bf16_f32 v77, v62, v63
    v_cvt_pk_bf16_f32 v78, v64, v65
    v_cvt_pk_bf16_f32 v79, v66, v67
    v_exp_f32 v68, v68
    v_exp_f32 v69, v69
    v_exp_f32 v70, v70
    v_mfma_f32_32x32x16_bf16 v[132:147], v[28:31], v[76:79], v[132:147]
    v_exp_f32 v71, v71
    v_exp_f32 v72, v72
    v_exp_f32 v73, v73
    v_exp_f32 v74, v74
    v_exp_f32 v75, v75
    v_cvt_pk_bf16_f32 v80, v68, v69
    v_cvt_pk_bf16_f32 v81, v70, v71
    v_cvt_pk_bf16_f32 v82, v72, v73
    v_cvt_pk_bf16_f32 v83, v74, v75
    v_exp_f32 v44, v44
    v_exp_f32 v45, v45
    v_mfma_f32_32x32x16_bf16 v[132:147], v[32:35], v[80:83], v[132:147]
    ds_read_b128 v[20:23], v212 offset:57344
    v_exp_f32 v46, v46
    v_exp_f32 v47, v47
    s_mov_b64 exec, s[58:59]
    ds_read_b128 v[28:31], v213 offset:57344
    ds_read_b128 v[32:35], v213 offset:57856
    s_mov_b64 exec, -1
    v_exp_f32 v48, v48
    v_exp_f32 v49, v49
    v_exp_f32 v50, v50
    v_mfma_f32_32x32x16_bf16 v[60:75], v[24:27], v[8:11], 0
    v_exp_f32 v51, v51
    v_cvt_pk_bf16_f32 v76, v44, v45
    v_cvt_pk_bf16_f32 v77, v46, v47
    v_cvt_pk_bf16_f32 v78, v48, v49
    v_cvt_pk_bf16_f32 v79, v50, v51
    v_exp_f32 v52, v52
    v_exp_f32 v53, v53
    v_exp_f32 v54, v54
    v_mfma_f32_32x32x16_bf16 v[84:99], v[36:39], v[76:79], v[84:99]
    v_exp_f32 v55, v55
    v_exp_f32 v56, v56
    v_exp_f32 v57, v57
    v_exp_f32 v58, v58
    v_exp_f32 v59, v59
    v_cvt_pk_bf16_f32 v80, v52, v53
    v_cvt_pk_bf16_f32 v81, v54, v55
    v_cvt_pk_bf16_f32 v82, v56, v57
    v_cvt_pk_bf16_f32 v83, v58, v59
    v_exp_f32 v60, v60
    v_exp_f32 v61, v61
    v_mfma_f32_32x32x16_bf16 v[84:99], v[40:43], v[80:83], v[84:99]
    v_exp_f32 v62, v62
    v_exp_f32 v63, v63
    v_exp_f32 v64, v64
    v_exp_f32 v65, v65
    v_exp_f32 v66, v66
    v_mfma_f32_32x32x16_bf16 v[44:59], v[24:27], v[12:15], 0
    v_exp_f32 v67, v67
    v_cvt_pk_bf16_f32 v76, v60, v61
    v_cvt_pk_bf16_f32 v77, v62, v63
    v_cvt_pk_bf16_f32 v78, v64, v65
    v_cvt_pk_bf16_f32 v79, v66, v67
    v_exp_f32 v68, v68
    v_exp_f32 v69, v69
    v_exp_f32 v70, v70
    v_mfma_f32_32x32x16_bf16 v[100:115], v[36:39], v[76:79], v[100:115]
    v_exp_f32 v71, v71
    v_exp_f32 v72, v72
    v_exp_f32 v73, v73
    v_exp_f32 v74, v74
    v_exp_f32 v75, v75
    v_cvt_pk_bf16_f32 v80, v68, v69
    v_cvt_pk_bf16_f32 v81, v70, v71
    v_cvt_pk_bf16_f32 v82, v72, v73
    v_cvt_pk_bf16_f32 v83, v74, v75
    v_exp_f32 v44, v44
    v_exp_f32 v45, v45
    v_mfma_f32_32x32x16_bf16 v[100:115], v[40:43], v[80:83], v[100:115]
    v_exp_f32 v46, v46
    v_exp_f32 v47, v47
    v_exp_f32 v48, v48
    v_exp_f32 v49, v49
    v_exp_f32 v50, v50
    v_mfma_f32_32x32x16_bf16 v[60:75], v[24:27], v[16:19], 0
    v_exp_f32 v51, v51
    v_cvt_pk_bf16_f32 v76, v44, v45
    v_cvt_pk_bf16_f32 v77, v46, v47
    v_cvt_pk_bf16_f32 v78, v48, v49
    v_cvt_pk_bf16_f32 v79, v50, v51
    v_exp_f32 v52, v52
    v_exp_f32 v53, v53
    v_exp_f32 v54, v54
    v_mfma_f32_32x32x16_bf16 v[116:131], v[36:39], v[76:79], v[116:131]
    v_exp_f32 v55, v55
    v_exp_f32 v56, v56
    v_exp_f32 v57, v57
    v_exp_f32 v58, v58
    v_exp_f32 v59, v59
    v_cvt_pk_bf16_f32 v80, v52, v53
    v_cvt_pk_bf16_f32 v81, v54, v55
    v_cvt_pk_bf16_f32 v82, v56, v57
    v_cvt_pk_bf16_f32 v83, v58, v59
    v_exp_f32 v60, v60
    v_exp_f32 v61, v61
    v_mfma_f32_32x32x16_bf16 v[116:131], v[40:43], v[80:83], v[116:131]
    v_exp_f32 v62, v62
    v_exp_f32 v63, v63
    v_exp_f32 v64, v64
    v_exp_f32 v65, v65
    v_exp_f32 v66, v66
    s_waitcnt lgkmcnt(0)
    v_mfma_f32_32x32x16_bf16 v[44:59], v[20:23], v[4:7], 0
    v_exp_f32 v67, v67
    v_cvt_pk_bf16_f32 v76, v60, v61
    v_cvt_pk_bf16_f32 v77, v62, v63
    v_cvt_pk_bf16_f32 v78, v64, v65
    v_cvt_pk_bf16_f32 v79, v66, v67
    v_exp_f32 v68, v68
    v_exp_f32 v69, v69
    v_exp_f32 v70, v70
    v_mfma_f32_32x32x16_bf16 v[132:147], v[36:39], v[76:79], v[132:147]
    v_exp_f32 v71, v71
    v_exp_f32 v72, v72
    v_exp_f32 v73, v73
    v_exp_f32 v74, v74
    v_exp_f32 v75, v75
    v_cvt_pk_bf16_f32 v80, v68, v69
    v_cvt_pk_bf16_f32 v81, v70, v71
    v_cvt_pk_bf16_f32 v82, v72, v73
    v_cvt_pk_bf16_f32 v83, v74, v75
    v_exp_f32 v44, v44
    v_exp_f32 v45, v45
    v_mfma_f32_32x32x16_bf16 v[132:147], v[40:43], v[80:83], v[132:147]
    ds_read_b128 v[24:27], v212 offset:59392
    v_exp_f32 v46, v46
    v_exp_f32 v47, v47
    s_mov_b64 exec, s[58:59]
    ds_read_b128 v[36:39], v213 offset:59392
    ds_read_b128 v[40:43], v213 offset:59904
    s_mov_b64 exec, -1
    v_exp_f32 v48, v48
    v_exp_f32 v49, v49
    v_exp_f32 v50, v50
    v_mfma_f32_32x32x16_bf16 v[60:75], v[20:23], v[8:11], 0
    v_exp_f32 v51, v51
    v_cvt_pk_bf16_f32 v76, v44, v45
    v_cvt_pk_bf16_f32 v77, v46, v47
    v_cvt_pk_bf16_f32 v78, v48, v49
    v_cvt_pk_bf16_f32 v79, v50, v51
    v_exp_f32 v52, v52
    v_exp_f32 v53, v53
    v_exp_f32 v54, v54
    v_mfma_f32_32x32x16_bf16 v[84:99], v[28:31], v[76:79], v[84:99]
    v_exp_f32 v55, v55
    v_exp_f32 v56, v56
    v_exp_f32 v57, v57
    v_exp_f32 v58, v58
    v_exp_f32 v59, v59
    v_cvt_pk_bf16_f32 v80, v52, v53
    v_cvt_pk_bf16_f32 v81, v54, v55
    v_cvt_pk_bf16_f32 v82, v56, v57
    v_cvt_pk_bf16_f32 v83, v58, v59
    v_exp_f32 v60, v60
    v_exp_f32 v61, v61
    v_mfma_f32_32x32x16_bf16 v[84:99], v[32:35], v[80:83], v[84:99]
    v_exp_f32 v62, v62
    v_exp_f32 v63, v63
    v_exp_f32 v64, v64
    v_exp_f32 v65, v65
    v_exp_f32 v66, v66
    v_mfma_f32_32x32x16_bf16 v[44:59], v[20:23], v[12:15], 0
    v_exp_f32 v67, v67
    v_cvt_pk_bf16_f32 v76, v60, v61
    v_cvt_pk_bf16_f32 v77, v62, v63
    v_cvt_pk_bf16_f32 v78, v64, v65
    v_cvt_pk_bf16_f32 v79, v66, v67
    v_exp_f32 v68, v68
    v_exp_f32 v69, v69
    v_exp_f32 v70, v70
    v_mfma_f32_32x32x16_bf16 v[100:115], v[28:31], v[76:79], v[100:115]
    v_exp_f32 v71, v71
    v_exp_f32 v72, v72
    v_exp_f32 v73, v73
    v_exp_f32 v74, v74
    v_exp_f32 v75, v75
    v_cvt_pk_bf16_f32 v80, v68, v69
    v_cvt_pk_bf16_f32 v81, v70, v71
    v_cvt_pk_bf16_f32 v82, v72, v73
    v_cvt_pk_bf16_f32 v83, v74, v75
    v_exp_f32 v44, v44
    v_exp_f32 v45, v45
    v_mfma_f32_32x32x16_bf16 v[100:115], v[32:35], v[80:83], v[100:115]
    v_exp_f32 v46, v46
    v_exp_f32 v47, v47
    v_exp_f32 v48, v48
    v_exp_f32 v49, v49
    v_exp_f32 v50, v50
    v_mfma_f32_32x32x16_bf16 v[60:75], v[20:23], v[16:19], 0
    v_exp_f32 v51, v51
    v_cvt_pk_bf16_f32 v76, v44, v45
    v_cvt_pk_bf16_f32 v77, v46, v47
    v_cvt_pk_bf16_f32 v78, v48, v49
    v_cvt_pk_bf16_f32 v79, v50, v51
    v_exp_f32 v52, v52
    v_exp_f32 v53, v53
    v_exp_f32 v54, v54
    v_mfma_f32_32x32x16_bf16 v[116:131], v[28:31], v[76:79], v[116:131]
    v_exp_f32 v55, v55
    v_exp_f32 v56, v56
    v_exp_f32 v57, v57
    v_exp_f32 v58, v58
    v_exp_f32 v59, v59
    v_cvt_pk_bf16_f32 v80, v52, v53
    v_cvt_pk_bf16_f32 v81, v54, v55
    v_cvt_pk_bf16_f32 v82, v56, v57
    v_cvt_pk_bf16_f32 v83, v58, v59
    v_exp_f32 v60, v60
    v_exp_f32 v61, v61
    v_mfma_f32_32x32x16_bf16 v[116:131], v[32:35], v[80:83], v[116:131]
    v_exp_f32 v62, v62
    v_exp_f32 v63, v63
    v_exp_f32 v64, v64
    v_exp_f32 v65, v65
    v_exp_f32 v66, v66
    s_waitcnt lgkmcnt(0)
    v_mfma_f32_32x32x16_bf16 v[44:59], v[24:27], v[4:7], 0
    v_exp_f32 v67, v67
    v_cvt_pk_bf16_f32 v76, v60, v61
    v_cvt_pk_bf16_f32 v77, v62, v63
    v_cvt_pk_bf16_f32 v78, v64, v65
    v_cvt_pk_bf16_f32 v79, v66, v67
    v_exp_f32 v68, v68
    v_exp_f32 v69, v69
    v_exp_f32 v70, v70
    v_mfma_f32_32x32x16_bf16 v[132:147], v[28:31], v[76:79], v[132:147]
    v_exp_f32 v71, v71
    v_exp_f32 v72, v72
    v_exp_f32 v73, v73
    v_exp_f32 v74, v74
    v_exp_f32 v75, v75
    v_cvt_pk_bf16_f32 v80, v68, v69
    v_cvt_pk_bf16_f32 v81, v70, v71
    v_cvt_pk_bf16_f32 v82, v72, v73
    v_cvt_pk_bf16_f32 v83, v74, v75
    v_exp_f32 v44, v44
    v_exp_f32 v45, v45
    v_mfma_f32_32x32x16_bf16 v[132:147], v[32:35], v[80:83], v[132:147]
    ds_read_b128 v[20:23], v212 offset:61440
    v_exp_f32 v46, v46
    v_exp_f32 v47, v47
    s_mov_b64 exec, s[58:59]
    ds_read_b128 v[28:31], v213 offset:61440
    ds_read_b128 v[32:35], v213 offset:61952
    s_mov_b64 exec, -1
    v_exp_f32 v48, v48
    v_exp_f32 v49, v49
    v_exp_f32 v50, v50
    v_mfma_f32_32x32x16_bf16 v[60:75], v[24:27], v[8:11], 0
    v_exp_f32 v51, v51
    v_cvt_pk_bf16_f32 v76, v44, v45
    v_cvt_pk_bf16_f32 v77, v46, v47
    v_cvt_pk_bf16_f32 v78, v48, v49
    v_cvt_pk_bf16_f32 v79, v50, v51
    v_exp_f32 v52, v52
    v_exp_f32 v53, v53
    v_exp_f32 v54, v54
    v_mfma_f32_32x32x16_bf16 v[84:99], v[36:39], v[76:79], v[84:99]
    v_exp_f32 v55, v55
    v_exp_f32 v56, v56
    v_exp_f32 v57, v57
    v_exp_f32 v58, v58
    v_exp_f32 v59, v59
    v_cvt_pk_bf16_f32 v80, v52, v53
    v_cvt_pk_bf16_f32 v81, v54, v55
    v_cvt_pk_bf16_f32 v82, v56, v57
    v_cvt_pk_bf16_f32 v83, v58, v59
    v_exp_f32 v60, v60
    v_exp_f32 v61, v61
    v_mfma_f32_32x32x16_bf16 v[84:99], v[40:43], v[80:83], v[84:99]
    v_exp_f32 v62, v62
    v_exp_f32 v63, v63
    v_exp_f32 v64, v64
    v_exp_f32 v65, v65
    v_exp_f32 v66, v66
    v_mfma_f32_32x32x16_bf16 v[44:59], v[24:27], v[12:15], 0
    v_exp_f32 v67, v67
    v_cvt_pk_bf16_f32 v76, v60, v61
    v_cvt_pk_bf16_f32 v77, v62, v63
    v_cvt_pk_bf16_f32 v78, v64, v65
    v_cvt_pk_bf16_f32 v79, v66, v67
    v_exp_f32 v68, v68
    v_exp_f32 v69, v69
    v_exp_f32 v70, v70
    v_mfma_f32_32x32x16_bf16 v[100:115], v[36:39], v[76:79], v[100:115]
    v_exp_f32 v71, v71
    v_exp_f32 v72, v72
    v_exp_f32 v73, v73
    v_exp_f32 v74, v74
    v_exp_f32 v75, v75
    v_cvt_pk_bf16_f32 v80, v68, v69
    v_cvt_pk_bf16_f32 v81, v70, v71
    v_cvt_pk_bf16_f32 v82, v72, v73
    v_cvt_pk_bf16_f32 v83, v74, v75
    v_exp_f32 v44, v44
    v_exp_f32 v45, v45
    v_mfma_f32_32x32x16_bf16 v[100:115], v[40:43], v[80:83], v[100:115]
    v_exp_f32 v46, v46
    v_exp_f32 v47, v47
    v_exp_f32 v48, v48
    v_exp_f32 v49, v49
    v_exp_f32 v50, v50
    v_mfma_f32_32x32x16_bf16 v[60:75], v[24:27], v[16:19], 0
    buffer_load_dword v216, v214, s[12:15], s60 offen
    v_exp_f32 v51, v51
    v_cvt_pk_bf16_f32 v76, v44, v45
    v_cvt_pk_bf16_f32 v77, v46, v47
    v_cvt_pk_bf16_f32 v78, v48, v49
    v_cvt_pk_bf16_f32 v79, v50, v51
    v_exp_f32 v52, v52
    v_exp_f32 v53, v53
    v_exp_f32 v54, v54
    v_mfma_f32_32x32x16_bf16 v[116:131], v[36:39], v[76:79], v[116:131]
    v_exp_f32 v55, v55
    v_exp_f32 v56, v56
    v_exp_f32 v57, v57
    v_exp_f32 v58, v58
    v_exp_f32 v59, v59
    v_cvt_pk_bf16_f32 v80, v52, v53
    v_cvt_pk_bf16_f32 v81, v54, v55
    v_cvt_pk_bf16_f32 v82, v56, v57
    v_cvt_pk_bf16_f32 v83, v58, v59
    v_exp_f32 v60, v60
    v_exp_f32 v61, v61
    v_mfma_f32_32x32x16_bf16 v[116:131], v[40:43], v[80:83], v[116:131]
    v_exp_f32 v62, v62
    v_exp_f32 v63, v63
    v_exp_f32 v64, v64
    v_exp_f32 v65, v65
    v_exp_f32 v66, v66
    s_waitcnt lgkmcnt(0)
    v_mfma_f32_32x32x16_bf16 v[44:59], v[20:23], v[4:7], 0
    v_exp_f32 v67, v67
    v_cvt_pk_bf16_f32 v76, v60, v61
    v_cvt_pk_bf16_f32 v77, v62, v63
    v_cvt_pk_bf16_f32 v78, v64, v65
    v_cvt_pk_bf16_f32 v79, v66, v67
    v_exp_f32 v68, v68
    v_exp_f32 v69, v69
    v_exp_f32 v70, v70
    v_mfma_f32_32x32x16_bf16 v[132:147], v[36:39], v[76:79], v[132:147]
    v_exp_f32 v71, v71
    v_exp_f32 v72, v72
    v_exp_f32 v73, v73
    v_exp_f32 v74, v74
    v_exp_f32 v75, v75
    v_cvt_pk_bf16_f32 v80, v68, v69
    v_cvt_pk_bf16_f32 v81, v70, v71
    v_cvt_pk_bf16_f32 v82, v72, v73
    v_cvt_pk_bf16_f32 v83, v74, v75
    v_exp_f32 v44, v44
    v_exp_f32 v45, v45
    v_mfma_f32_32x32x16_bf16 v[132:147], v[40:43], v[80:83], v[132:147]
    ds_read_b128 v[24:27], v212 offset:63488
    v_exp_f32 v46, v46
    v_exp_f32 v47, v47
    s_mov_b64 exec, s[58:59]
    ds_read_b128 v[36:39], v213 offset:63488
    ds_read_b128 v[40:43], v213 offset:64000
    s_mov_b64 exec, -1
    v_exp_f32 v48, v48
    v_exp_f32 v49, v49
    v_exp_f32 v50, v50
    v_mfma_f32_32x32x16_bf16 v[60:75], v[20:23], v[8:11], 0
    v_exp_f32 v51, v51
    v_cvt_pk_bf16_f32 v76, v44, v45
    v_cvt_pk_bf16_f32 v77, v46, v47
    v_cvt_pk_bf16_f32 v78, v48, v49
    v_cvt_pk_bf16_f32 v79, v50, v51
    v_exp_f32 v52, v52
    v_exp_f32 v53, v53
    v_exp_f32 v54, v54
    v_mfma_f32_32x32x16_bf16 v[84:99], v[28:31], v[76:79], v[84:99]
    v_exp_f32 v55, v55
    v_exp_f32 v56, v56
    v_exp_f32 v57, v57
    v_exp_f32 v58, v58
    v_exp_f32 v59, v59
    v_cvt_pk_bf16_f32 v80, v52, v53
    v_cvt_pk_bf16_f32 v81, v54, v55
    v_cvt_pk_bf16_f32 v82, v56, v57
    v_cvt_pk_bf16_f32 v83, v58, v59
    v_exp_f32 v60, v60
    v_exp_f32 v61, v61
    v_mfma_f32_32x32x16_bf16 v[84:99], v[32:35], v[80:83], v[84:99]
    v_exp_f32 v62, v62
    v_exp_f32 v63, v63
    v_exp_f32 v64, v64
    v_exp_f32 v65, v65
    v_exp_f32 v66, v66
    v_mfma_f32_32x32x16_bf16 v[44:59], v[20:23], v[12:15], 0
    v_exp_f32 v67, v67
    v_cvt_pk_bf16_f32 v76, v60, v61
    v_cvt_pk_bf16_f32 v77, v62, v63
    v_cvt_pk_bf16_f32 v78, v64, v65
    v_cvt_pk_bf16_f32 v79, v66, v67
    v_exp_f32 v68, v68
    v_exp_f32 v69, v69
    v_exp_f32 v70, v70
    v_mfma_f32_32x32x16_bf16 v[100:115], v[28:31], v[76:79], v[100:115]
    v_exp_f32 v71, v71
    v_exp_f32 v72, v72
    v_exp_f32 v73, v73
    v_exp_f32 v74, v74
    v_exp_f32 v75, v75
    v_cvt_pk_bf16_f32 v80, v68, v69
    v_cvt_pk_bf16_f32 v81, v70, v71
    v_cvt_pk_bf16_f32 v82, v72, v73
    v_cvt_pk_bf16_f32 v83, v74, v75
    v_exp_f32 v44, v44
    v_exp_f32 v45, v45
    v_mfma_f32_32x32x16_bf16 v[100:115], v[32:35], v[80:83], v[100:115]
    v_exp_f32 v46, v46
    v_exp_f32 v47, v47
    v_exp_f32 v48, v48
    v_exp_f32 v49, v49
    v_exp_f32 v50, v50
    v_mfma_f32_32x32x16_bf16 v[60:75], v[20:23], v[16:19], 0
    v_exp_f32 v51, v51
    v_cvt_pk_bf16_f32 v76, v44, v45
    v_cvt_pk_bf16_f32 v77, v46, v47
    v_cvt_pk_bf16_f32 v78, v48, v49
    v_cvt_pk_bf16_f32 v79, v50, v51
    v_exp_f32 v52, v52
    v_exp_f32 v53, v53
    v_exp_f32 v54, v54
    v_mfma_f32_32x32x16_bf16 v[116:131], v[28:31], v[76:79], v[116:131]
    v_exp_f32 v55, v55
    v_exp_f32 v56, v56
    v_exp_f32 v57, v57
    v_exp_f32 v58, v58
    v_exp_f32 v59, v59
    v_cvt_pk_bf16_f32 v80, v52, v53
    v_cvt_pk_bf16_f32 v81, v54, v55
    v_cvt_pk_bf16_f32 v82, v56, v57
    v_cvt_pk_bf16_f32 v83, v58, v59
    v_exp_f32 v60, v60
    v_exp_f32 v61, v61
    v_mfma_f32_32x32x16_bf16 v[116:131], v[32:35], v[80:83], v[116:131]
    v_exp_f32 v62, v62
    v_exp_f32 v63, v63
    v_exp_f32 v64, v64
    v_exp_f32 v65, v65
    v_exp_f32 v66, v66
    s_waitcnt lgkmcnt(0)
    v_mfma_f32_32x32x16_bf16 v[44:59], v[24:27], v[4:7], 0
    v_exp_f32 v67, v67
    v_cvt_pk_bf16_f32 v76, v60, v61
    v_cvt_pk_bf16_f32 v77, v62, v63
    v_cvt_pk_bf16_f32 v78, v64, v65
    v_cvt_pk_bf16_f32 v79, v66, v67
    v_exp_f32 v68, v68
    v_exp_f32 v69, v69
    v_exp_f32 v70, v70
    v_mfma_f32_32x32x16_bf16 v[132:147], v[28:31], v[76:79], v[132:147]
    v_exp_f32 v71, v71
    v_exp_f32 v72, v72
    v_exp_f32 v73, v73
    v_exp_f32 v74, v74
    v_exp_f32 v75, v75
    v_cvt_pk_bf16_f32 v80, v68, v69
    v_cvt_pk_bf16_f32 v81, v70, v71
    v_cvt_pk_bf16_f32 v82, v72, v73
    v_cvt_pk_bf16_f32 v83, v74, v75
    v_exp_f32 v44, v44
    v_exp_f32 v45, v45
    v_mfma_f32_32x32x16_bf16 v[132:147], v[32:35], v[80:83], v[132:147]
    v_exp_f32 v46, v46
    v_exp_f32 v47, v47
    v_exp_f32 v48, v48
    v_exp_f32 v49, v49
    v_exp_f32 v50, v50
    v_mfma_f32_32x32x16_bf16 v[60:75], v[24:27], v[8:11], 0
    v_exp_f32 v51, v51
    v_cvt_pk_bf16_f32 v76, v44, v45
    v_cvt_pk_bf16_f32 v77, v46, v47
    v_cvt_pk_bf16_f32 v78, v48, v49
    v_cvt_pk_bf16_f32 v79, v50, v51
    v_exp_f32 v52, v52
    v_exp_f32 v53, v53
    v_exp_f32 v54, v54
    v_mfma_f32_32x32x16_bf16 v[84:99], v[36:39], v[76:79], v[84:99]
    v_exp_f32 v55, v55
    v_exp_f32 v56, v56
    v_exp_f32 v57, v57
    v_exp_f32 v58, v58
    v_exp_f32 v59, v59
    v_cvt_pk_bf16_f32 v80, v52, v53
    v_cvt_pk_bf16_f32 v81, v54, v55
    v_cvt_pk_bf16_f32 v82, v56, v57
    v_cvt_pk_bf16_f32 v83, v58, v59
    v_exp_f32 v60, v60
    v_exp_f32 v61, v61
    v_mfma_f32_32x32x16_bf16 v[84:99], v[40:43], v[80:83], v[84:99]
    v_exp_f32 v62, v62
    v_exp_f32 v63, v63
    v_exp_f32 v64, v64
    v_exp_f32 v65, v65
    v_exp_f32 v66, v66
    v_mfma_f32_32x32x16_bf16 v[44:59], v[24:27], v[12:15], 0
    v_exp_f32 v67, v67
    v_cvt_pk_bf16_f32 v76, v60, v61
    v_cvt_pk_bf16_f32 v77, v62, v63
    v_cvt_pk_bf16_f32 v78, v64, v65
    v_cvt_pk_bf16_f32 v79, v66, v67
    v_exp_f32 v68, v68
    v_exp_f32 v69, v69
    v_exp_f32 v70, v70
    v_mfma_f32_32x32x16_bf16 v[100:115], v[36:39], v[76:79], v[100:115]
    v_exp_f32 v71, v71
    v_exp_f32 v72, v72
    v_exp_f32 v73, v73
    v_exp_f32 v74, v74
    v_exp_f32 v75, v75
    v_cvt_pk_bf16_f32 v80, v68, v69
    v_cvt_pk_bf16_f32 v81, v70, v71
    v_cvt_pk_bf16_f32 v82, v72, v73
    v_cvt_pk_bf16_f32 v83, v74, v75
    v_exp_f32 v44, v44
    v_exp_f32 v45, v45
    v_mfma_f32_32x32x16_bf16 v[100:115], v[40:43], v[80:83], v[100:115]
    v_exp_f32 v46, v46
    v_exp_f32 v47, v47
    v_exp_f32 v48, v48
    v_exp_f32 v49, v49
    v_exp_f32 v50, v50
    v_mfma_f32_32x32x16_bf16 v[60:75], v[24:27], v[16:19], 0
    v_exp_f32 v51, v51
    v_cvt_pk_bf16_f32 v76, v44, v45
    v_cvt_pk_bf16_f32 v77, v46, v47
    v_cvt_pk_bf16_f32 v78, v48, v49
    v_cvt_pk_bf16_f32 v79, v50, v51
    v_exp_f32 v52, v52
    v_exp_f32 v53, v53
    v_exp_f32 v54, v54
    v_mfma_f32_32x32x16_bf16 v[116:131], v[36:39], v[76:79], v[116:131]
    v_exp_f32 v55, v55
    v_exp_f32 v56, v56
    v_exp_f32 v57, v57
    v_exp_f32 v58, v58
    v_exp_f32 v59, v59
    v_cvt_pk_bf16_f32 v80, v52, v53
    v_cvt_pk_bf16_f32 v81, v54, v55
    v_cvt_pk_bf16_f32 v82, v56, v57
    v_cvt_pk_bf16_f32 v83, v58, v59
    v_exp_f32 v60, v60
    v_exp_f32 v61, v61
    v_mfma_f32_32x32x16_bf16 v[116:131], v[40:43], v[80:83], v[116:131]
    v_exp_f32 v62, v62
    v_exp_f32 v63, v63
    v_exp_f32 v64, v64
    v_exp_f32 v65, v65
    v_exp_f32 v66, v66
    v_exp_f32 v67, v67
    v_cvt_pk_bf16_f32 v76, v60, v61
    v_cvt_pk_bf16_f32 v77, v62, v63
    v_cvt_pk_bf16_f32 v78, v64, v65
    v_cvt_pk_bf16_f32 v79, v66, v67
    v_exp_f32 v68, v68
    v_exp_f32 v69, v69
    v_exp_f32 v70, v70
    v_mfma_f32_32x32x16_bf16 v[132:147], v[36:39], v[76:79], v[132:147]
    v_exp_f32 v71, v71
    v_exp_f32 v72, v72
    v_exp_f32 v73, v73
    v_exp_f32 v74, v74
    v_exp_f32 v75, v75
    v_cvt_pk_bf16_f32 v80, v68, v69
    v_cvt_pk_bf16_f32 v81, v70, v71
    v_cvt_pk_bf16_f32 v82, v72, v73
    v_cvt_pk_bf16_f32 v83, v74, v75
    s_waitcnt vmcnt(2)
    s_branch L_kb_fin
L_kb_slow:
    s_mov_b32 m0, s31
    s_add_u32 s32, s30, 4096
    buffer_load_dwordx4 v2, s[16:19], s30 offen offset:0 sc1 lds
    buffer_load_dwordx4 v2, s[16:19], s30 offen offset:1024 sc1 lds
    buffer_load_dwordx4 v2, s[16:19], s30 offen offset:2048 sc1 lds
    buffer_load_dwordx4 v2, s[16:19], s30 offen offset:3072 sc1 lds
    s_add_u32 m0, s31, 4096
    s_add_u32 s30, s30, 16384
    buffer_load_dwordx4 v2, s[16:19], s32 offen offset:0 sc1 lds
    buffer_load_dwordx4 v2, s[16:19], s32 offen offset:1024 sc1 lds
    buffer_load_dwordx4 v2, s[16:19], s32 offen offset:2048 sc1 lds
    buffer_load_dwordx4 v2, s[16:19], s32 offen offset:3072 sc1 lds
    s_add_u32 s31, s31, 16384
    s_mov_b32 m0, s31
    s_add_u32 s32, s30, 4096
    buffer_load_dwordx4 v2, s[16:19], s30 offen offset:0 sc1 lds
    buffer_load_dwordx4 v2, s[16:19], s30 offen offset:1024 sc1 lds
    buffer_load_dwordx4 v2, s[16:19], s30 offen offset:2048 sc1 lds
    buffer_load_dwordx4 v2, s[16:19], s30 offen offset:3072 sc1 lds
    s_add_u32 m0, s31, 4096
    s_add_u32 s30, s30, 16384
    buffer_load_dwordx4 v2, s[16:19], s32 offen offset:0 sc1 lds
    buffer_load_dwordx4 v2, s[16:19], s32 offen offset:1024 sc1 lds
    buffer_load_dwordx4 v2, s[16:19], s32 offen offset:2048 sc1 lds
    buffer_load_dwordx4 v2, s[16:19], s32 offen offset:3072 sc1 lds
    s_add_u32 s31, s31, 16384
    s_mov_b32 m0, s31
    s_add_u32 s32, s30, 4096
    buffer_load_dwordx4 v2, s[16:19], s30 offen offset:0 sc1 lds
    buffer_load_dwordx4 v2, s[16:19], s30 offen offset:1024 sc1 lds
    buffer_load_dwordx4 v2, s[16:19], s30 offen offset:2048 sc1 lds
    buffer_load_dwordx4 v2, s[16:19], s30 offen offset:3072 sc1 lds
    s_add_u32 m0, s31, 4096
    s_add_u32 s30, s30, 16384
    buffer_load_dwordx4 v2, s[16:19], s32 offen offset:0 sc1 lds
    buffer_load_dwordx4 v2, s[16:19], s32 offen offset:1024 sc1 lds
    buffer_load_dwordx4 v2, s[16:19], s32 offen offset:2048 sc1 lds
    buffer_load_dwordx4 v2, s[16:19], s32 offen offset:3072 sc1 lds
    s_add_u32 s31, s31, 16384
    v_mov_b32 v148, -1
    v_mov_b32 v149, -1
    v_mov_b32 v150, -1
    v_mov_b32 v151, -1
    v_lshlrev_b32 v152, 2, v1
    s_lshl_b32 s64, s2, 13
    s_lshl_b32 s65, s22, 11
    s_add_u32 s64, s64, s65
    s_lshl_b32 s66, s2, 10
    s_lshl_b32 s65, s22, 8
    s_add_u32 s66, s66, s65
    s_add_u32 s66, s66, 9437184
    s_add_u32 s65, s64, 7340032
    buffer_store_dwordx4 v[148:151], v2, s[16:19], s65 offen offset:0 sc1
    s_add_u32 s65, s64, 7340032
    buffer_store_dwordx4 v[148:151], v2, s[16:19], s65 offen offset:1024 sc1
    s_add_u32 s65, s64, 12582912
    buffer_store_dwordx4 v[148:151], v2, s[16:19], s65 offen offset:0 sc1
    s_add_u32 s65, s64, 12582912
    buffer_store_dwordx4 v[148:151], v2, s[16:19], s65 offen offset:1024 sc1
    s_add_u32 s65, s64, 14680064
    buffer_store_dwordx4 v[148:151], v2, s[16:19], s65 offen offset:0 sc1
    s_add_u32 s65, s64, 14680064
    buffer_store_dwordx4 v[148:151], v2, s[16:19], s65 offen offset:1024 sc1
    buffer_store_dword v148, v152, s[16:19], s66 offen sc1
    s_waitcnt vmcnt(0)
    s_barrier
    s_cmp_lg_u32 s22, 0
    s_cbranch_scc1 L_fa2
    s_and_b32 s65, s2, 15
    s_lshl_b32 s65, s65, 8
    s_add_u32 s65, s65, 6361088
    v_mov_b32 v153, 0
    v_mov_b32 v154, 1
    s_mov_b64 exec, 1
    buffer_atomic_add v154, v153, s[16:19], s65 offen sc1
    s_mov_b64 exec, -1
L_fa2:
    v_mov_b32 v233, 0
    v_mov_b32 v218, 0xff800000
    v_mov_b32 v219, 0xff800000
    v_mov_b32 v220, 0xff800000
    v_mov_b32 v221, 0xff800000
    s_mov_b32 s39, 0
    v_mov_b32 v222, v2
L_kb_p1:
    ds_read_b128 v[20:23], v222
    v_add_u32 v222, 0x800, v222
    s_waitcnt lgkmcnt(0)
    v_mfma_f32_32x32x16_bf16 v[44:59], v[20:23], v[4:7], 0
    v_mfma_f32_32x32x16_bf16 v[60:75], v[20:23], v[8:11], 0
    s_nop 10
    v_max3_f32 v218, v44, v45, v218
    v_max3_f32 v218, v46, v47, v218
    v_max3_f32 v218, v48, v49, v218
    v_max3_f32 v218, v50, v51, v218
    v_max3_f32 v218, v52, v53, v218
    v_max3_f32 v218, v54, v55, v218
    v_max3_f32 v218, v56, v57, v218
    v_max3_f32 v218, v58, v59, v218
    v_max3_f32 v219, v60, v61, v219
    v_max3_f32 v219, v62, v63, v219
    v_max3_f32 v219, v64, v65, v219
    v_max3_f32 v219, v66, v67, v219
    v_max3_f32 v219, v68, v69, v219
    v_max3_f32 v219, v70, v71, v219
    v_max3_f32 v219, v72, v73, v219
    v_max3_f32 v219, v74, v75, v219
    v_mfma_f32_32x32x16_bf16 v[44:59], v[20:23], v[12:15], 0
    v_mfma_f32_32x32x16_bf16 v[60:75], v[20:23], v[16:19], 0
    s_nop 10
    v_max3_f32 v220, v44, v45, v220
    v_max3_f32 v220, v46, v47, v220
    v_max3_f32 v220, v48, v49, v220
    v_max3_f32 v220, v50, v51, v220
    v_max3_f32 v220, v52, v53, v220
    v_max3_f32 v220, v54, v55, v220
    v_max3_f32 v220, v56, v57, v220
    v_max3_f32 v220, v58, v59, v220
    v_max3_f32 v221, v60, v61, v221
    v_max3_f32 v221, v62, v63, v221
    v_max3_f32 v221, v64, v65, v221
    v_max3_f32 v221, v66, v67, v221
    v_max3_f32 v221, v68, v69, v221
    v_max3_f32 v221, v70, v71, v221
    v_max3_f32 v221, v72, v73, v221
    v_max3_f32 v221, v74, v75, v221
    s_add_u32 s39, s39, 1
    s_cmp_lt_u32 s39, 64
    s_cbranch_scc1 L_kb_p1
    v_mov_b32 v222, v218
    s_nop 1
    v_permlane32_swap_b32 v218, v222
    v_max_f32 v218, v218, v222
    v_sub_f32 v218, 0, v218
    v_mov_b32 v148, v218
    v_mov_b32 v149, v218
    v_mov_b32 v150, v218
    v_mov_b32 v151, v218
    v_mov_b32 v152, v218
    v_mov_b32 v153, v218
    v_mov_b32 v154, v218
    v_mov_b32 v155, v218
    v_mov_b32 v156, v218
    v_mov_b32 v157, v218
    v_mov_b32 v158, v218
    v_mov_b32 v159, v218
    v_mov_b32 v160, v218
    v_mov_b32 v161, v218
    v_mov_b32 v162, v218
    v_mov_b32 v163, v218
    v_mov_b32 v222, v219
    s_nop 1
    v_permlane32_swap_b32 v219, v222
    v_max_f32 v219, v219, v222
    v_sub_f32 v219, 0, v219
    v_mov_b32 v164, v219
    v_mov_b32 v165, v219
    v_mov_b32 v166, v219
    v_mov_b32 v167, v219
    v_mov_b32 v168, v219
    v_mov_b32 v169, v219
    v_mov_b32 v170, v219
    v_mov_b32 v171, v219
    v_mov_b32 v172, v219
    v_mov_b32 v173, v219
    v_mov_b32 v174, v219
    v_mov_b32 v175, v219
    v_mov_b32 v176, v219
    v_mov_b32 v177, v219
    v_mov_b32 v178, v219
    v_mov_b32 v179, v219
    v_mov_b32 v222, v220
    s_nop 1
    v_permlane32_swap_b32 v220, v222
    v_max_f32 v220, v220, v222
    v_sub_f32 v220, 0, v220
    v_mov_b32 v180, v220
    v_mov_b32 v181, v220
    v_mov_b32 v182, v220
    v_mov_b32 v183, v220
    v_mov_b32 v184, v220
    v_mov_b32 v185, v220
    v_mov_b32 v186, v220
    v_mov_b32 v187, v220
    v_mov_b32 v188, v220
    v_mov_b32 v189, v220
    v_mov_b32 v190, v220
    v_mov_b32 v191, v220
    v_mov_b32 v192, v220
    v_mov_b32 v193, v220
    v_mov_b32 v194, v220
    v_mov_b32 v195, v220
    v_mov_b32 v222, v221
    s_nop 1
    v_permlane32_swap_b32 v221, v222
    v_max_f32 v221, v221, v222
    v_sub_f32 v221, 0, v221
    v_mov_b32 v196, v221
    v_mov_b32 v197, v221
    v_mov_b32 v198, v221
    v_mov_b32 v199, v221
    v_mov_b32 v200, v221
    v_mov_b32 v201, v221
    v_mov_b32 v202, v221
    v_mov_b32 v203, v221
    v_mov_b32 v204, v221
    v_mov_b32 v205, v221
    v_mov_b32 v206, v221
    v_mov_b32 v207, v221
    v_mov_b32 v208, v221
    v_mov_b32 v209, v221
    v_mov_b32 v210, v221
    v_mov_b32 v211, v221
    ds_read_b128 v[20:23], v212
    s_mov_b64 exec, s[58:59]
    ds_read_b128 v[28:31], v213
    ds_read_b128 v[32:35], v213 offset:512
    s_mov_b64 exec, -1
    s_waitcnt lgkmcnt(0)
    v_mfma_f32_32x32x16_bf16 v[44:59], v[20:23], v[4:7], v[148:163]
    s_mov_b32 s39, 0
    s_nop 11
.p2align 6
L_kb_s_loop:
    v_exp_f32 v44, v44
    v_exp_f32 v45, v45
    v_mfma_f32_32x32x16_bf16 v[132:147], v[40:43], v[80:83], v[132:147]
    ds_read_b128 v[24:27], v212 offset:2048
    v_exp_f32 v46, v46
    v_exp_f32 v47, v47
    s_mov_b64 exec, s[58:59]
    ds_read_b128 v[36:39], v213 offset:2048
    ds_read_b128 v[40:43], v213 offset:2560
    s_mov_b64 exec, -1
    v_exp_f32 v48, v48
    v_exp_f32 v49, v49
    v_exp_f32 v50, v50
    v_mfma_f32_32x32x16_bf16 v[60:75], v[20:23], v[8:11], v[164:179]
    v_exp_f32 v51, v51
    v_cvt_pk_bf16_f32 v76, v44, v45
    v_cvt_pk_bf16_f32 v77, v46, v47
    v_cvt_pk_bf16_f32 v78, v48, v49
    v_cvt_pk_bf16_f32 v79, v50, v51
    v_exp_f32 v52, v52
    v_exp_f32 v53, v53
    v_exp_f32 v54, v54
    v_mfma_f32_32x32x16_bf16 v[84:99], v[28:31], v[76:79], v[84:99]
    v_exp_f32 v55, v55
    v_exp_f32 v56, v56
    v_exp_f32 v57, v57
    v_exp_f32 v58, v58
    v_exp_f32 v59, v59
    v_cvt_pk_bf16_f32 v80, v52, v53
    v_cvt_pk_bf16_f32 v81, v54, v55
    v_cvt_pk_bf16_f32 v82, v56, v57
    v_cvt_pk_bf16_f32 v83, v58, v59
    v_exp_f32 v60, v60
    v_exp_f32 v61, v61
    v_mfma_f32_32x32x16_bf16 v[84:99], v[32:35], v[80:83], v[84:99]
    v_exp_f32 v62, v62
    v_exp_f32 v63, v63
    v_exp_f32 v64, v64
    v_exp_f32 v65, v65
    v_exp_f32 v66, v66
    v_mfma_f32_32x32x16_bf16 v[44:59], v[20:23], v[12:15], v[180:195]
    v_exp_f32 v67, v67
    v_cvt_pk_bf16_f32 v76, v60, v61
    v_cvt_pk_bf16_f32 v77, v62, v63
    v_cvt_pk_bf16_f32 v78, v64, v65
    v_cvt_pk_bf16_f32 v79, v66, v67
    v_exp_f32 v68, v68
    v_exp_f32 v69, v69
    v_exp_f32 v70, v70
    v_mfma_f32_32x32x16_bf16 v[100:115], v[28:31], v[76:79], v[100:115]
    v_exp_f32 v71, v71
    v_exp_f32 v72, v72
    v_exp_f32 v73, v73
    v_exp_f32 v74, v74
    v_exp_f32 v75, v75
    v_cvt_pk_bf16_f32 v80, v68, v69
    v_cvt_pk_bf16_f32 v81, v70, v71
    v_cvt_pk_bf16_f32 v82, v72, v73
    v_cvt_pk_bf16_f32 v83, v74, v75
    v_exp_f32 v44, v44
    v_exp_f32 v45, v45
    v_mfma_f32_32x32x16_bf16 v[100:115], v[32:35], v[80:83], v[100:115]
    v_exp_f32 v46, v46
    v_exp_f32 v47, v47
    v_exp_f32 v48, v48
    v_exp_f32 v49, v49
    v_exp_f32 v50, v50
    v_mfma_f32_32x32x16_bf16 v[60:75], v[20:23], v[16:19], v[196:211]
    v_exp_f32 v51, v51
    v_cvt_pk_bf16_f32 v76, v44, v45
    v_cvt_pk_bf16_f32 v77, v46, v47
    v_cvt_pk_bf16_f32 v78, v48, v49
    v_cvt_pk_bf16_f32 v79, v50, v51
    v_exp_f32 v52, v52
    v_exp_f32 v53, v53
    v_exp_f32 v54, v54
    v_mfma_f32_32x32x16_bf16 v[116:131], v[28:31], v[76:79], v[116:131]
    v_exp_f32 v55, v55
    v_exp_f32 v56, v56
    v_exp_f32 v57, v57
    v_exp_f32 v58, v58
    v_exp_f32 v59, v59
    v_cvt_pk_bf16_f32 v80, v52, v53
    v_cvt_pk_bf16_f32 v81, v54, v55
    v_cvt_pk_bf16_f32 v82, v56, v57
    v_cvt_pk_bf16_f32 v83, v58, v59
    v_exp_f32 v60, v60
    v_exp_f32 v61, v61
    v_mfma_f32_32x32x16_bf16 v[116:131], v[32:35], v[80:83], v[116:131]
    v_exp_f32 v62, v62
    v_exp_f32 v63, v63
    v_exp_f32 v64, v64
    v_exp_f32 v65, v65
    v_exp_f32 v66, v66
    s_waitcnt lgkmcnt(0)
    v_mfma_f32_32x32x16_bf16 v[44:59], v[24:27], v[4:7], v[148:163]
    v_exp_f32 v67, v67
    v_cvt_pk_bf16_f32 v76, v60, v61
    v_cvt_pk_bf16_f32 v77, v62, v63
    v_cvt_pk_bf16_f32 v78, v64, v65
    v_cvt_pk_bf16_f32 v79, v66, v67
    v_exp_f32 v68, v68
    v_exp_f32 v69, v69
    v_exp_f32 v70, v70
    v_mfma_f32_32x32x16_bf16 v[132:147], v[28:31], v[76:79], v[132:147]
    v_exp_f32 v71, v71
    v_exp_f32 v72, v72
    v_exp_f32 v73, v73
    v_exp_f32 v74, v74
    v_exp_f32 v75, v75
    v_cvt_pk_bf16_f32 v80, v68, v69
    v_cvt_pk_bf16_f32 v81, v70, v71
    v_cvt_pk_bf16_f32 v82, v72, v73
    v_cvt_pk_bf16_f32 v83, v74, v75
    v_exp_f32 v44, v44
    v_exp_f32 v45, v45
    v_mfma_f32_32x32x16_bf16 v[132:147], v[32:35], v[80:83], v[132:147]
    ds_read_b128 v[20:23], v212 offset:4096
    v_exp_f32 v46, v46
    v_exp_f32 v47, v47
    s_mov_b64 exec, s[58:59]
    ds_read_b128 v[28:31], v213 offset:4096
    ds_read_b128 v[32:35], v213 offset:4608
    s_mov_b64 exec, -1
    v_exp_f32 v48, v48
    v_exp_f32 v49, v49
    v_exp_f32 v50, v50
    v_mfma_f32_32x32x16_bf16 v[60:75], v[24:27], v[8:11], v[164:179]
    v_exp_f32 v51, v51
    v_cvt_pk_bf16_f32 v76, v44, v45
    v_cvt_pk_bf16_f32 v77, v46, v47
    v_cvt_pk_bf16_f32 v78, v48, v49
    v_cvt_pk_bf16_f32 v79, v50, v51
    v_exp_f32 v52, v52
    v_exp_f32 v53, v53
    v_exp_f32 v54, v54
    v_mfma_f32_32x32x16_bf16 v[84:99], v[36:39], v[76:79], v[84:99]
    v_exp_f32 v55, v55
    v_exp_f32 v56, v56
    v_exp_f32 v57, v57
    v_exp_f32 v58, v58
    v_exp_f32 v59, v59
    v_cvt_pk_bf16_f32 v80, v52, v53
    v_cvt_pk_bf16_f32 v81, v54, v55
    v_cvt_pk_bf16_f32 v82, v56, v57
    v_cvt_pk_bf16_f32 v83, v58, v59
    v_exp_f32 v60, v60
    v_exp_f32 v61, v61
    v_mfma_f32_32x32x16_bf16 v[84:99], v[40:43], v[80:83], v[84:99]
    v_exp_f32 v62, v62
    v_exp_f32 v63, v63
    v_exp_f32 v64, v64
    v_exp_f32 v65, v65
    v_exp_f32 v66, v66
    v_mfma_f32_32x32x16_bf16 v[44:59], v[24:27], v[12:15], v[180:195]
    v_exp_f32 v67, v67
    v_cvt_pk_bf16_f32 v76, v60, v61
    v_cvt_pk_bf16_f32 v77, v62, v63
    v_cvt_pk_bf16_f32 v78, v64, v65
    v_cvt_pk_bf16_f32 v79, v66, v67
    v_exp_f32 v68, v68
    v_exp_f32 v69, v69
    v_exp_f32 v70, v70
    v_mfma_f32_32x32x16_bf16 v[100:115], v[36:39], v[76:79], v[100:115]
    v_exp_f32 v71, v71
    v_exp_f32 v72, v72
    v_exp_f32 v73, v73
    v_exp_f32 v74, v74
    v_exp_f32 v75, v75
    v_cvt_pk_bf16_f32 v80, v68, v69
    v_cvt_pk_bf16_f32 v81, v70, v71
    v_cvt_pk_bf16_f32 v82, v72, v73
    v_cvt_pk_bf16_f32 v83, v74, v75
    v_exp_f32 v44, v44
    v_exp_f32 v45, v45
    v_mfma_f32_32x32x16_bf16 v[100:115], v[40:43], v[80:83], v[100:115]
    v_exp_f32 v46, v46
    v_exp_f32 v47, v47
    v_exp_f32 v48, v48
    v_exp_f32 v49, v49
    v_exp_f32 v50, v50
    v_mfma_f32_32x32x16_bf16 v[60:75], v[24:27], v[16:19], v[196:211]
    v_exp_f32 v51, v51
    v_cvt_pk_bf16_f32 v76, v44, v45
    v_cvt_pk_bf16_f32 v77, v46, v47
    v_cvt_pk_bf16_f32 v78, v48, v49
    v_cvt_pk_bf16_f32 v79, v50, v51
    v_exp_f32 v52, v52
    v_exp_f32 v53, v53
    v_exp_f32 v54, v54
    v_mfma_f32_32x32x16_bf16 v[116:131], v[36:39], v[76:79], v[116:131]
    v_exp_f32 v55, v55
    v_exp_f32 v56, v56
    v_exp_f32 v57, v57
    v_exp_f32 v58, v58
    v_exp_f32 v59, v59
    v_cvt_pk_bf16_f32 v80, v52, v53
    v_cvt_pk_bf16_f32 v81, v54, v55
    v_cvt_pk_bf16_f32 v82, v56, v57
    v_cvt_pk_bf16_f32 v83, v58, v59
    v_exp_f32 v60, v60
    v_exp_f32 v61, v61
    v_mfma_f32_32x32x16_bf16 v[116:131], v[40:43], v[80:83], v[116:131]
    v_exp_f32 v62, v62
    v_exp_f32 v63, v63
    v_exp_f32 v64, v64
    v_exp_f32 v65, v65
    v_exp_f32 v66, v66
    s_waitcnt lgkmcnt(0)
    v_mfma_f32_32x32x16_bf16 v[44:59], v[20:23], v[4:7], v[148:163]
    v_exp_f32 v67, v67
    v_cvt_pk_bf16_f32 v76, v60, v61
    v_cvt_pk_bf16_f32 v77, v62, v63
    v_cvt_pk_bf16_f32 v78, v64, v65
    v_cvt_pk_bf16_f32 v79, v66, v67
    v_exp_f32 v68, v68
    v_exp_f32 v69, v69
    v_exp_f32 v70, v70
    v_mfma_f32_32x32x16_bf16 v[132:147], v[36:39], v[76:79], v[132:147]
    v_exp_f32 v71, v71
    v_exp_f32 v72, v72
    v_exp_f32 v73, v73
    v_exp_f32 v74, v74
    v_exp_f32 v75, v75
    v_cvt_pk_bf16_f32 v80, v68, v69
    v_cvt_pk_bf16_f32 v81, v70, v71
    v_cvt_pk_bf16_f32 v82, v72, v73
    v_cvt_pk_bf16_f32 v83, v74, v75
    v_exp_f32 v44, v44
    v_exp_f32 v45, v45
    v_mfma_f32_32x32x16_bf16 v[132:147], v[40:43], v[80:83], v[132:147]
    ds_read_b128 v[24:27], v212 offset:6144
    v_exp_f32 v46, v46
    v_exp_f32 v47, v47
    s_mov_b64 exec, s[58:59]
    ds_read_b128 v[36:39], v213 offset:6144
    ds_read_b128 v[40:43], v213 offset:6656
    s_mov_b64 exec, -1
    v_exp_f32 v48, v48
    v_exp_f32 v49, v49
    v_exp_f32 v50, v50
    v_mfma_f32_32x32x16_bf16 v[60:75], v[20:23], v[8:11], v[164:179]
    v_exp_f32 v51, v51
    v_cvt_pk_bf16_f32 v76, v44, v45
    v_cvt_pk_bf16_f32 v77, v46, v47
    v_cvt_pk_bf16_f32 v78, v48, v49
    v_cvt_pk_bf16_f32 v79, v50, v51
    v_exp_f32 v52, v52
    v_exp_f32 v53, v53
    v_exp_f32 v54, v54
    v_mfma_f32_32x32x16_bf16 v[84:99], v[28:31], v[76:79], v[84:99]
    v_exp_f32 v55, v55
    v_exp_f32 v56, v56
    v_exp_f32 v57, v57
    v_exp_f32 v58, v58
    v_exp_f32 v59, v59
    v_cvt_pk_bf16_f32 v80, v52, v53
    v_cvt_pk_bf16_f32 v81, v54, v55
    v_cvt_pk_bf16_f32 v82, v56, v57
    v_cvt_pk_bf16_f32 v83, v58, v59
    v_exp_f32 v60, v60
    v_exp_f32 v61, v61
    v_mfma_f32_32x32x16_bf16 v[84:99], v[32:35], v[80:83], v[84:99]
    v_exp_f32 v62, v62
    v_exp_f32 v63, v63
    v_exp_f32 v64, v64
    v_exp_f32 v65, v65
    v_exp_f32 v66, v66
    v_mfma_f32_32x32x16_bf16 v[44:59], v[20:23], v[12:15], v[180:195]
    v_exp_f32 v67, v67
    v_cvt_pk_bf16_f32 v76, v60, v61
    v_cvt_pk_bf16_f32 v77, v62, v63
    v_cvt_pk_bf16_f32 v78, v64, v65
    v_cvt_pk_bf16_f32 v79, v66, v67
    v_exp_f32 v68, v68
    v_exp_f32 v69, v69
    v_exp_f32 v70, v70
    v_mfma_f32_32x32x16_bf16 v[100:115], v[28:31], v[76:79], v[100:115]
    v_exp_f32 v71, v71
    v_exp_f32 v72, v72
    v_exp_f32 v73, v73
    v_exp_f32 v74, v74
    v_exp_f32 v75, v75
    v_cvt_pk_bf16_f32 v80, v68, v69
    v_cvt_pk_bf16_f32 v81, v70, v71
    v_cvt_pk_bf16_f32 v82, v72, v73
    v_cvt_pk_bf16_f32 v83, v74, v75
    v_exp_f32 v44, v44
    v_exp_f32 v45, v45
    v_mfma_f32_32x32x16_bf16 v[100:115], v[32:35], v[80:83], v[100:115]
    v_exp_f32 v46, v46
    v_exp_f32 v47, v47
    v_exp_f32 v48, v48
    v_exp_f32 v49, v49
    v_exp_f32 v50, v50
    v_mfma_f32_32x32x16_bf16 v[60:75], v[20:23], v[16:19], v[196:211]
    v_exp_f32 v51, v51
    v_cvt_pk_bf16_f32 v76, v44, v45
    v_cvt_pk_bf16_f32 v77, v46, v47
    v_cvt_pk_bf16_f32 v78, v48, v49
    v_cvt_pk_bf16_f32 v79, v50, v51
    v_exp_f32 v52, v52
    v_exp_f32 v53, v53
    v_exp_f32 v54, v54
    v_mfma_f32_32x32x16_bf16 v[116:131], v[28:31], v[76:79], v[116:131]
    v_exp_f32 v55, v55
    v_exp_f32 v56, v56
    v_exp_f32 v57, v57
    v_exp_f32 v58, v58
    v_exp_f32 v59, v59
    v_cvt_pk_bf16_f32 v80, v52, v53
    v_cvt_pk_bf16_f32 v81, v54, v55
    v_cvt_pk_bf16_f32 v82, v56, v57
    v_cvt_pk_bf16_f32 v83, v58, v59
    v_exp_f32 v60, v60
    v_exp_f32 v61, v61
    v_mfma_f32_32x32x16_bf16 v[116:131], v[32:35], v[80:83], v[116:131]
    v_exp_f32 v62, v62
    v_exp_f32 v63, v63
    v_exp_f32 v64, v64
    v_exp_f32 v65, v65
    v_exp_f32 v66, v66
    s_waitcnt lgkmcnt(0)
    v_mfma_f32_32x32x16_bf16 v[44:59], v[24:27], v[4:7], v[148:163]
    v_exp_f32 v67, v67
    v_cvt_pk_bf16_f32 v76, v60, v61
    v_cvt_pk_bf16_f32 v77, v62, v63
    v_cvt_pk_bf16_f32 v78, v64, v65
    v_cvt_pk_bf16_f32 v79, v66, v67
    v_exp_f32 v68, v68
    v_exp_f32 v69, v69
    v_exp_f32 v70, v70
    v_mfma_f32_32x32x16_bf16 v[132:147], v[28:31], v[76:79], v[132:147]
    v_exp_f32 v71, v71
    v_exp_f32 v72, v72
    v_exp_f32 v73, v73
    v_exp_f32 v74, v74
    v_exp_f32 v75, v75
    v_cvt_pk_bf16_f32 v80, v68, v69
    v_cvt_pk_bf16_f32 v81, v70, v71
    v_cvt_pk_bf16_f32 v82, v72, v73
    v_cvt_pk_bf16_f32 v83, v74, v75
    v_exp_f32 v44, v44
    v_exp_f32 v45, v45
    v_mfma_f32_32x32x16_bf16 v[132:147], v[32:35], v[80:83], v[132:147]
    ds_read_b128 v[20:23], v212 offset:8192
    v_exp_f32 v46, v46
    v_exp_f32 v47, v47
    s_mov_b64 exec, s[58:59]
    ds_read_b128 v[28:31], v213 offset:8192
    ds_read_b128 v[32:35], v213 offset:8704
    s_mov_b64 exec, -1
    v_exp_f32 v48, v48
    v_exp_f32 v49, v49
    v_exp_f32 v50, v50
    v_mfma_f32_32x32x16_bf16 v[60:75], v[24:27], v[8:11], v[164:179]
    v_exp_f32 v51, v51
    v_cvt_pk_bf16_f32 v76, v44, v45
    v_cvt_pk_bf16_f32 v77, v46, v47
    v_cvt_pk_bf16_f32 v78, v48, v49
    v_cvt_pk_bf16_f32 v79, v50, v51
    v_exp_f32 v52, v52
    v_exp_f32 v53, v53
    v_exp_f32 v54, v54
    v_mfma_f32_32x32x16_bf16 v[84:99], v[36:39], v[76:79], v[84:99]
    v_exp_f32 v55, v55
    v_exp_f32 v56, v56
    v_exp_f32 v57, v57
    v_exp_f32 v58, v58
    v_exp_f32 v59, v59
    v_cvt_pk_bf16_f32 v80, v52, v53
    v_cvt_pk_bf16_f32 v81, v54, v55
    v_cvt_pk_bf16_f32 v82, v56, v57
    v_cvt_pk_bf16_f32 v83, v58, v59
    v_exp_f32 v60, v60
    v_exp_f32 v61, v61
    v_mfma_f32_32x32x16_bf16 v[84:99], v[40:43], v[80:83], v[84:99]
    v_exp_f32 v62, v62
    v_exp_f32 v63, v63
    v_exp_f32 v64, v64
    v_exp_f32 v65, v65
    v_exp_f32 v66, v66
    v_mfma_f32_32x32x16_bf16 v[44:59], v[24:27], v[12:15], v[180:195]
    v_exp_f32 v67, v67
    v_cvt_pk_bf16_f32 v76, v60, v61
    v_cvt_pk_bf16_f32 v77, v62, v63
    v_cvt_pk_bf16_f32 v78, v64, v65
    v_cvt_pk_bf16_f32 v79, v66, v67
    v_exp_f32 v68, v68
    v_exp_f32 v69, v69
    v_exp_f32 v70, v70
    v_mfma_f32_32x32x16_bf16 v[100:115], v[36:39], v[76:79], v[100:115]
    v_exp_f32 v71, v71
    v_exp_f32 v72, v72
    v_exp_f32 v73, v73
    v_exp_f32 v74, v74
    v_exp_f32 v75, v75
    v_cvt_pk_bf16_f32 v80, v68, v69
    v_cvt_pk_bf16_f32 v81, v70, v71
    v_cvt_pk_bf16_f32 v82, v72, v73
    v_cvt_pk_bf16_f32 v83, v74, v75
    v_exp_f32 v44, v44
    v_exp_f32 v45, v45
    v_mfma_f32_32x32x16_bf16 v[100:115], v[40:43], v[80:83], v[100:115]
    v_exp_f32 v46, v46
    v_exp_f32 v47, v47
    v_exp_f32 v48, v48
    v_exp_f32 v49, v49
    v_exp_f32 v50, v50
    v_mfma_f32_32x32x16_bf16 v[60:75], v[24:27], v[16:19], v[196:211]
    v_exp_f32 v51, v51
    v_cvt_pk_bf16_f32 v76, v44, v45
    v_cvt_pk_bf16_f32 v77, v46, v47
    v_cvt_pk_bf16_f32 v78, v48, v49
    v_cvt_pk_bf16_f32 v79, v50, v51
    v_exp_f32 v52, v52
    v_exp_f32 v53, v53
    v_exp_f32 v54, v54
    v_mfma_f32_32x32x16_bf16 v[116:131], v[36:39], v[76:79], v[116:131]
    v_exp_f32 v55, v55
    v_exp_f32 v56, v56
    v_exp_f32 v57, v57
    v_exp_f32 v58, v58
    v_exp_f32 v59, v59
    v_cvt_pk_bf16_f32 v80, v52, v53
    v_cvt_pk_bf16_f32 v81, v54, v55
    v_cvt_pk_bf16_f32 v82, v56, v57
    v_cvt_pk_bf16_f32 v83, v58, v59
    v_exp_f32 v60, v60
    v_exp_f32 v61, v61
    v_mfma_f32_32x32x16_bf16 v[116:131], v[40:43], v[80:83], v[116:131]
    v_exp_f32 v62, v62
    v_exp_f32 v63, v63
    v_exp_f32 v64, v64
    v_exp_f32 v65, v65
    v_exp_f32 v66, v66
    s_waitcnt lgkmcnt(0)
    v_mfma_f32_32x32x16_bf16 v[44:59], v[20:23], v[4:7], v[148:163]
    v_exp_f32 v67, v67
    v_cvt_pk_bf16_f32 v76, v60, v61
    v_cvt_pk_bf16_f32 v77, v62, v63
    v_cvt_pk_bf16_f32 v78, v64, v65
    v_cvt_pk_bf16_f32 v79, v66, v67
    v_exp_f32 v68, v68
    v_exp_f32 v69, v69
    v_exp_f32 v70, v70
    v_mfma_f32_32x32x16_bf16 v[132:147], v[36:39], v[76:79], v[132:147]
    v_exp_f32 v71, v71
    v_exp_f32 v72, v72
    v_exp_f32 v73, v73
    v_exp_f32 v74, v74
    v_exp_f32 v75, v75
    v_cvt_pk_bf16_f32 v80, v68, v69
    v_cvt_pk_bf16_f32 v81, v70, v71
    v_cvt_pk_bf16_f32 v82, v72, v73
    v_cvt_pk_bf16_f32 v83, v74, v75
    v_exp_f32 v44, v44
    v_exp_f32 v45, v45
    v_mfma_f32_32x32x16_bf16 v[132:147], v[40:43], v[80:83], v[132:147]
    ds_read_b128 v[24:27], v212 offset:10240
    v_exp_f32 v46, v46
    v_exp_f32 v47, v47
    s_mov_b64 exec, s[58:59]
    ds_read_b128 v[36:39], v213 offset:10240
    ds_read_b128 v[40:43], v213 offset:10752
    s_mov_b64 exec, -1
    v_exp_f32 v48, v48
    v_exp_f32 v49, v49
    v_exp_f32 v50, v50
    v_mfma_f32_32x32x16_bf16 v[60:75], v[20:23], v[8:11], v[164:179]
    v_exp_f32 v51, v51
    v_cvt_pk_bf16_f32 v76, v44, v45
    v_cvt_pk_bf16_f32 v77, v46, v47
    v_cvt_pk_bf16_f32 v78, v48, v49
    v_cvt_pk_bf16_f32 v79, v50, v51
    v_exp_f32 v52, v52
    v_exp_f32 v53, v53
    v_exp_f32 v54, v54
    v_mfma_f32_32x32x16_bf16 v[84:99], v[28:31], v[76:79], v[84:99]
    v_exp_f32 v55, v55
    v_exp_f32 v56, v56
    v_exp_f32 v57, v57
    v_exp_f32 v58, v58
    v_exp_f32 v59, v59
    v_cvt_pk_bf16_f32 v80, v52, v53
    v_cvt_pk_bf16_f32 v81, v54, v55
    v_cvt_pk_bf16_f32 v82, v56, v57
    v_cvt_pk_bf16_f32 v83, v58, v59
    v_exp_f32 v60, v60
    v_exp_f32 v61, v61
    v_mfma_f32_32x32x16_bf16 v[84:99], v[32:35], v[80:83], v[84:99]
    v_exp_f32 v62, v62
    v_exp_f32 v63, v63
    v_exp_f32 v64, v64
    v_exp_f32 v65, v65
    v_exp_f32 v66, v66
    v_mfma_f32_32x32x16_bf16 v[44:59], v[20:23], v[12:15], v[180:195]
    v_exp_f32 v67, v67
    v_cvt_pk_bf16_f32 v76, v60, v61
    v_cvt_pk_bf16_f32 v77, v62, v63
    v_cvt_pk_bf16_f32 v78, v64, v65
    v_cvt_pk_bf16_f32 v79, v66, v67
    v_exp_f32 v68, v68
    v_exp_f32 v69, v69
    v_exp_f32 v70, v70
    v_mfma_f32_32x32x16_bf16 v[100:115], v[28:31], v[76:79], v[100:115]
    v_exp_f32 v71, v71
    v_exp_f32 v72, v72
    v_exp_f32 v73, v73
    v_exp_f32 v74, v74
    v_exp_f32 v75, v75
    v_cvt_pk_bf16_f32 v80, v68, v69
    v_cvt_pk_bf16_f32 v81, v70, v71
    v_cvt_pk_bf16_f32 v82, v72, v73
    v_cvt_pk_bf16_f32 v83, v74, v75
    v_exp_f32 v44, v44
    v_exp_f32 v45, v45
    v_mfma_f32_32x32x16_bf16 v[100:115], v[32:35], v[80:83], v[100:115]
    v_exp_f32 v46, v46
    v_exp_f32 v47, v47
    v_exp_f32 v48, v48
    v_exp_f32 v49, v49
    v_exp_f32 v50, v50
    v_mfma_f32_32x32x16_bf16 v[60:75], v[20:23], v[16:19], v[196:211]
    v_exp_f32 v51, v51
    v_cvt_pk_bf16_f32 v76, v44, v45
    v_cvt_pk_bf16_f32 v77, v46, v47
    v_cvt_pk_bf16_f32 v78, v48, v49
    v_cvt_pk_bf16_f32 v79, v50, v51
    v_exp_f32 v52, v52
    v_exp_f32 v53, v53
    v_exp_f32 v54, v54
    v_mfma_f32_32x32x16_bf16 v[116:131], v[28:31], v[76:79], v[116:131]
    v_exp_f32 v55, v55
    v_exp_f32 v56, v56
    v_exp_f32 v57, v57
    v_exp_f32 v58, v58
    v_exp_f32 v59, v59
    v_cvt_pk_bf16_f32 v80, v52, v53
    v_cvt_pk_bf16_f32 v81, v54, v55
    v_cvt_pk_bf16_f32 v82, v56, v57
    v_cvt_pk_bf16_f32 v83, v58, v59
    v_exp_f32 v60, v60
    v_exp_f32 v61, v61
    v_mfma_f32_32x32x16_bf16 v[116:131], v[32:35], v[80:83], v[116:131]
    v_exp_f32 v62, v62
    v_exp_f32 v63, v63
    v_exp_f32 v64, v64
    v_exp_f32 v65, v65
    v_exp_f32 v66, v66
    s_waitcnt lgkmcnt(0)
    v_mfma_f32_32x32x16_bf16 v[44:59], v[24:27], v[4:7], v[148:163]
    v_exp_f32 v67, v67
    v_cvt_pk_bf16_f32 v76, v60, v61
    v_cvt_pk_bf16_f32 v77, v62, v63
    v_cvt_pk_bf16_f32 v78, v64, v65
    v_cvt_pk_bf16_f32 v79, v66, v67
    v_exp_f32 v68, v68
    v_exp_f32 v69, v69
    v_exp_f32 v70, v70
    v_mfma_f32_32x32x16_bf16 v[132:147], v[28:31], v[76:79], v[132:147]
    v_exp_f32 v71, v71
    v_exp_f32 v72, v72
    v_exp_f32 v73, v73
    v_exp_f32 v74, v74
    v_exp_f32 v75, v75
    v_cvt_pk_bf16_f32 v80, v68, v69
    v_cvt_pk_bf16_f32 v81, v70, v71
    v_cvt_pk_bf16_f32 v82, v72, v73
    v_cvt_pk_bf16_f32 v83, v74, v75
    v_exp_f32 v44, v44
    v_exp_f32 v45, v45
    v_mfma_f32_32x32x16_bf16 v[132:147], v[32:35], v[80:83], v[132:147]
    ds_read_b128 v[20:23], v212 offset:12288
    v_exp_f32 v46, v46
    v_exp_f32 v47, v47
    s_mov_b64 exec, s[58:59]
    ds_read_b128 v[28:31], v213 offset:12288
    ds_read_b128 v[32:35], v213 offset:12800
    s_mov_b64 exec, -1
    v_exp_f32 v48, v48
    v_exp_f32 v49, v49
    v_exp_f32 v50, v50
    v_mfma_f32_32x32x16_bf16 v[60:75], v[24:27], v[8:11], v[164:179]
    v_exp_f32 v51, v51
    v_cvt_pk_bf16_f32 v76, v44, v45
    v_cvt_pk_bf16_f32 v77, v46, v47
    v_cvt_pk_bf16_f32 v78, v48, v49
    v_cvt_pk_bf16_f32 v79, v50, v51
    v_exp_f32 v52, v52
    v_exp_f32 v53, v53
    v_exp_f32 v54, v54
    v_mfma_f32_32x32x16_bf16 v[84:99], v[36:39], v[76:79], v[84:99]
    v_exp_f32 v55, v55
    v_exp_f32 v56, v56
    v_exp_f32 v57, v57
    v_exp_f32 v58, v58
    v_exp_f32 v59, v59
    v_cvt_pk_bf16_f32 v80, v52, v53
    v_cvt_pk_bf16_f32 v81, v54, v55
    v_cvt_pk_bf16_f32 v82, v56, v57
    v_cvt_pk_bf16_f32 v83, v58, v59
    v_exp_f32 v60, v60
    v_exp_f32 v61, v61
    v_mfma_f32_32x32x16_bf16 v[84:99], v[40:43], v[80:83], v[84:99]
    v_exp_f32 v62, v62
    v_exp_f32 v63, v63
    v_exp_f32 v64, v64
    v_exp_f32 v65, v65
    v_exp_f32 v66, v66
    v_mfma_f32_32x32x16_bf16 v[44:59], v[24:27], v[12:15], v[180:195]
    v_exp_f32 v67, v67
    v_cvt_pk_bf16_f32 v76, v60, v61
    v_cvt_pk_bf16_f32 v77, v62, v63
    v_cvt_pk_bf16_f32 v78, v64, v65
    v_cvt_pk_bf16_f32 v79, v66, v67
    v_exp_f32 v68, v68
    v_exp_f32 v69, v69
    v_exp_f32 v70, v70
    v_mfma_f32_32x32x16_bf16 v[100:115], v[36:39], v[76:79], v[100:115]
    v_exp_f32 v71, v71
    v_exp_f32 v72, v72
    v_exp_f32 v73, v73
    v_exp_f32 v74, v74
    v_exp_f32 v75, v75
    v_cvt_pk_bf16_f32 v80, v68, v69
    v_cvt_pk_bf16_f32 v81, v70, v71
    v_cvt_pk_bf16_f32 v82, v72, v73
    v_cvt_pk_bf16_f32 v83, v74, v75
    v_exp_f32 v44, v44
    v_exp_f32 v45, v45
    v_mfma_f32_32x32x16_bf16 v[100:115], v[40:43], v[80:83], v[100:115]
    v_exp_f32 v46, v46
    v_exp_f32 v47, v47
    v_exp_f32 v48, v48
    v_exp_f32 v49, v49
    v_exp_f32 v50, v50
    v_mfma_f32_32x32x16_bf16 v[60:75], v[24:27], v[16:19], v[196:211]
    v_exp_f32 v51, v51
    v_cvt_pk_bf16_f32 v76, v44, v45
    v_cvt_pk_bf16_f32 v77, v46, v47
    v_cvt_pk_bf16_f32 v78, v48, v49
    v_cvt_pk_bf16_f32 v79, v50, v51
    v_exp_f32 v52, v52
    v_exp_f32 v53, v53
    v_exp_f32 v54, v54
    v_mfma_f32_32x32x16_bf16 v[116:131], v[36:39], v[76:79], v[116:131]
    v_exp_f32 v55, v55
    v_exp_f32 v56, v56
    v_exp_f32 v57, v57
    v_exp_f32 v58, v58
    v_exp_f32 v59, v59
    v_cvt_pk_bf16_f32 v80, v52, v53
    v_cvt_pk_bf16_f32 v81, v54, v55
    v_cvt_pk_bf16_f32 v82, v56, v57
    v_cvt_pk_bf16_f32 v83, v58, v59
    v_exp_f32 v60, v60
    v_exp_f32 v61, v61
    v_mfma_f32_32x32x16_bf16 v[116:131], v[40:43], v[80:83], v[116:131]
    v_exp_f32 v62, v62
    v_exp_f32 v63, v63
    v_exp_f32 v64, v64
    v_exp_f32 v65, v65
    v_exp_f32 v66, v66
    s_waitcnt lgkmcnt(0)
    v_mfma_f32_32x32x16_bf16 v[44:59], v[20:23], v[4:7], v[148:163]
    v_exp_f32 v67, v67
    v_cvt_pk_bf16_f32 v76, v60, v61
    v_cvt_pk_bf16_f32 v77, v62, v63
    v_cvt_pk_bf16_f32 v78, v64, v65
    v_cvt_pk_bf16_f32 v79, v66, v67
    v_exp_f32 v68, v68
    v_exp_f32 v69, v69
    v_exp_f32 v70, v70
    v_mfma_f32_32x32x16_bf16 v[132:147], v[36:39], v[76:79], v[132:147]
    v_exp_f32 v71, v71
    v_exp_f32 v72, v72
    v_exp_f32 v73, v73
    v_exp_f32 v74, v74
    v_exp_f32 v75, v75
    v_cvt_pk_bf16_f32 v80, v68, v69
    v_cvt_pk_bf16_f32 v81, v70, v71
    v_cvt_pk_bf16_f32 v82, v72, v73
    v_cvt_pk_bf16_f32 v83, v74, v75
    v_exp_f32 v44, v44
    v_exp_f32 v45, v45
    v_mfma_f32_32x32x16_bf16 v[132:147], v[40:43], v[80:83], v[132:147]
    ds_read_b128 v[24:27], v212 offset:14336
    v_exp_f32 v46, v46
    v_exp_f32 v47, v47
    s_mov_b64 exec, s[58:59]
    ds_read_b128 v[36:39], v213 offset:14336
    ds_read_b128 v[40:43], v213 offset:14848
    s_mov_b64 exec, -1
    v_exp_f32 v48, v48
    v_exp_f32 v49, v49
    v_exp_f32 v50, v50
    v_mfma_f32_32x32x16_bf16 v[60:75], v[20:23], v[8:11], v[164:179]
    v_exp_f32 v51, v51
    v_cvt_pk_bf16_f32 v76, v44, v45
    v_cvt_pk_bf16_f32 v77, v46, v47
    v_cvt_pk_bf16_f32 v78, v48, v49
    v_cvt_pk_bf16_f32 v79, v50, v51
    v_exp_f32 v52, v52
    v_exp_f32 v53, v53
    v_exp_f32 v54, v54
    v_mfma_f32_32x32x16_bf16 v[84:99], v[28:31], v[76:79], v[84:99]
    v_exp_f32 v55, v55
    v_exp_f32 v56, v56
    v_exp_f32 v57, v57
    v_exp_f32 v58, v58
    v_exp_f32 v59, v59
    v_cvt_pk_bf16_f32 v80, v52, v53
    v_cvt_pk_bf16_f32 v81, v54, v55
    v_cvt_pk_bf16_f32 v82, v56, v57
    v_cvt_pk_bf16_f32 v83, v58, v59
    v_exp_f32 v60, v60
    v_exp_f32 v61, v61
    v_mfma_f32_32x32x16_bf16 v[84:99], v[32:35], v[80:83], v[84:99]
    v_exp_f32 v62, v62
    v_exp_f32 v63, v63
    v_exp_f32 v64, v64
    v_exp_f32 v65, v65
    v_exp_f32 v66, v66
    v_mfma_f32_32x32x16_bf16 v[44:59], v[20:23], v[12:15], v[180:195]
    v_exp_f32 v67, v67
    v_cvt_pk_bf16_f32 v76, v60, v61
    v_cvt_pk_bf16_f32 v77, v62, v63
    v_cvt_pk_bf16_f32 v78, v64, v65
    v_cvt_pk_bf16_f32 v79, v66, v67
    v_exp_f32 v68, v68
    v_exp_f32 v69, v69
    v_exp_f32 v70, v70
    v_mfma_f32_32x32x16_bf16 v[100:115], v[28:31], v[76:79], v[100:115]
    v_exp_f32 v71, v71
    v_exp_f32 v72, v72
    v_exp_f32 v73, v73
    v_exp_f32 v74, v74
    v_exp_f32 v75, v75
    v_cvt_pk_bf16_f32 v80, v68, v69
    v_cvt_pk_bf16_f32 v81, v70, v71
    v_cvt_pk_bf16_f32 v82, v72, v73
    v_cvt_pk_bf16_f32 v83, v74, v75
    v_exp_f32 v44, v44
    v_exp_f32 v45, v45
    v_mfma_f32_32x32x16_bf16 v[100:115], v[32:35], v[80:83], v[100:115]
    v_exp_f32 v46, v46
    v_exp_f32 v47, v47
    v_exp_f32 v48, v48
    v_exp_f32 v49, v49
    v_exp_f32 v50, v50
    v_mfma_f32_32x32x16_bf16 v[60:75], v[20:23], v[16:19], v[196:211]
    v_exp_f32 v51, v51
    v_cvt_pk_bf16_f32 v76, v44, v45
    v_cvt_pk_bf16_f32 v77, v46, v47
    v_cvt_pk_bf16_f32 v78, v48, v49
    v_cvt_pk_bf16_f32 v79, v50, v51
    v_exp_f32 v52, v52
    v_exp_f32 v53, v53
    v_exp_f32 v54, v54
    v_mfma_f32_32x32x16_bf16 v[116:131], v[28:31], v[76:79], v[116:131]
    v_exp_f32 v55, v55
    v_exp_f32 v56, v56
    v_exp_f32 v57, v57
    v_exp_f32 v58, v58
    v_exp_f32 v59, v59
    v_cvt_pk_bf16_f32 v80, v52, v53
    v_cvt_pk_bf16_f32 v81, v54, v55
    v_cvt_pk_bf16_f32 v82, v56, v57
    v_cvt_pk_bf16_f32 v83, v58, v59
    v_exp_f32 v60, v60
    v_exp_f32 v61, v61
    v_mfma_f32_32x32x16_bf16 v[116:131], v[32:35], v[80:83], v[116:131]
    v_exp_f32 v62, v62
    v_exp_f32 v63, v63
    v_exp_f32 v64, v64
    v_exp_f32 v65, v65
    v_exp_f32 v66, v66
    s_waitcnt lgkmcnt(0)
    v_mfma_f32_32x32x16_bf16 v[44:59], v[24:27], v[4:7], v[148:163]
    v_exp_f32 v67, v67
    v_cvt_pk_bf16_f32 v76, v60, v61
    v_cvt_pk_bf16_f32 v77, v62, v63
    v_cvt_pk_bf16_f32 v78, v64, v65
    v_cvt_pk_bf16_f32 v79, v66, v67
    v_exp_f32 v68, v68
    v_exp_f32 v69, v69
    v_exp_f32 v70, v70
    v_mfma_f32_32x32x16_bf16 v[132:147], v[28:31], v[76:79], v[132:147]
    v_exp_f32 v71, v71
    v_exp_f32 v72, v72
    v_exp_f32 v73, v73
    v_exp_f32 v74, v74
    v_exp_f32 v75, v75
    v_cvt_pk_bf16_f32 v80, v68, v69
    v_cvt_pk_bf16_f32 v81, v70, v71
    v_cvt_pk_bf16_f32 v82, v72, v73
    v_cvt_pk_bf16_f32 v83, v74, v75
    v_exp_f32 v44, v44
    v_exp_f32 v45, v45
    v_mfma_f32_32x32x16_bf16 v[132:147], v[32:35], v[80:83], v[132:147]
    ds_read_b128 v[20:23], v212 offset:16384
    v_exp_f32 v46, v46
    v_exp_f32 v47, v47
    s_mov_b64 exec, s[58:59]
    ds_read_b128 v[28:31], v213 offset:16384
    ds_read_b128 v[32:35], v213 offset:16896
    s_mov_b64 exec, -1
    v_exp_f32 v48, v48
    v_exp_f32 v49, v49
    v_exp_f32 v50, v50
    v_mfma_f32_32x32x16_bf16 v[60:75], v[24:27], v[8:11], v[164:179]
    v_exp_f32 v51, v51
    v_cvt_pk_bf16_f32 v76, v44, v45
    v_cvt_pk_bf16_f32 v77, v46, v47
    v_cvt_pk_bf16_f32 v78, v48, v49
    v_cvt_pk_bf16_f32 v79, v50, v51
    v_exp_f32 v52, v52
    v_exp_f32 v53, v53
    v_exp_f32 v54, v54
    v_mfma_f32_32x32x16_bf16 v[84:99], v[36:39], v[76:79], v[84:99]
    v_exp_f32 v55, v55
    v_exp_f32 v56, v56
    v_exp_f32 v57, v57
    v_exp_f32 v58, v58
    v_exp_f32 v59, v59
    v_cvt_pk_bf16_f32 v80, v52, v53
    v_cvt_pk_bf16_f32 v81, v54, v55
    v_cvt_pk_bf16_f32 v82, v56, v57
    v_cvt_pk_bf16_f32 v83, v58, v59
    v_exp_f32 v60, v60
    v_exp_f32 v61, v61
    v_mfma_f32_32x32x16_bf16 v[84:99], v[40:43], v[80:83], v[84:99]
    v_exp_f32 v62, v62
    v_exp_f32 v63, v63
    v_exp_f32 v64, v64
    v_exp_f32 v65, v65
    v_exp_f32 v66, v66
    v_mfma_f32_32x32x16_bf16 v[44:59], v[24:27], v[12:15], v[180:195]
    v_exp_f32 v67, v67
    v_cvt_pk_bf16_f32 v76, v60, v61
    v_cvt_pk_bf16_f32 v77, v62, v63
    v_cvt_pk_bf16_f32 v78, v64, v65
    v_cvt_pk_bf16_f32 v79, v66, v67
    v_exp_f32 v68, v68
    v_exp_f32 v69, v69
    v_exp_f32 v70, v70
    v_mfma_f32_32x32x16_bf16 v[100:115], v[36:39], v[76:79], v[100:115]
    v_exp_f32 v71, v71
    v_exp_f32 v72, v72
    v_exp_f32 v73, v73
    v_exp_f32 v74, v74
    v_exp_f32 v75, v75
    v_cvt_pk_bf16_f32 v80, v68, v69
    v_cvt_pk_bf16_f32 v81, v70, v71
    v_cvt_pk_bf16_f32 v82, v72, v73
    v_cvt_pk_bf16_f32 v83, v74, v75
    v_exp_f32 v44, v44
    v_exp_f32 v45, v45
    v_mfma_f32_32x32x16_bf16 v[100:115], v[40:43], v[80:83], v[100:115]
    v_exp_f32 v46, v46
    v_exp_f32 v47, v47
    v_exp_f32 v48, v48
    v_exp_f32 v49, v49
    v_exp_f32 v50, v50
    v_mfma_f32_32x32x16_bf16 v[60:75], v[24:27], v[16:19], v[196:211]
    v_exp_f32 v51, v51
    v_cvt_pk_bf16_f32 v76, v44, v45
    v_cvt_pk_bf16_f32 v77, v46, v47
    v_cvt_pk_bf16_f32 v78, v48, v49
    v_cvt_pk_bf16_f32 v79, v50, v51
    v_exp_f32 v52, v52
    v_exp_f32 v53, v53
    v_exp_f32 v54, v54
    v_mfma_f32_32x32x16_bf16 v[116:131], v[36:39], v[76:79], v[116:131]
    v_exp_f32 v55, v55
    v_exp_f32 v56, v56
    v_exp_f32 v57, v57
    v_exp_f32 v58, v58
    v_exp_f32 v59, v59
    v_cvt_pk_bf16_f32 v80, v52, v53
    v_cvt_pk_bf16_f32 v81, v54, v55
    v_cvt_pk_bf16_f32 v82, v56, v57
    v_cvt_pk_bf16_f32 v83, v58, v59
    v_exp_f32 v60, v60
    v_exp_f32 v61, v61
    v_mfma_f32_32x32x16_bf16 v[116:131], v[40:43], v[80:83], v[116:131]
    v_exp_f32 v62, v62
    v_exp_f32 v63, v63
    v_exp_f32 v64, v64
    v_exp_f32 v65, v65
    v_exp_f32 v66, v66
    s_waitcnt lgkmcnt(0)
    v_mfma_f32_32x32x16_bf16 v[44:59], v[20:23], v[4:7], v[148:163]
    v_exp_f32 v67, v67
    v_cvt_pk_bf16_f32 v76, v60, v61
    v_cvt_pk_bf16_f32 v77, v62, v63
    v_cvt_pk_bf16_f32 v78, v64, v65
    v_cvt_pk_bf16_f32 v79, v66, v67
    v_exp_f32 v68, v68
    v_exp_f32 v69, v69
    v_exp_f32 v70, v70
    v_mfma_f32_32x32x16_bf16 v[132:147], v[36:39], v[76:79], v[132:147]
    v_exp_f32 v71, v71
    v_exp_f32 v72, v72
    v_exp_f32 v73, v73
    v_exp_f32 v74, v74
    v_exp_f32 v75, v75
    v_cvt_pk_bf16_f32 v80, v68, v69
    v_cvt_pk_bf16_f32 v81, v70, v71
    v_cvt_pk_bf16_f32 v82, v72, v73
    v_cvt_pk_bf16_f32 v83, v74, v75
    v_add_u32 v212, 0x4000, v212
    v_add_u32 v213, 0x4000, v213
    s_add_u32 s39, s39, 1
    s_cmp_lt_u32 s39, 4
    s_cbranch_scc1 L_kb_s_loop
    s_barrier
    v_lshrrev_b32 v222, 3, v1
    s_mov_b32 s69, 1024
    v_mul_lo_u32 v222, v222, s69
    v_bfe_u32 v223, v1, 4, 1
    v_lshlrev_b32 v223, 2, v223
    v_and_b32 v218, 7, v1
    v_xor_b32 v223, v223, v218
    v_lshl_add_u32 v218, v223, 4, v222
    v_add_u32 v219, 7168, v218
    v_add_u32 v220, 14336, v218
    v_add_u32 v221, 21504, v218
    s_lshl_b32 s37, s26, 8
    s_lshl_b32 s38, s25, 5
    s_add_u32 s37, s37, s38
    s_lshl_b32 s37, s37, 10
    s_lshl_b32 s28, s35, 7
    s_add_u32 s37, s37, s28
    s_lshl_b32 s28, s26, 16
    s_lshl_b32 s38, s38, 7
    s_add_u32 s38, s38, s28
    s_add_u32 m0, s38, 0
    s_add_u32 s28, s37, 0
    buffer_load_dwordx4 v218, s[4:7], s28 offen offset:0 lds
    buffer_load_dwordx4 v219, s[4:7], s28 offen offset:1024 lds
    buffer_load_dwordx4 v220, s[4:7], s28 offen offset:2048 lds
    buffer_load_dwordx4 v221, s[4:7], s28 offen offset:3072 lds
    s_add_u32 m0, s38, 8192
    s_add_u32 s28, s37, 65536
    buffer_load_dwordx4 v218, s[4:7], s28 offen offset:0 lds
    buffer_load_dwordx4 v219, s[4:7], s28 offen offset:1024 lds
    buffer_load_dwordx4 v220, s[4:7], s28 offen offset:2048 lds
    buffer_load_dwordx4 v221, s[4:7], s28 offen offset:3072 lds
    s_add_u32 m0, s38, 16384
    s_add_u32 s28, s37, 131072
    buffer_load_dwordx4 v218, s[4:7], s28 offen offset:0 lds
    buffer_load_dwordx4 v219, s[4:7], s28 offen offset:1024 lds
    buffer_load_dwordx4 v220, s[4:7], s28 offen offset:2048 lds
    buffer_load_dwordx4 v221, s[4:7], s28 offen offset:3072 lds
    s_add_u32 m0, s38, 24576
    s_add_u32 s28, s37, 196608
    buffer_load_dwordx4 v218, s[4:7], s28 offen offset:0 lds
    buffer_load_dwordx4 v219, s[4:7], s28 offen offset:1024 lds
    buffer_load_dwordx4 v220, s[4:7], s28 offen offset:2048 lds
    buffer_load_dwordx4 v221, s[4:7], s28 offen offset:3072 lds
    s_waitcnt vmcnt(0)
L_kb_fin:
    v_cmp_gt_u32 vcc, 16, v233
    s_cbranch_vccnz L_kb_cfspin
L_kb_cfok:
    s_nop 1
    v_mfma_f32_32x32x16_bf16 v[132:147], v[40:43], v[80:83], v[132:147]
    s_xor_b32 s28, s22, 1
    s_mul_i32 s28, s28, 6144
    s_add_u32 s28, s28, 131072
    v_add_u32 v218, s28, v2
    s_mul_i32 s28, s22, 6144
    s_add_u32 s28, s28, 131072
    v_add_u32 v219, s28, v2
    s_lshl_b32 s29, s27, 15
    s_lshl_b32 s28, s23, 10
    s_add_u32 s29, s29, s28
    s_add_u32 s29, s29, 7340032
    s_cmp_eq_u32 s26, 0
    s_cbranch_scc0 L_kb_x1
    s_nop 11
    ds_write_b128 v218, v[116:119] offset:0
    ds_write_b128 v218, v[120:123] offset:1024
    ds_write_b128 v218, v[124:127] offset:2048
    ds_write_b128 v218, v[132:135] offset:3072
    ds_write_b128 v218, v[136:139] offset:4096
    ds_write_b128 v218, v[140:143] offset:5120
    s_waitcnt lgkmcnt(0)
    s_barrier
    ds_read_b128 v[44:47], v219 offset:0
    ds_read_b128 v[48:51], v219 offset:1024
    ds_read_b128 v[52:55], v219 offset:2048
    ds_read_b128 v[56:59], v219 offset:3072
    ds_read_b128 v[60:63], v219 offset:4096
    ds_read_b128 v[64:67], v219 offset:5120
    s_waitcnt lgkmcnt(0)
    s_barrier
    v_add_f32 v84, v84, v44
    v_add_f32 v85, v85, v45
    v_add_f32 v86, v86, v46
    v_add_f32 v87, v87, v47
    v_add_f32 v88, v88, v48
    v_add_f32 v89, v89, v49
    v_add_f32 v90, v90, v50
    v_add_f32 v91, v91, v51
    v_add_f32 v92, v92, v52
    v_rcp_f32 v220, v92
    s_nop 0
    v_mul_f32 v84, v84, v220
    v_mul_f32 v85, v85, v220
    v_mul_f32 v86, v86, v220
    v_mul_f32 v87, v87, v220
    v_mul_f32 v88, v88, v220
    v_mul_f32 v89, v89, v220
    v_mul_f32 v90, v90, v220
    v_mul_f32 v91, v91, v220
    v_cvt_pk_bf16_f32 v76, v84, v85
    v_cvt_pk_bf16_f32 v77, v86, v87
    v_cvt_pk_bf16_f32 v78, v88, v89
    v_cvt_pk_bf16_f32 v79, v90, v91
    s_add_u32 s28, s29, 0
    v_min_u32 v76, 0xfffffffe, v76
    buffer_store_dwordx4 v[76:79], v2, s[16:19], s28 offen sc1
    v_add_f32 v100, v100, v56
    v_add_f32 v101, v101, v57
    v_add_f32 v102, v102, v58
    v_add_f32 v103, v103, v59
    v_add_f32 v104, v104, v60
    v_add_f32 v105, v105, v61
    v_add_f32 v106, v106, v62
    v_add_f32 v107, v107, v63
    v_add_f32 v108, v108, v64
    v_rcp_f32 v220, v108
    s_nop 0
    v_mul_f32 v100, v100, v220
    v_mul_f32 v101, v101, v220
    v_mul_f32 v102, v102, v220
    v_mul_f32 v103, v103, v220
    v_mul_f32 v104, v104, v220
    v_mul_f32 v105, v105, v220
    v_mul_f32 v106, v106, v220
    v_mul_f32 v107, v107, v220
    v_cvt_pk_bf16_f32 v80, v100, v101
    v_cvt_pk_bf16_f32 v81, v102, v103
    v_cvt_pk_bf16_f32 v82, v104, v105
    v_cvt_pk_bf16_f32 v83, v106, v107
    s_add_u32 s28, s29, 32768
    v_min_u32 v80, 0xfffffffe, v80
    buffer_store_dwordx4 v[80:83], v2, s[16:19], s28 offen sc1
    s_branch L_kb_x2
L_kb_x1:
    s_nop 11
    ds_write_b128 v218, v[84:87] offset:0
    ds_write_b128 v218, v[88:91] offset:1024
    ds_write_b128 v218, v[92:95] offset:2048
    ds_write_b128 v218, v[100:103] offset:3072
    ds_write_b128 v218, v[104:107] offset:4096
    ds_write_b128 v218, v[108:111] offset:5120
    s_waitcnt lgkmcnt(0)
    s_barrier
    ds_read_b128 v[44:47], v219 offset:0
    ds_read_b128 v[48:51], v219 offset:1024
    ds_read_b128 v[52:55], v219 offset:2048
    ds_read_b128 v[56:59], v219 offset:3072
    ds_read_b128 v[60:63], v219 offset:4096
    ds_read_b128 v[64:67], v219 offset:5120
    s_waitcnt lgkmcnt(0)
    s_barrier
    v_add_f32 v116, v116, v44
    v_add_f32 v117, v117, v45
    v_add_f32 v118, v118, v46
    v_add_f32 v119, v119, v47
    v_add_f32 v120, v120, v48
    v_add_f32 v121, v121, v49
    v_add_f32 v122, v122, v50
    v_add_f32 v123, v123, v51
    v_add_f32 v124, v124, v52
    v_rcp_f32 v220, v124
    s_nop 0
    v_mul_f32 v116, v116, v220
    v_mul_f32 v117, v117, v220
    v_mul_f32 v118, v118, v220
    v_mul_f32 v119, v119, v220
    v_mul_f32 v120, v120, v220
    v_mul_f32 v121, v121, v220
    v_mul_f32 v122, v122, v220
    v_mul_f32 v123, v123, v220
    v_cvt_pk_bf16_f32 v76, v116, v117
    v_cvt_pk_bf16_f32 v77, v118, v119
    v_cvt_pk_bf16_f32 v78, v120, v121
    v_cvt_pk_bf16_f32 v79, v122, v123
    s_add_u32 s28, s29, 65536
    v_min_u32 v76, 0xfffffffe, v76
    buffer_store_dwordx4 v[76:79], v2, s[16:19], s28 offen sc1
    v_add_f32 v132, v132, v56
    v_add_f32 v133, v133, v57
    v_add_f32 v134, v134, v58
    v_add_f32 v135, v135, v59
    v_add_f32 v136, v136, v60
    v_add_f32 v137, v137, v61
    v_add_f32 v138, v138, v62
    v_add_f32 v139, v139, v63
    v_add_f32 v140, v140, v64
    v_rcp_f32 v220, v140
    s_nop 0
    v_mul_f32 v132, v132, v220
    v_mul_f32 v133, v133, v220
    v_mul_f32 v134, v134, v220
    v_mul_f32 v135, v135, v220
    v_mul_f32 v136, v136, v220
    v_mul_f32 v137, v137, v220
    v_mul_f32 v138, v138, v220
    v_mul_f32 v139, v139, v220
    v_cvt_pk_bf16_f32 v80, v132, v133
    v_cvt_pk_bf16_f32 v81, v134, v135
    v_cvt_pk_bf16_f32 v82, v136, v137
    v_cvt_pk_bf16_f32 v83, v138, v139
    s_add_u32 s28, s29, 98304
    v_min_u32 v80, 0xfffffffe, v80
    buffer_store_dwordx4 v[80:83], v2, s[16:19], s28 offen sc1
L_kb_x2:
    s_mov_b32 s23, s72
    s_mov_b32 s24, s73
    s_lshl_b32 s31, s24, 1
    s_add_u32 s31, s31, s25
    s_mov_b32 s4, s40
    s_and_b32 s5, s41, 0xffff
    s_mov_b32 s6, 2097152
    s_mov_b32 s7, 0x00020000
    v_and_b32 v8, 31, v1
    v_lshlrev_b32 v8, 10, v8
    v_lshrrev_b32 v9, 5, v1
    v_lshl_add_u32 v8, v9, 4, v8
    s_lshl_b32 s33, s31, 15
    s_lshl_b32 s34, s23, 7
    s_add_u32 s33, s33, s34
    s_lshl_b32 s34, s26, 6
    s_add_u32 s33, s33, s34
    buffer_load_dwordx4 v[96:99], v8, s[4:7], s33 offen
    buffer_load_dwordx4 v[100:103], v8, s[4:7], s33 offen offset:32
    v_lshrrev_b32 v8, 3, v1
    s_mov_b32 s69, 3584
    v_mul_lo_u32 v8, v8, s69
    v_bfe_u32 v9, v1, 4, 1
    v_lshlrev_b32 v9, 2, v9
    v_and_b32 v4, 7, v1
    v_xor_b32 v9, v9, v4
    v_lshl_add_u32 v4, v9, 4, v8
    v_add_u32 v5, 27648, v4
    v_add_u32 v6, 55296, v4
    v_add_u32 v7, 82944, v4
    v_lshrrev_b32 v8, 3, v1
    s_mov_b32 s69, 4096
    v_mul_lo_u32 v8, v8, s69
    v_bfe_u32 v9, v1, 4, 1
    v_lshlrev_b32 v9, 2, v9
    v_and_b32 v20, 7, v1
    v_xor_b32 v9, v9, v20
    v_lshl_add_u32 v20, v9, 4, v8
    v_add_u32 v21, 31744, v20
    v_add_u32 v22, 63488, v20
    v_add_u32 v23, 95232, v20
    v_lshrrev_b32 v8, 5, v1
    v_lshlrev_b32 v8, 2, v8
    v_bfe_u32 v9, v1, 2, 2
    v_add_u32 v8, v8, v9
    v_lshlrev_b32 v8, 7, v8
    v_bfe_u32 v9, v1, 4, 1
    v_lshlrev_b32 v9, 1, v9
    v_bfe_u32 v25, v1, 1, 1
    v_add_u32 v9, v9, v25
    v_bfe_u32 v25, v1, 3, 1
    v_lshlrev_b32 v25, 2, v25
    v_xor_b32 v9, v9, v25
    v_lshl_add_u32 v8, v9, 4, v8
    v_and_b32 v9, 1, v1
    v_lshl_add_u32 v24, v9, 3, v8
    v_xor_b32 v25, 64, v24
    s_lshl_b32 s80, s26, 14
    s_lshl_b32 s69, s25, 16
    s_add_u32 s80, s80, s69
    s_add_u32 s80, s80, 32768
    s_lshl_b32 s69, s26, 6
    v_xor_b32 v26, s69, v24
    v_xor_b32 v27, s69, v25
    v_add_u32 v26, s80, v26
    v_add_u32 v27, s80, v27
    s_lshl_b32 s34, s26, 16
    v_add_u32 v10, s34, v24
    v_add_u32 v11, s34, v25
    ds_read_b64_tr_b16 a[0:1], v10 offset:0
    ds_read_b64_tr_b16 a[2:3], v10 offset:1024
    ds_read_b64_tr_b16 a[4:5], v11 offset:0
    ds_read_b64_tr_b16 a[6:7], v11 offset:1024
    ds_read_b64_tr_b16 a[8:9], v10 offset:2048
    ds_read_b64_tr_b16 a[10:11], v10 offset:3072
    ds_read_b64_tr_b16 a[12:13], v11 offset:2048
    ds_read_b64_tr_b16 a[14:15], v11 offset:3072
    ds_read_b64_tr_b16 a[16:17], v10 offset:4096
    ds_read_b64_tr_b16 a[18:19], v10 offset:5120
    ds_read_b64_tr_b16 a[20:21], v11 offset:4096
    ds_read_b64_tr_b16 a[22:23], v11 offset:5120
    s_waitcnt lgkmcnt(6)
    ds_read_b64_tr_b16 a[24:25], v10 offset:6144
    ds_read_b64_tr_b16 a[26:27], v10 offset:7168
    ds_read_b64_tr_b16 a[28:29], v11 offset:6144
    ds_read_b64_tr_b16 a[30:31], v11 offset:7168
    ds_read_b64_tr_b16 a[32:33], v10 offset:8192
    ds_read_b64_tr_b16 a[34:35], v10 offset:9216
    ds_read_b64_tr_b16 a[36:37], v11 offset:8192
    ds_read_b64_tr_b16 a[38:39], v11 offset:9216
    s_waitcnt lgkmcnt(6)
    ds_read_b64_tr_b16 a[40:41], v10 offset:10240
    ds_read_b64_tr_b16 a[42:43], v10 offset:11264
    ds_read_b64_tr_b16 a[44:45], v11 offset:10240
    ds_read_b64_tr_b16 a[46:47], v11 offset:11264
    ds_read_b64_tr_b16 a[48:49], v10 offset:12288
    ds_read_b64_tr_b16 a[50:51], v10 offset:13312
    ds_read_b64_tr_b16 a[52:53], v11 offset:12288
    ds_read_b64_tr_b16 a[54:55], v11 offset:13312
    s_waitcnt lgkmcnt(6)
    ds_read_b64_tr_b16 a[56:57], v10 offset:14336
    ds_read_b64_tr_b16 a[58:59], v10 offset:15360
    ds_read_b64_tr_b16 a[60:61], v11 offset:14336
    ds_read_b64_tr_b16 a[62:63], v11 offset:15360
    ds_read_b64_tr_b16 a[64:65], v10 offset:16384
    ds_read_b64_tr_b16 a[66:67], v10 offset:17408
    ds_read_b64_tr_b16 a[68:69], v11 offset:16384
    ds_read_b64_tr_b16 a[70:71], v11 offset:17408
    s_waitcnt lgkmcnt(6)
    ds_read_b64_tr_b16 a[72:73], v10 offset:18432
    ds_read_b64_tr_b16 a[74:75], v10 offset:19456
    ds_read_b64_tr_b16 a[76:77], v11 offset:18432
    ds_read_b64_tr_b16 a[78:79], v11 offset:19456
    ds_read_b64_tr_b16 a[80:81], v10 offset:20480
    ds_read_b64_tr_b16 a[82:83], v10 offset:21504
    ds_read_b64_tr_b16 a[84:85], v11 offset:20480
    ds_read_b64_tr_b16 a[86:87], v11 offset:21504
    s_waitcnt lgkmcnt(6)
    ds_read_b64_tr_b16 a[88:89], v10 offset:22528
    ds_read_b64_tr_b16 a[90:91], v10 offset:23552
    ds_read_b64_tr_b16 a[92:93], v11 offset:22528
    ds_read_b64_tr_b16 a[94:95], v11 offset:23552
    ds_read_b64_tr_b16 a[96:97], v10 offset:24576
    ds_read_b64_tr_b16 a[98:99], v10 offset:25600
    ds_read_b64_tr_b16 a[100:101], v11 offset:24576
    ds_read_b64_tr_b16 a[102:103], v11 offset:25600
    s_waitcnt lgkmcnt(6)
    ds_read_b64_tr_b16 a[104:105], v10 offset:26624
    ds_read_b64_tr_b16 a[106:107], v10 offset:27648
    ds_read_b64_tr_b16 a[108:109], v11 offset:26624
    ds_read_b64_tr_b16 a[110:111], v11 offset:27648
    ds_read_b64_tr_b16 a[112:113], v10 offset:28672
    ds_read_b64_tr_b16 a[114:115], v10 offset:29696
    ds_read_b64_tr_b16 a[116:117], v11 offset:28672
    ds_read_b64_tr_b16 a[118:119], v11 offset:29696
    s_waitcnt lgkmcnt(6)
    ds_read_b64_tr_b16 a[120:121], v10 offset:30720
    ds_read_b64_tr_b16 a[122:123], v10 offset:31744
    ds_read_b64_tr_b16 a[124:125], v11 offset:30720
    ds_read_b64_tr_b16 a[126:127], v11 offset:31744
    v_mov_b32 v14, 0x3f80
    v_mov_b32 v15, 0x3f800000
    v_and_b32 v12, 31, v1
    v_lshrrev_b32 v13, 5, v1
    v_lshlrev_b32 v13, 3, v13
    v_sub_u32 v12, v12, v13
    v_cmp_eq_u32 vcc, 0, v12
    v_cmp_eq_u32 s[58:59], 1, v12
    s_nop 0
    v_cndmask_b32 v104, 0, v14, vcc
    v_cndmask_b32 v104, v104, v15, s[58:59]
    v_cmp_eq_u32 vcc, 2, v12
    v_cmp_eq_u32 s[58:59], 3, v12
    s_nop 0
    v_cndmask_b32 v105, 0, v14, vcc
    v_cndmask_b32 v105, v105, v15, s[58:59]
    v_cmp_eq_u32 vcc, 4, v12
    v_cmp_eq_u32 s[58:59], 5, v12
    s_nop 0
    v_cndmask_b32 v106, 0, v14, vcc
    v_cndmask_b32 v106, v106, v15, s[58:59]
    v_cmp_eq_u32 vcc, 6, v12
    v_cmp_eq_u32 s[58:59], 7, v12
    s_nop 0
    v_cndmask_b32 v107, 0, v14, vcc
    v_cndmask_b32 v107, v107, v15, s[58:59]
    v_cmp_eq_u32 vcc, 16, v12
    v_cmp_eq_u32 s[58:59], 17, v12
    s_nop 0
    v_cndmask_b32 v108, 0, v14, vcc
    v_cndmask_b32 v108, v108, v15, s[58:59]
    v_cmp_eq_u32 vcc, 18, v12
    v_cmp_eq_u32 s[58:59], 19, v12
    s_nop 0
    v_cndmask_b32 v109, 0, v14, vcc
    v_cndmask_b32 v109, v109, v15, s[58:59]
    v_cmp_eq_u32 vcc, 20, v12
    v_cmp_eq_u32 s[58:59], 21, v12
    s_nop 0
    v_cndmask_b32 v110, 0, v14, vcc
    v_cndmask_b32 v110, v110, v15, s[58:59]
    v_cmp_eq_u32 vcc, 22, v12
    v_cmp_eq_u32 s[58:59], 23, v12
    s_nop 0
    v_cndmask_b32 v111, 0, v14, vcc
    v_cndmask_b32 v111, v111, v15, s[58:59]
    v_mov_b32 v14, 0x3f80
    v_mov_b32 v15, 0x3f800000
    v_and_b32 v12, 31, v1
    v_lshrrev_b32 v13, 5, v1
    v_lshlrev_b32 v13, 2, v13
    v_sub_u32 v12, v12, v13
    v_cmp_eq_u32 vcc, 0, v12
    v_cmp_eq_u32 s[58:59], 1, v12
    s_nop 0
    v_cndmask_b32 v112, 0, v14, vcc
    v_cndmask_b32 v112, v112, v15, s[58:59]
    v_cmp_eq_u32 vcc, 2, v12
    v_cmp_eq_u32 s[58:59], 3, v12
    s_nop 0
    v_cndmask_b32 v113, 0, v14, vcc
    v_cndmask_b32 v113, v113, v15, s[58:59]
    v_cmp_eq_u32 vcc, 8, v12
    v_cmp_eq_u32 s[58:59], 9, v12
    s_nop 0
    v_cndmask_b32 v114, 0, v14, vcc
    v_cndmask_b32 v114, v114, v15, s[58:59]
    v_cmp_eq_u32 vcc, 10, v12
    v_cmp_eq_u32 s[58:59], 11, v12
    s_nop 0
    v_cndmask_b32 v115, 0, v14, vcc
    v_cndmask_b32 v115, v115, v15, s[58:59]
    v_cmp_eq_u32 vcc, 16, v12
    v_cmp_eq_u32 s[58:59], 17, v12
    s_nop 0
    v_cndmask_b32 v116, 0, v14, vcc
    v_cndmask_b32 v116, v116, v15, s[58:59]
    v_cmp_eq_u32 vcc, 18, v12
    v_cmp_eq_u32 s[58:59], 19, v12
    s_nop 0
    v_cndmask_b32 v117, 0, v14, vcc
    v_cndmask_b32 v117, v117, v15, s[58:59]
    v_cmp_eq_u32 vcc, 24, v12
    v_cmp_eq_u32 s[58:59], 25, v12
    s_nop 0
    v_cndmask_b32 v118, 0, v14, vcc
    v_cndmask_b32 v118, v118, v15, s[58:59]
    v_cmp_eq_u32 vcc, 26, v12
    v_cmp_eq_u32 s[58:59], 27, v12
    s_nop 0
    v_cndmask_b32 v119, 0, v14, vcc
    v_cndmask_b32 v119, v119, v15, s[58:59]
    v_mov_b32 v128, 0
    v_mov_b32 v129, 0
    v_mov_b32 v130, 0
    v_mov_b32 v131, 0
    v_mov_b32 v132, 0
    v_mov_b32 v133, 0
    v_mov_b32 v134, 0
    v_mov_b32 v135, 0
    v_mov_b32 v136, 0
    v_mov_b32 v137, 0
    v_mov_b32 v138, 0
    v_mov_b32 v139, 0
    v_mov_b32 v140, 0
    v_mov_b32 v141, 0
    v_mov_b32 v142, 0
    v_mov_b32 v143, 0
    v_mov_b32 v144, 0
    v_mov_b32 v145, 0
    v_mov_b32 v146, 0
    v_mov_b32 v147, 0
    v_mov_b32 v148, 0
    v_mov_b32 v149, 0
    v_mov_b32 v150, 0
    v_mov_b32 v151, 0
    v_mov_b32 v152, 0
    v_mov_b32 v153, 0
    v_mov_b32 v154, 0
    v_mov_b32 v155, 0
    v_mov_b32 v156, 0
    v_mov_b32 v157, 0
    v_mov_b32 v158, 0
    v_mov_b32 v159, 0
    s_lshl_b32 s32, s31, 15
    s_lshl_b32 s33, s26, 14
    s_add_u32 s32, s32, s33
    s_add_u32 s32, s32, 7340032
    v_and_b32 v16, 15, v1
    v_lshlrev_b32 v16, 10, v16
    s_add_u32 s33, s32, 0
    buffer_load_dwordx4 v[32:35], v2, s[16:19], s33 offen offset:0 sc1
    buffer_load_dwordx4 v[36:39], v2, s[16:19], s33 offen offset:1024 sc1
    buffer_load_dwordx4 v[40:43], v2, s[16:19], s33 offen offset:2048 sc1
    buffer_load_dwordx4 v[44:47], v2, s[16:19], s33 offen offset:3072 sc1
    s_add_u32 s33, s32, 4096
    buffer_load_dwordx4 v[48:51], v2, s[16:19], s33 offen offset:0 sc1
    buffer_load_dwordx4 v[52:55], v2, s[16:19], s33 offen offset:1024 sc1
    buffer_load_dwordx4 v[56:59], v2, s[16:19], s33 offen offset:2048 sc1
    buffer_load_dwordx4 v[60:63], v2, s[16:19], s33 offen offset:3072 sc1
    s_add_u32 s33, s32, 8192
    buffer_load_dwordx4 v[64:67], v2, s[16:19], s33 offen offset:0 sc1
    buffer_load_dwordx4 v[68:71], v2, s[16:19], s33 offen offset:1024 sc1
    buffer_load_dwordx4 v[72:75], v2, s[16:19], s33 offen offset:2048 sc1
    buffer_load_dwordx4 v[76:79], v2, s[16:19], s33 offen offset:3072 sc1
    s_add_u32 s33, s32, 12288
    buffer_load_dwordx4 v[80:83], v2, s[16:19], s33 offen offset:0 sc1
    buffer_load_dwordx4 v[84:87], v2, s[16:19], s33 offen offset:1024 sc1
    buffer_load_dwordx4 v[88:91], v2, s[16:19], s33 offen offset:2048 sc1
    buffer_load_dwordx4 v[92:95], v2, s[16:19], s33 offen offset:3072 sc1
    s_waitcnt vmcnt(16)
    s_cmp_eq_u32 s26, 0
    s_cbranch_scc1 L_kc_r0
    v_mfma_f32_32x32x16_bf16 v[144:159], v[104:107], v[96:99], v[144:159]
    v_mfma_f32_32x32x16_bf16 v[144:159], v[108:111], v[100:103], v[144:159]
    s_branch L_kc_r1
L_kc_r0:
    s_nop 1
    v_mfma_f32_32x32x16_bf16 v[128:143], v[104:107], v[96:99], v[128:143]
    v_mfma_f32_32x32x16_bf16 v[128:143], v[108:111], v[100:103], v[128:143]
L_kc_r1:
    s_waitcnt vmcnt(0)
    v_max3_u32 v17, v32, v36, v40
    v_max3_u32 v18, v44, v48, v52
    v_max3_u32 v17, v17, v56, v60
    v_max3_u32 v18, v18, v64, v68
    v_max3_u32 v17, v17, v72, v76
    v_max3_u32 v18, v18, v80, v84
    v_max3_u32 v17, v17, v88, v92
    v_max_u32 v17, v17, v18
    v_cmp_eq_u32 vcc, -1, v17
    s_cbranch_vccnz L_kc_spin
L_kc_ok:
    s_waitcnt lgkmcnt(0)
    v_mfma_f32_32x32x16_bf16 v[128:143], a[0:3], v[32:35], v[128:143]
    v_mfma_f32_32x32x16_bf16 v[144:159], a[4:7], v[32:35], v[144:159]
    s_add_u32 m0, s80, 0
    s_add_u32 s34, s74, 917504
    buffer_load_dwordx4 v4, s[8:11], s34 offen offset:0 lds
    v_mfma_f32_32x32x16_bf16 v[128:143], a[8:11], v[36:39], v[128:143]
    v_mfma_f32_32x32x16_bf16 v[144:159], a[12:15], v[36:39], v[144:159]
    buffer_load_dwordx4 v5, s[8:11], s34 offen offset:1024 lds
    v_mfma_f32_32x32x16_bf16 v[128:143], a[16:19], v[40:43], v[128:143]
    v_mfma_f32_32x32x16_bf16 v[144:159], a[20:23], v[40:43], v[144:159]
    buffer_load_dwordx4 v6, s[8:11], s34 offen offset:2048 lds
    v_mfma_f32_32x32x16_bf16 v[128:143], a[24:27], v[44:47], v[128:143]
    v_mfma_f32_32x32x16_bf16 v[144:159], a[28:31], v[44:47], v[144:159]
    buffer_load_dwordx4 v7, s[8:11], s34 offen offset:3072 lds
    v_mfma_f32_32x32x16_bf16 v[128:143], a[32:35], v[48:51], v[128:143]
    v_mfma_f32_32x32x16_bf16 v[144:159], a[36:39], v[48:51], v[144:159]
    s_add_u32 m0, s80, 4096
    s_add_u32 s34, s74, 1032192
    buffer_load_dwordx4 v4, s[8:11], s34 offen offset:0 lds
    v_mfma_f32_32x32x16_bf16 v[128:143], a[40:43], v[52:55], v[128:143]
    v_mfma_f32_32x32x16_bf16 v[144:159], a[44:47], v[52:55], v[144:159]
    buffer_load_dwordx4 v5, s[8:11], s34 offen offset:1024 lds
    v_mfma_f32_32x32x16_bf16 v[128:143], a[48:51], v[56:59], v[128:143]
    v_mfma_f32_32x32x16_bf16 v[144:159], a[52:55], v[56:59], v[144:159]
    buffer_load_dwordx4 v6, s[8:11], s34 offen offset:2048 lds
    v_mfma_f32_32x32x16_bf16 v[128:143], a[56:59], v[60:63], v[128:143]
    v_mfma_f32_32x32x16_bf16 v[144:159], a[60:63], v[60:63], v[144:159]
    buffer_load_dwordx4 v7, s[8:11], s34 offen offset:3072 lds
    v_mfma_f32_32x32x16_bf16 v[128:143], a[64:67], v[64:67], v[128:143]
    v_mfma_f32_32x32x16_bf16 v[144:159], a[68:71], v[64:67], v[144:159]
    s_add_u32 m0, s80, 8192
    s_add_u32 s34, s74, 1146880
    buffer_load_dwordx4 v4, s[8:11], s34 offen offset:0 lds
    v_mfma_f32_32x32x16_bf16 v[128:143], a[72:75], v[68:71], v[128:143]
    v_mfma_f32_32x32x16_bf16 v[144:159], a[76:79], v[68:71], v[144:159]
    buffer_load_dwordx4 v5, s[8:11], s34 offen offset:1024 lds
    v_mfma_f32_32x32x16_bf16 v[128:143], a[80:83], v[72:75], v[128:143]
    v_mfma_f32_32x32x16_bf16 v[144:159], a[84:87], v[72:75], v[144:159]
    buffer_load_dwordx4 v6, s[8:11], s34 offen offset:2048 lds
    v_mfma_f32_32x32x16_bf16 v[128:143], a[88:91], v[76:79], v[128:143]
    v_mfma_f32_32x32x16_bf16 v[144:159], a[92:95], v[76:79], v[144:159]
    buffer_load_dwordx4 v7, s[8:11], s34 offen offset:3072 lds
    v_mfma_f32_32x32x16_bf16 v[128:143], a[96:99], v[80:83], v[128:143]
    v_mfma_f32_32x32x16_bf16 v[144:159], a[100:103], v[80:83], v[144:159]
    s_add_u32 m0, s80, 12288
    s_add_u32 s34, s74, 1261568
    buffer_load_dwordx4 v4, s[8:11], s34 offen offset:0 lds
    v_mfma_f32_32x32x16_bf16 v[128:143], a[104:107], v[84:87], v[128:143]
    v_mfma_f32_32x32x16_bf16 v[144:159], a[108:111], v[84:87], v[144:159]
    buffer_load_dwordx4 v5, s[8:11], s34 offen offset:1024 lds
    v_mfma_f32_32x32x16_bf16 v[128:143], a[112:115], v[88:91], v[128:143]
    v_mfma_f32_32x32x16_bf16 v[144:159], a[116:119], v[88:91], v[144:159]
    buffer_load_dwordx4 v6, s[8:11], s34 offen offset:2048 lds
    v_mfma_f32_32x32x16_bf16 v[128:143], a[120:123], v[92:95], v[128:143]
    v_mfma_f32_32x32x16_bf16 v[144:159], a[124:127], v[92:95], v[144:159]
    buffer_load_dwordx4 v7, s[8:11], s34 offen offset:3072 lds
    s_xor_b32 s34, s22, 1
    s_lshl_b32 s34, s34, 12
    s_add_u32 s34, s34, 131072
    v_add_u32 v8, s34, v2
    s_lshl_b32 s34, s22, 12
    s_add_u32 s34, s34, 131072
    v_add_u32 v9, s34, v2
    s_cmp_eq_u32 s26, 0
    s_cbranch_scc1 L_kc_k0
    s_nop 0
    ds_write_b128 v8, v[128:131] offset:0
    ds_write_b128 v8, v[132:135] offset:1024
    ds_write_b128 v8, v[136:139] offset:2048
    ds_write_b128 v8, v[140:143] offset:3072
    v_mov_b32 v240, v144
    v_mov_b32 v241, v145
    v_mov_b32 v242, v146
    v_mov_b32 v243, v147
    v_mov_b32 v244, v148
    v_mov_b32 v245, v149
    v_mov_b32 v246, v150
    v_mov_b32 v247, v151
    v_mov_b32 v248, v152
    v_mov_b32 v249, v153
    v_mov_b32 v250, v154
    v_mov_b32 v251, v155
    v_mov_b32 v252, v156
    v_mov_b32 v253, v157
    v_mov_b32 v254, v158
    v_mov_b32 v255, v159
    s_branch L_kc_k1
L_kc_k0:
    s_nop 11
    ds_write_b128 v8, v[144:147] offset:0
    ds_write_b128 v8, v[148:151] offset:1024
    ds_write_b128 v8, v[152:155] offset:2048
    ds_write_b128 v8, v[156:159] offset:3072
    v_mov_b32 v240, v128
    v_mov_b32 v241, v129
    v_mov_b32 v242, v130
    v_mov_b32 v243, v131
    v_mov_b32 v244, v132
    v_mov_b32 v245, v133
    v_mov_b32 v246, v134
    v_mov_b32 v247, v135
    v_mov_b32 v248, v136
    v_mov_b32 v249, v137
    v_mov_b32 v250, v138
    v_mov_b32 v251, v139
    v_mov_b32 v252, v140
    v_mov_b32 v253, v141
    v_mov_b32 v254, v142
    v_mov_b32 v255, v143
L_kc_k1:
    s_waitcnt lgkmcnt(0)
    s_barrier
    ds_read_b128 v[144:147], v9 offset:0
    ds_read_b128 v[148:151], v9 offset:1024
    ds_read_b128 v[152:155], v9 offset:2048
    ds_read_b128 v[156:159], v9 offset:3072
    s_waitcnt lgkmcnt(0)
    v_add_f32 v240, v240, v144
    v_add_f32 v241, v241, v145
    v_add_f32 v242, v242, v146
    v_add_f32 v243, v243, v147
    v_add_f32 v244, v244, v148
    v_add_f32 v245, v245, v149
    v_add_f32 v246, v246, v150
    v_add_f32 v247, v247, v151
    v_add_f32 v248, v248, v152
    v_add_f32 v249, v249, v153
    v_add_f32 v250, v250, v154
    v_add_f32 v251, v251, v155
    v_add_f32 v252, v252, v156
    v_add_f32 v253, v253, v157
    v_add_f32 v254, v254, v158
    v_add_f32 v255, v255, v159
    v_add_f32 v16, v240, v241
    v_mul_f32 v17, v240, v240
    v_add_f32 v18, v242, v243
    v_mul_f32 v19, v242, v242
    v_fma_f32 v17, v241, v241, v17
    v_fma_f32 v19, v243, v243, v19
    v_add_f32 v16, v16, v244
    v_fma_f32 v17, v244, v244, v17
    v_add_f32 v18, v18, v245
    v_fma_f32 v19, v245, v245, v19
    v_add_f32 v16, v16, v246
    v_fma_f32 v17, v246, v246, v17
    v_add_f32 v18, v18, v247
    v_fma_f32 v19, v247, v247, v19
    v_add_f32 v16, v16, v248
    v_fma_f32 v17, v248, v248, v17
    v_add_f32 v18, v18, v249
    v_fma_f32 v19, v249, v249, v19
    v_add_f32 v16, v16, v250
    v_fma_f32 v17, v250, v250, v17
    v_add_f32 v18, v18, v251
    v_fma_f32 v19, v251, v251, v19
    v_add_f32 v16, v16, v252
    v_fma_f32 v17, v252, v252, v17
    v_add_f32 v18, v18, v253
    v_fma_f32 v19, v253, v253, v19
    v_add_f32 v16, v16, v254
    v_fma_f32 v17, v254, v254, v17
    v_add_f32 v18, v18, v255
    v_fma_f32 v19, v255, v255, v19
    v_add_f32 v16, v16, v18
    v_add_f32 v17, v17, v19
    v_mov_b32 v18, v16
    v_mov_b32 v19, v17
    s_nop 0
    v_permlane32_swap_b32 v16, v18
    v_permlane32_swap_b32 v17, v19
    v_add_f32 v16, v16, v18
    v_add_f32 v17, v17, v19
    v_min_u32 v16, 0xfffffffe, v16
    v_min_u32 v17, 0xfffffffe, v17
    s_lshl_b32 s34, s31, 12
    s_add_u32 s39, s34, 9437184
    s_lshl_b32 s35, s23, 1
    s_add_u32 s35, s35, s26
    s_lshl_b32 s35, s35, 8
    s_add_u32 s35, s35, s39
    v_and_b32 v8, 31, v1
    v_lshlrev_b32 v8, 3, v8
    s_mov_b32 exec_hi, 0
    buffer_store_dwordx2 v[16:17], v8, s[16:19], s35 offen sc0 sc1
    s_mov_b64 exec, -1
    s_waitcnt vmcnt(9)
    s_waitcnt lgkmcnt(0)
    ds_read_b64_tr_b16 a[128:129], v26 offset:0
    ds_read_b64_tr_b16 a[130:131], v26 offset:1024
    ds_read_b64_tr_b16 a[132:133], v27 offset:0
    ds_read_b64_tr_b16 a[134:135], v27 offset:1024
    ds_read_b64_tr_b16 a[136:137], v26 offset:2048
    ds_read_b64_tr_b16 a[138:139], v26 offset:3072
    ds_read_b64_tr_b16 a[140:141], v27 offset:2048
    ds_read_b64_tr_b16 a[142:143], v27 offset:3072
    ds_read_b64_tr_b16 a[144:145], v26 offset:4096
    ds_read_b64_tr_b16 a[146:147], v26 offset:5120
    ds_read_b64_tr_b16 a[148:149], v27 offset:4096
    ds_read_b64_tr_b16 a[150:151], v27 offset:5120
    s_waitcnt lgkmcnt(8)
    ds_read_b64_tr_b16 a[152:153], v26 offset:6144
    ds_read_b64_tr_b16 a[154:155], v26 offset:7168
    ds_read_b64_tr_b16 a[156:157], v27 offset:6144
    ds_read_b64_tr_b16 a[158:159], v27 offset:7168
    s_waitcnt vmcnt(1)
    s_waitcnt lgkmcnt(0)
    ds_read_b64_tr_b16 a[160:161], v26 offset:8192
    ds_read_b64_tr_b16 a[162:163], v26 offset:9216
    ds_read_b64_tr_b16 a[164:165], v27 offset:8192
    ds_read_b64_tr_b16 a[166:167], v27 offset:9216
    ds_read_b64_tr_b16 a[168:169], v26 offset:10240
    ds_read_b64_tr_b16 a[170:171], v26 offset:11264
    ds_read_b64_tr_b16 a[172:173], v27 offset:10240
    ds_read_b64_tr_b16 a[174:175], v27 offset:11264
    ds_read_b64_tr_b16 a[176:177], v26 offset:12288
    ds_read_b64_tr_b16 a[178:179], v26 offset:13312
    ds_read_b64_tr_b16 a[180:181], v27 offset:12288
    ds_read_b64_tr_b16 a[182:183], v27 offset:13312
    s_waitcnt lgkmcnt(8)
    ds_read_b64_tr_b16 a[184:185], v26 offset:14336
    ds_read_b64_tr_b16 a[186:187], v26 offset:15360
    ds_read_b64_tr_b16 a[188:189], v27 offset:14336
    ds_read_b64_tr_b16 a[190:191], v27 offset:15360
    s_waitcnt lgkmcnt(0)
    s_add_u32 m0, s80, 0
    s_add_u32 s34, s74, 1376256
    buffer_load_dwordx4 v4, s[8:11], s34 offen offset:0 lds
    buffer_load_dwordx4 v5, s[8:11], s34 offen offset:1024 lds
    buffer_load_dwordx4 v6, s[8:11], s34 offen offset:2048 lds
    buffer_load_dwordx4 v7, s[8:11], s34 offen offset:3072 lds
    s_add_u32 m0, s80, 4096
    s_add_u32 s34, s74, 1490944
    buffer_load_dwordx4 v4, s[8:11], s34 offen offset:0 lds
    buffer_load_dwordx4 v5, s[8:11], s34 offen offset:1024 lds
    buffer_load_dwordx4 v6, s[8:11], s34 offen offset:2048 lds
    buffer_load_dwordx4 v7, s[8:11], s34 offen offset:3072 lds
    s_add_u32 m0, s80, 8192
    s_add_u32 s34, s74, 1605632
    buffer_load_dwordx4 v4, s[8:11], s34 offen offset:0 lds
    buffer_load_dwordx4 v5, s[8:11], s34 offen offset:1024 lds
    buffer_load_dwordx4 v6, s[8:11], s34 offen offset:2048 lds
    buffer_load_dwordx4 v7, s[8:11], s34 offen offset:3072 lds
    s_add_u32 m0, s80, 12288
    s_add_u32 s34, s74, 1720320
    buffer_load_dwordx4 v4, s[8:11], s34 offen offset:0 lds
    buffer_load_dwordx4 v5, s[8:11], s34 offen offset:1024 lds
    buffer_load_dwordx4 v6, s[8:11], s34 offen offset:2048 lds
    buffer_load_dwordx4 v7, s[8:11], s34 offen offset:3072 lds
    v_lshrrev_b32 v9, 5, v1
    v_lshl_add_u32 v8, v9, 11, v8
    s_mov_b32 s37, 262144
L_kc_poll:
    buffer_load_dwordx2 v[32:33], v8, s[16:19], s39 offen offset:0 sc0 sc1
    buffer_load_dwordx2 v[34:35], v8, s[16:19], s39 offen offset:256 sc0 sc1
    buffer_load_dwordx2 v[36:37], v8, s[16:19], s39 offen offset:512 sc0 sc1
    buffer_load_dwordx2 v[38:39], v8, s[16:19], s39 offen offset:768 sc0 sc1
    buffer_load_dwordx2 v[40:41], v8, s[16:19], s39 offen offset:1024 sc0 sc1
    buffer_load_dwordx2 v[42:43], v8, s[16:19], s39 offen offset:1280 sc0 sc1
    buffer_load_dwordx2 v[44:45], v8, s[16:19], s39 offen offset:1536 sc0 sc1
    buffer_load_dwordx2 v[46:47], v8, s[16:19], s39 offen offset:1792 sc0 sc1
    s_waitcnt vmcnt(0)
    v_max_u32 v48, v32, v33
    v_max3_u32 v48, v34, v35, v48
    v_max3_u32 v48, v36, v37, v48
    v_max3_u32 v48, v38, v39, v48
    v_max3_u32 v48, v40, v41, v48
    v_max3_u32 v48, v42, v43, v48
    v_max3_u32 v48, v44, v45, v48
    v_max3_u32 v48, v46, v47, v48
    v_cmp_eq_u32 vcc, -1, v48
    s_sub_u32 s37, s37, 1
    s_cmp_eq_u32 s37, 0
    s_cbranch_scc1 L_kc_go
    s_cbranch_vccnz L_kc_poll
L_kc_go:
    v_add_f32 v32, v32, v40
    v_add_f32 v33, v33, v41
    v_add_f32 v34, v34, v42
    v_add_f32 v35, v35, v43
    v_add_f32 v36, v36, v44
    v_add_f32 v37, v37, v45
    v_add_f32 v38, v38, v46
    v_add_f32 v39, v39, v47
    v_add_f32 v32, v32, v36
    v_add_f32 v33, v33, v37
    v_add_f32 v34, v34, v38
    v_add_f32 v35, v35, v39
    v_add_f32 v32, v32, v34
    v_add_f32 v33, v33, v35
    v_mov_b32 v34, v32
    v_mov_b32 v35, v33
    s_nop 0
    v_permlane32_swap_b32 v32, v34
    v_permlane32_swap_b32 v33, v35
    v_add_f32 v32, v32, v34
    v_add_f32 v33, v33, v35
    s_mov_b32 s30, 0x3b000000
    v_mul_f32 v32, s30, v32
    v_mul_f32 v33, s30, v33
    v_fma_f32 v33, -v32, v32, v33
    v_max_f32 v33, 0, v33
    v_add_f32 v34, 0x3727c5ac, v33
    v_rsq_f32 v34, v34
    s_nop 0
    v_mul_f32 v35, v33, v34
    v_mul_f32 v35, v35, v34
    v_add_f32 v35, 0x3727c5ac, v35
    v_rsq_f32 v35, v35
    s_nop 0
    v_mul_f32 v34, v34, v35
    v_mul_f32 v36, v32, v34
    v_sub_f32 v36, 0, v36
    v_mov_b32 v35, v34
    v_mov_b32 v37, v36
    v_pk_fma_f32 v[160:161], v[240:241], v[34:35], v[36:37]
    v_pk_fma_f32 v[162:163], v[242:243], v[34:35], v[36:37]
    v_pk_fma_f32 v[164:165], v[244:245], v[34:35], v[36:37]
    v_pk_fma_f32 v[166:167], v[246:247], v[34:35], v[36:37]
    v_pk_fma_f32 v[168:169], v[248:249], v[34:35], v[36:37]
    v_pk_fma_f32 v[170:171], v[250:251], v[34:35], v[36:37]
    v_pk_fma_f32 v[172:173], v[252:253], v[34:35], v[36:37]
    v_pk_fma_f32 v[174:175], v[254:255], v[34:35], v[36:37]
    v_cvt_pk_bf16_f32 v40, v160, v161
    v_cvt_pk_bf16_f32 v41, v162, v163
    v_cvt_pk_bf16_f32 v42, v164, v165
    v_cvt_pk_bf16_f32 v43, v166, v167
    v_cvt_pk_bf16_f32 v44, v168, v169
    v_cvt_pk_bf16_f32 v45, v170, v171
    v_cvt_pk_bf16_f32 v46, v172, v173
    v_cvt_pk_bf16_f32 v47, v174, v175
    v_mfma_f32_32x32x16_bf16 v[144:159], v[40:43], v[112:115], 0
    s_nop 0
    v_mfma_f32_32x32x16_bf16 v[144:159], v[44:47], v[116:119], v[144:159]
    s_lshl_b32 s35, s23, 1
    s_add_u32 s35, s35, s26
    s_lshl_b32 s35, s35, 7
    s_lshl_b32 s36, s31, 1
    s_add_u32 s35, s35, s36
    s_lshl_b32 s35, s35, 10
    s_add_u32 s35, s35, 12582912
    s_nop 4
    v_cvt_pk_bf16_f32 v48, v144, v145
    v_cvt_pk_bf16_f32 v49, v146, v147
    v_cvt_pk_bf16_f32 v50, v148, v149
    v_cvt_pk_bf16_f32 v51, v150, v151
    v_cvt_pk_bf16_f32 v52, v152, v153
    v_cvt_pk_bf16_f32 v53, v154, v155
    v_cvt_pk_bf16_f32 v54, v156, v157
    v_cvt_pk_bf16_f32 v55, v158, v159
    v_min_u32 v48, 0xfffffffe, v48
    v_min_u32 v52, 0xfffffffe, v52
    buffer_store_dwordx4 v[48:51], v2, s[16:19], s35 offen sc1
    buffer_store_dwordx4 v[52:55], v2, s[16:19], s35 offen offset:1024 sc1
    s_waitcnt lgkmcnt(0)
    ds_read_b64_tr_b16 a[192:193], v26 offset:0
    ds_read_b64_tr_b16 a[194:195], v26 offset:1024
    ds_read_b64_tr_b16 a[196:197], v27 offset:0
    ds_read_b64_tr_b16 a[198:199], v27 offset:1024
    ds_read_b64_tr_b16 a[200:201], v26 offset:2048
    ds_read_b64_tr_b16 a[202:203], v26 offset:3072
    ds_read_b64_tr_b16 a[204:205], v27 offset:2048
    ds_read_b64_tr_b16 a[206:207], v27 offset:3072
    ds_read_b64_tr_b16 a[208:209], v26 offset:4096
    ds_read_b64_tr_b16 a[210:211], v26 offset:5120
    ds_read_b64_tr_b16 a[212:213], v27 offset:4096
    ds_read_b64_tr_b16 a[214:215], v27 offset:5120
    s_waitcnt lgkmcnt(8)
    ds_read_b64_tr_b16 a[216:217], v26 offset:6144
    ds_read_b64_tr_b16 a[218:219], v26 offset:7168
    ds_read_b64_tr_b16 a[220:221], v27 offset:6144
    ds_read_b64_tr_b16 a[222:223], v27 offset:7168
    s_waitcnt lgkmcnt(0)
    ds_read_b64_tr_b16 a[224:225], v26 offset:8192
    ds_read_b64_tr_b16 a[226:227], v26 offset:9216
    ds_read_b64_tr_b16 a[228:229], v27 offset:8192
    ds_read_b64_tr_b16 a[230:231], v27 offset:9216
    ds_read_b64_tr_b16 a[232:233], v26 offset:10240
    ds_read_b64_tr_b16 a[234:235], v26 offset:11264
    ds_read_b64_tr_b16 a[236:237], v27 offset:10240
    ds_read_b64_tr_b16 a[238:239], v27 offset:11264
    ds_read_b64_tr_b16 a[240:241], v26 offset:12288
    ds_read_b64_tr_b16 a[242:243], v26 offset:13312
    ds_read_b64_tr_b16 a[244:245], v27 offset:12288
    ds_read_b64_tr_b16 a[246:247], v27 offset:13312
    s_waitcnt lgkmcnt(8)
    ds_read_b64_tr_b16 a[248:249], v26 offset:14336
    ds_read_b64_tr_b16 a[250:251], v26 offset:15360
    ds_read_b64_tr_b16 a[252:253], v27 offset:14336
    ds_read_b64_tr_b16 a[254:255], v27 offset:15360
    s_waitcnt lgkmcnt(0)
    s_barrier
    s_mul_i32 s80, s22, 24576
    s_lshl_b32 s69, s26, 6
    v_xor_b32 v26, s69, v24
    v_xor_b32 v27, s69, v25
    v_add_u32 v26, s80, v26
    v_add_u32 v27, s80, v27
    s_cmp_ge_u32 s2, 224
    s_cbranch_scc1 L_kd_skip
    s_add_u32 m0, s80, 0
    s_add_u32 s34, s74, 0
    buffer_load_dwordx4 v4, s[8:11], s34 offen offset:0 lds
    buffer_load_dwordx4 v5, s[8:11], s34 offen offset:1024 lds
    buffer_load_dwordx4 v6, s[8:11], s34 offen offset:2048 lds
    buffer_load_dwordx4 v7, s[8:11], s34 offen offset:3072 lds
    s_add_u32 m0, s80, 4096
    s_add_u32 s34, s74, 114688
    buffer_load_dwordx4 v4, s[8:11], s34 offen offset:0 lds
    buffer_load_dwordx4 v5, s[8:11], s34 offen offset:1024 lds
    buffer_load_dwordx4 v6, s[8:11], s34 offen offset:2048 lds
    buffer_load_dwordx4 v7, s[8:11], s34 offen offset:3072 lds
    s_add_u32 m0, s80, 8192
    s_add_u32 s34, s74, 229376
    buffer_load_dwordx4 v4, s[8:11], s34 offen offset:0 lds
    buffer_load_dwordx4 v5, s[8:11], s34 offen offset:1024 lds
    buffer_load_dwordx4 v6, s[8:11], s34 offen offset:2048 lds
    buffer_load_dwordx4 v7, s[8:11], s34 offen offset:3072 lds
    s_add_u32 m0, s80, 12288
    s_add_u32 s34, s74, 344064
    buffer_load_dwordx4 v4, s[8:11], s34 offen offset:0 lds
    buffer_load_dwordx4 v5, s[8:11], s34 offen offset:1024 lds
    buffer_load_dwordx4 v6, s[8:11], s34 offen offset:2048 lds
    buffer_load_dwordx4 v7, s[8:11], s34 offen offset:3072 lds
    s_lshl_b32 s32, s70, 18
    s_lshl_b32 s33, s22, 15
    s_add_u32 s32, s32, s33
    s_add_u32 s32, s32, 12582912
    s_lshr_b32 s33, s22, 1
    s_mul_i32 s77, s33, 131072
    s_add_u32 s77, s77, s32
    s_mul_i32 s78, s33, 4294705152
    s_add_u32 s78, s78, 131072
    v_bfe_u32 v16, v1, 2, 1
    s_mov_b32 s69, 131072
    v_mul_lo_u32 v16, v16, s69
    v_and_b32 v17, 3, v1
    v_lshl_add_u32 v16, v17, 10, v16
    v_lshlrev_b32 v160, 16, v224
    v_and_b32 v161, 0xffff0000, v224
    v_lshlrev_b32 v162, 16, v225
    v_and_b32 v163, 0xffff0000, v225
    v_lshlrev_b32 v164, 16, v226
    v_and_b32 v165, 0xffff0000, v226
    v_lshlrev_b32 v166, 16, v227
    v_and_b32 v167, 0xffff0000, v227
    v_lshlrev_b32 v168, 16, v228
    v_and_b32 v169, 0xffff0000, v228
    v_lshlrev_b32 v170, 16, v229
    v_and_b32 v171, 0xffff0000, v229
    v_lshlrev_b32 v172, 16, v230
    v_and_b32 v173, 0xffff0000, v230
    v_lshlrev_b32 v174, 16, v231
    v_and_b32 v175, 0xffff0000, v231
    v_mov_b32 v176, 0
    v_mov_b32 v177, 0
    v_mov_b32 v178, 0
    v_mov_b32 v179, 0
    v_mov_b32 v180, 0
    v_mov_b32 v181, 0
    v_mov_b32 v182, 0
    v_mov_b32 v183, 0
    v_mov_b32 v184, 0
    v_mov_b32 v185, 0
    v_mov_b32 v186, 0
    v_mov_b32 v187, 0
    v_mov_b32 v188, 0
    v_mov_b32 v189, 0
    v_mov_b32 v190, 0
    v_mov_b32 v191, 0
    v_mov_b32 v192, 0
    v_mov_b32 v193, 0
    v_mov_b32 v194, 0
    v_mov_b32 v195, 0
    v_mov_b32 v196, 0
    v_mov_b32 v197, 0
    v_mov_b32 v198, 0
    v_mov_b32 v199, 0
    v_mov_b32 v200, 0
    v_mov_b32 v201, 0
    v_mov_b32 v202, 0
    v_mov_b32 v203, 0
    v_mov_b32 v204, 0
    v_mov_b32 v205, 0
    v_mov_b32 v206, 0
    v_mov_b32 v207, 0
    v_mov_b32 v208, 0
    v_mov_b32 v209, 0
    v_mov_b32 v210, 0
    v_mov_b32 v211, 0
    v_mov_b32 v212, 0
    v_mov_b32 v213, 0
    v_mov_b32 v214, 0
    v_mov_b32 v215, 0
    v_mov_b32 v216, 0
    v_mov_b32 v217, 0
    v_mov_b32 v218, 0
    v_mov_b32 v219, 0
    v_mov_b32 v220, 0
    v_mov_b32 v221, 0
    v_mov_b32 v222, 0
    v_mov_b32 v223, 0
    s_add_u32 s35, s77, 0
    s_add_u32 s36, s35, s78
    buffer_load_dwordx4 v[32:35], v2, s[16:19], s35 offen offset:0 sc1
    buffer_load_dwordx4 v[36:39], v2, s[16:19], s36 offen offset:0 sc1
    buffer_load_dwordx4 v[40:43], v2, s[16:19], s35 offen offset:1024 sc1
    buffer_load_dwordx4 v[44:47], v2, s[16:19], s36 offen offset:1024 sc1
    buffer_load_dwordx4 v[48:51], v2, s[16:19], s35 offen offset:2048 sc1
    buffer_load_dwordx4 v[52:55], v2, s[16:19], s36 offen offset:2048 sc1
    buffer_load_dwordx4 v[56:59], v2, s[16:19], s35 offen offset:3072 sc1
    buffer_load_dwordx4 v[60:63], v2, s[16:19], s36 offen offset:3072 sc1
    s_add_u32 s35, s77, 4096
    s_add_u32 s36, s35, s78
    buffer_load_dwordx4 v[64:67], v2, s[16:19], s35 offen offset:0 sc1
    buffer_load_dwordx4 v[68:71], v2, s[16:19], s36 offen offset:0 sc1
    buffer_load_dwordx4 v[72:75], v2, s[16:19], s35 offen offset:1024 sc1
    buffer_load_dwordx4 v[76:79], v2, s[16:19], s36 offen offset:1024 sc1
    buffer_load_dwordx4 v[80:83], v2, s[16:19], s35 offen offset:2048 sc1
    buffer_load_dwordx4 v[84:87], v2, s[16:19], s36 offen offset:2048 sc1
    buffer_load_dwordx4 v[88:91], v2, s[16:19], s35 offen offset:3072 sc1
    buffer_load_dwordx4 v[92:95], v2, s[16:19], s36 offen offset:3072 sc1
    s_waitcnt vmcnt(24)
    s_waitcnt lgkmcnt(0)
    ds_read_b64_tr_b16 a[0:1], v26 offset:0
    ds_read_b64_tr_b16 a[2:3], v26 offset:1024
    ds_read_b64_tr_b16 a[4:5], v27 offset:0
    ds_read_b64_tr_b16 a[6:7], v27 offset:1024
    ds_read_b64_tr_b16 a[8:9], v26 offset:2048
    ds_read_b64_tr_b16 a[10:11], v26 offset:3072
    ds_read_b64_tr_b16 a[12:13], v27 offset:2048
    ds_read_b64_tr_b16 a[14:15], v27 offset:3072
    ds_read_b64_tr_b16 a[16:17], v26 offset:4096
    ds_read_b64_tr_b16 a[18:19], v26 offset:5120
    ds_read_b64_tr_b16 a[20:21], v27 offset:4096
    ds_read_b64_tr_b16 a[22:23], v27 offset:5120
    s_waitcnt lgkmcnt(8)
    ds_read_b64_tr_b16 a[24:25], v26 offset:6144
    ds_read_b64_tr_b16 a[26:27], v26 offset:7168
    ds_read_b64_tr_b16 a[28:29], v27 offset:6144
    ds_read_b64_tr_b16 a[30:31], v27 offset:7168
    s_waitcnt vmcnt(16)
    s_waitcnt lgkmcnt(0)
    ds_read_b64_tr_b16 a[32:33], v26 offset:8192
    ds_read_b64_tr_b16 a[34:35], v26 offset:9216
    ds_read_b64_tr_b16 a[36:37], v27 offset:8192
    ds_read_b64_tr_b16 a[38:39], v27 offset:9216
    ds_read_b64_tr_b16 a[40:41], v26 offset:10240
    ds_read_b64_tr_b16 a[42:43], v26 offset:11264
    ds_read_b64_tr_b16 a[44:45], v27 offset:10240
    ds_read_b64_tr_b16 a[46:47], v27 offset:11264
    ds_read_b64_tr_b16 a[48:49], v26 offset:12288
    ds_read_b64_tr_b16 a[50:51], v26 offset:13312
    ds_read_b64_tr_b16 a[52:53], v27 offset:12288
    ds_read_b64_tr_b16 a[54:55], v27 offset:13312
    s_waitcnt lgkmcnt(8)
    ds_read_b64_tr_b16 a[56:57], v26 offset:14336
    ds_read_b64_tr_b16 a[58:59], v26 offset:15360
    ds_read_b64_tr_b16 a[60:61], v27 offset:14336
    ds_read_b64_tr_b16 a[62:63], v27 offset:15360
    s_add_u32 m0, s80, 16384
    s_add_u32 s34, s74, 458752
    buffer_load_dwordx4 v4, s[8:11], s34 offen offset:0 lds
    buffer_load_dwordx4 v5, s[8:11], s34 offen offset:1024 lds
    buffer_load_dwordx4 v6, s[8:11], s34 offen offset:2048 lds
    buffer_load_dwordx4 v7, s[8:11], s34 offen offset:3072 lds
    s_add_u32 m0, s80, 20480
    s_add_u32 s34, s74, 573440
    buffer_load_dwordx4 v4, s[8:11], s34 offen offset:0 lds
    buffer_load_dwordx4 v5, s[8:11], s34 offen offset:1024 lds
    buffer_load_dwordx4 v6, s[8:11], s34 offen offset:2048 lds
    buffer_load_dwordx4 v7, s[8:11], s34 offen offset:3072 lds
    s_add_u32 s35, s77, 8192
    s_add_u32 s36, s35, s78
    buffer_load_dwordx4 v[96:99], v2, s[16:19], s35 offen offset:0 sc1
    buffer_load_dwordx4 v[100:103], v2, s[16:19], s36 offen offset:0 sc1
    buffer_load_dwordx4 v[104:107], v2, s[16:19], s35 offen offset:1024 sc1
    buffer_load_dwordx4 v[108:111], v2, s[16:19], s36 offen offset:1024 sc1
    buffer_load_dwordx4 v[112:115], v2, s[16:19], s35 offen offset:2048 sc1
    buffer_load_dwordx4 v[116:119], v2, s[16:19], s36 offen offset:2048 sc1
    buffer_load_dwordx4 v[120:123], v2, s[16:19], s35 offen offset:3072 sc1
    buffer_load_dwordx4 v[124:127], v2, s[16:19], s36 offen offset:3072 sc1
    s_waitcnt vmcnt(24)
    v_max3_u32 v17, v32, v36, v40
    v_max3_u32 v18, v44, v48, v52
    v_max3_u32 v17, v17, v56, v60
    v_max_u32 v17, v17, v18
    v_cmp_eq_u32 vcc, -1, v17
    s_cbranch_vccnz L_kd_first_again
L_kd_first_ok:
    s_waitcnt lgkmcnt(0)
    v_mfma_f32_32x32x16_bf16 v[160:175], a[0:3], v[32:35], v[160:175]
    s_add_u32 s35, s77, 12288
    s_add_u32 s36, s35, s78
    buffer_load_dwordx4 v[128:131], v2, s[16:19], s35 offen offset:0 sc1
    v_mfma_f32_32x32x16_bf16 v[192:207], a[0:3], v[36:39], v[192:207]
    buffer_load_dwordx4 v[132:135], v2, s[16:19], s36 offen offset:0 sc1
    v_mfma_f32_32x32x16_bf16 v[176:191], a[4:7], v[32:35], v[176:191]
    buffer_load_dwordx4 v[136:139], v2, s[16:19], s35 offen offset:1024 sc1
    v_mfma_f32_32x32x16_bf16 v[208:223], a[4:7], v[36:39], v[208:223]
    v_mfma_f32_32x32x16_bf16 v[160:175], a[8:11], v[40:43], v[160:175]
    buffer_load_dwordx4 v[140:143], v2, s[16:19], s36 offen offset:1024 sc1
    v_mfma_f32_32x32x16_bf16 v[192:207], a[8:11], v[44:47], v[192:207]
    buffer_load_dwordx4 v[144:147], v2, s[16:19], s35 offen offset:2048 sc1
    v_mfma_f32_32x32x16_bf16 v[176:191], a[12:15], v[40:43], v[176:191]
    buffer_load_dwordx4 v[148:151], v2, s[16:19], s36 offen offset:2048 sc1
    v_mfma_f32_32x32x16_bf16 v[208:223], a[12:15], v[44:47], v[208:223]
    v_mfma_f32_32x32x16_bf16 v[160:175], a[16:19], v[48:51], v[160:175]
    buffer_load_dwordx4 v[152:155], v2, s[16:19], s35 offen offset:3072 sc1
    v_mfma_f32_32x32x16_bf16 v[192:207], a[16:19], v[52:55], v[192:207]
    buffer_load_dwordx4 v[156:159], v2, s[16:19], s36 offen offset:3072 sc1
    v_mfma_f32_32x32x16_bf16 v[176:191], a[20:23], v[48:51], v[176:191]
    s_add_u32 m0, s80, 0
    s_add_u32 s34, s74, 688128
    buffer_load_dwordx4 v4, s[8:11], s34 offen offset:0 lds
    v_mfma_f32_32x32x16_bf16 v[208:223], a[20:23], v[52:55], v[208:223]
    s_waitcnt vmcnt(25)
    v_max3_u32 v17, v64, v68, v72
    v_max3_u32 v18, v76, v80, v84
    v_max3_u32 v17, v17, v88, v92
    v_max_u32 v17, v17, v18
    v_cmp_eq_u32 vcc, -1, v17
    s_cbranch_vccnz L_kd_retry1
L_kd_ok1:
    v_mfma_f32_32x32x16_bf16 v[160:175], a[24:27], v[56:59], v[160:175]
    buffer_load_dwordx4 v5, s[8:11], s34 offen offset:1024 lds
    v_mfma_f32_32x32x16_bf16 v[192:207], a[24:27], v[60:63], v[192:207]
    buffer_load_dwordx4 v6, s[8:11], s34 offen offset:2048 lds
    v_mfma_f32_32x32x16_bf16 v[176:191], a[28:31], v[56:59], v[176:191]
    buffer_load_dwordx4 v7, s[8:11], s34 offen offset:3072 lds
    v_mfma_f32_32x32x16_bf16 v[208:223], a[28:31], v[60:63], v[208:223]
    v_mfma_f32_32x32x16_bf16 v[160:175], a[32:35], v[64:67], v[160:175]
    s_add_u32 m0, s80, 4096
    s_add_u32 s34, s74, 802816
    buffer_load_dwordx4 v4, s[8:11], s34 offen offset:0 lds
    v_mfma_f32_32x32x16_bf16 v[192:207], a[32:35], v[68:71], v[192:207]
    buffer_load_dwordx4 v5, s[8:11], s34 offen offset:1024 lds
    v_mfma_f32_32x32x16_bf16 v[176:191], a[36:39], v[64:67], v[176:191]
    buffer_load_dwordx4 v6, s[8:11], s34 offen offset:2048 lds
    v_mfma_f32_32x32x16_bf16 v[208:223], a[36:39], v[68:71], v[208:223]
    s_waitcnt vmcnt(23)
    s_waitcnt lgkmcnt(0)
    ds_read_b64_tr_b16 a[64:65], v26 offset:16384
    ds_read_b64_tr_b16 a[66:67], v26 offset:17408
    ds_read_b64_tr_b16 a[68:69], v27 offset:16384
    ds_read_b64_tr_b16 a[70:71], v27 offset:17408
    ds_read_b64_tr_b16 a[72:73], v26 offset:18432
    ds_read_b64_tr_b16 a[74:75], v26 offset:19456
    ds_read_b64_tr_b16 a[76:77], v27 offset:18432
    ds_read_b64_tr_b16 a[78:79], v27 offset:19456
    ds_read_b64_tr_b16 a[80:81], v26 offset:20480
    ds_read_b64_tr_b16 a[82:83], v26 offset:21504
    ds_read_b64_tr_b16 a[84:85], v27 offset:20480
    ds_read_b64_tr_b16 a[86:87], v27 offset:21504
    s_waitcnt lgkmcnt(8)
    ds_read_b64_tr_b16 a[88:89], v26 offset:22528
    ds_read_b64_tr_b16 a[90:91], v26 offset:23552
    ds_read_b64_tr_b16 a[92:93], v27 offset:22528
    ds_read_b64_tr_b16 a[94:95], v27 offset:23552
    v_mfma_f32_32x32x16_bf16 v[160:175], a[40:43], v[72:75], v[160:175]
    buffer_load_dwordx4 v7, s[8:11], s34 offen offset:3072 lds
    v_mfma_f32_32x32x16_bf16 v[192:207], a[40:43], v[76:79], v[192:207]
    s_add_u32 s35, s77, 16384
    s_add_u32 s36, s35, s78
    buffer_load_dwordx4 v[32:35], v2, s[16:19], s35 offen offset:0 sc1
    v_mfma_f32_32x32x16_bf16 v[176:191], a[44:47], v[72:75], v[176:191]
    buffer_load_dwordx4 v[36:39], v2, s[16:19], s36 offen offset:0 sc1
    v_mfma_f32_32x32x16_bf16 v[208:223], a[44:47], v[76:79], v[208:223]
    v_mfma_f32_32x32x16_bf16 v[160:175], a[48:51], v[80:83], v[160:175]
    buffer_load_dwordx4 v[40:43], v2, s[16:19], s35 offen offset:1024 sc1
    v_mfma_f32_32x32x16_bf16 v[192:207], a[48:51], v[84:87], v[192:207]
    buffer_load_dwordx4 v[44:47], v2, s[16:19], s36 offen offset:1024 sc1
    v_mfma_f32_32x32x16_bf16 v[176:191], a[52:55], v[80:83], v[176:191]
    buffer_load_dwordx4 v[48:51], v2, s[16:19], s35 offen offset:2048 sc1
    v_mfma_f32_32x32x16_bf16 v[208:223], a[52:55], v[84:87], v[208:223]
    s_waitcnt vmcnt(21)
    v_max3_u32 v17, v96, v100, v104
    v_max3_u32 v18, v108, v112, v116
    v_max3_u32 v17, v17, v120, v124
    v_max_u32 v17, v17, v18
    v_cmp_eq_u32 vcc, -1, v17
    s_cbranch_vccnz L_kd_retry2
L_kd_ok2:
    v_mfma_f32_32x32x16_bf16 v[160:175], a[56:59], v[88:91], v[160:175]
    buffer_load_dwordx4 v[52:55], v2, s[16:19], s36 offen offset:2048 sc1
    v_mfma_f32_32x32x16_bf16 v[192:207], a[56:59], v[92:95], v[192:207]
    buffer_load_dwordx4 v[56:59], v2, s[16:19], s35 offen offset:3072 sc1
    v_mfma_f32_32x32x16_bf16 v[176:191], a[60:63], v[88:91], v[176:191]
    buffer_load_dwordx4 v[60:63], v2, s[16:19], s36 offen offset:3072 sc1
    v_mfma_f32_32x32x16_bf16 v[208:223], a[60:63], v[92:95], v[208:223]
    s_waitcnt lgkmcnt(0)
    v_mfma_f32_32x32x16_bf16 v[160:175], a[64:67], v[96:99], v[160:175]
    s_add_u32 s35, s77, 20480
    s_add_u32 s36, s35, s78
    buffer_load_dwordx4 v[64:67], v2, s[16:19], s35 offen offset:0 sc1
    v_mfma_f32_32x32x16_bf16 v[192:207], a[64:67], v[100:103], v[192:207]
    v_mfma_f32_32x32x16_bf16 v[176:191], a[68:71], v[96:99], v[176:191]
    buffer_load_dwordx4 v[68:71], v2, s[16:19], s36 offen offset:0 sc1
    v_mfma_f32_32x32x16_bf16 v[208:223], a[68:71], v[100:103], v[208:223]
    v_mfma_f32_32x32x16_bf16 v[160:175], a[72:75], v[104:107], v[160:175]
    buffer_load_dwordx4 v[72:75], v2, s[16:19], s35 offen offset:1024 sc1
    v_mfma_f32_32x32x16_bf16 v[192:207], a[72:75], v[108:111], v[192:207]
    v_mfma_f32_32x32x16_bf16 v[176:191], a[76:79], v[104:107], v[176:191]
    buffer_load_dwordx4 v[76:79], v2, s[16:19], s36 offen offset:1024 sc1
    v_mfma_f32_32x32x16_bf16 v[208:223], a[76:79], v[108:111], v[208:223]
    v_mfma_f32_32x32x16_bf16 v[160:175], a[80:83], v[112:115], v[160:175]
    buffer_load_dwordx4 v[80:83], v2, s[16:19], s35 offen offset:2048 sc1
    v_mfma_f32_32x32x16_bf16 v[192:207], a[80:83], v[116:119], v[192:207]
    v_mfma_f32_32x32x16_bf16 v[176:191], a[84:87], v[112:115], v[176:191]
    buffer_load_dwordx4 v[84:87], v2, s[16:19], s36 offen offset:2048 sc1
    v_mfma_f32_32x32x16_bf16 v[208:223], a[84:87], v[116:119], v[208:223]
    s_waitcnt vmcnt(22)
    v_max3_u32 v17, v128, v132, v136
    v_max3_u32 v18, v140, v144, v148
    v_max3_u32 v17, v17, v152, v156
    v_max_u32 v17, v17, v18
    v_cmp_eq_u32 vcc, -1, v17
    s_cbranch_vccnz L_kd_retry3
L_kd_ok3:
    s_waitcnt vmcnt(14)
    s_waitcnt lgkmcnt(0)
    ds_read_b64_tr_b16 a[96:97], v26 offset:0
    ds_read_b64_tr_b16 a[98:99], v26 offset:1024
    ds_read_b64_tr_b16 a[100:101], v27 offset:0
    ds_read_b64_tr_b16 a[102:103], v27 offset:1024
    ds_read_b64_tr_b16 a[104:105], v26 offset:2048
    ds_read_b64_tr_b16 a[106:107], v26 offset:3072
    ds_read_b64_tr_b16 a[108:109], v27 offset:2048
    ds_read_b64_tr_b16 a[110:111], v27 offset:3072
    ds_read_b64_tr_b16 a[112:113], v26 offset:4096
    ds_read_b64_tr_b16 a[114:115], v26 offset:5120
    ds_read_b64_tr_b16 a[116:117], v27 offset:4096
    ds_read_b64_tr_b16 a[118:119], v27 offset:5120
    s_waitcnt lgkmcnt(8)
    ds_read_b64_tr_b16 a[120:121], v26 offset:6144
    ds_read_b64_tr_b16 a[122:123], v26 offset:7168
    ds_read_b64_tr_b16 a[124:125], v27 offset:6144
    ds_read_b64_tr_b16 a[126:127], v27 offset:7168
    v_mfma_f32_32x32x16_bf16 v[160:175], a[88:91], v[120:123], v[160:175]
    buffer_load_dwordx4 v[88:91], v2, s[16:19], s35 offen offset:3072 sc1
    v_mfma_f32_32x32x16_bf16 v[192:207], a[88:91], v[124:127], v[192:207]
    v_mfma_f32_32x32x16_bf16 v[176:191], a[92:95], v[120:123], v[176:191]
    buffer_load_dwordx4 v[92:95], v2, s[16:19], s36 offen offset:3072 sc1
    v_mfma_f32_32x32x16_bf16 v[208:223], a[92:95], v[124:127], v[208:223]
    s_waitcnt lgkmcnt(0)
    v_mfma_f32_32x32x16_bf16 v[160:175], a[96:99], v[128:131], v[160:175]
    s_add_u32 s35, s77, 24576
    s_add_u32 s36, s35, s78
    buffer_load_dwordx4 v[96:99], v2, s[16:19], s35 offen offset:0 sc1
    v_mfma_f32_32x32x16_bf16 v[192:207], a[96:99], v[132:135], v[192:207]
    v_mfma_f32_32x32x16_bf16 v[176:191], a[100:103], v[128:131], v[176:191]
    buffer_load_dwordx4 v[100:103], v2, s[16:19], s36 offen offset:0 sc1
    v_mfma_f32_32x32x16_bf16 v[208:223], a[100:103], v[132:135], v[208:223]
    s_lshl_b32 s69, s25, 6
    v_xor_b32 v26, s69, v24
    v_xor_b32 v27, s69, v25
    v_add_u32 v26, s80, v26
    v_add_u32 v27, s80, v27
    v_mfma_f32_32x32x16_bf16 v[160:175], a[104:107], v[136:139], v[160:175]
    buffer_load_dwordx4 v[104:107], v2, s[16:19], s35 offen offset:1024 sc1
    v_mfma_f32_32x32x16_bf16 v[192:207], a[104:107], v[140:143], v[192:207]
    v_mfma_f32_32x32x16_bf16 v[176:191], a[108:111], v[136:139], v[176:191]
    buffer_load_dwordx4 v[108:111], v2, s[16:19], s36 offen offset:1024 sc1
    v_mfma_f32_32x32x16_bf16 v[208:223], a[108:111], v[140:143], v[208:223]
    v_mfma_f32_32x32x16_bf16 v[160:175], a[112:115], v[144:147], v[160:175]
    buffer_load_dwordx4 v[112:115], v2, s[16:19], s35 offen offset:2048 sc1
    v_mfma_f32_32x32x16_bf16 v[192:207], a[112:115], v[148:151], v[192:207]
    v_mfma_f32_32x32x16_bf16 v[176:191], a[116:119], v[144:147], v[176:191]
    buffer_load_dwordx4 v[116:119], v2, s[16:19], s36 offen offset:2048 sc1
    v_mfma_f32_32x32x16_bf16 v[208:223], a[116:119], v[148:151], v[208:223]
    s_waitcnt vmcnt(14)
    v_max3_u32 v17, v32, v36, v40
    v_max3_u32 v18, v44, v48, v52
    v_max3_u32 v17, v17, v56, v60
    v_max_u32 v17, v17, v18
    v_cmp_eq_u32 vcc, -1, v17
    s_cbranch_vccnz L_kd_retry4
L_kd_ok4:
    v_mfma_f32_32x32x16_bf16 v[160:175], a[120:123], v[152:155], v[160:175]
    buffer_load_dwordx4 v[120:123], v2, s[16:19], s35 offen offset:3072 sc1
    v_mfma_f32_32x32x16_bf16 v[192:207], a[120:123], v[156:159], v[192:207]
    v_mfma_f32_32x32x16_bf16 v[176:191], a[124:127], v[152:155], v[176:191]
    buffer_load_dwordx4 v[124:127], v2, s[16:19], s36 offen offset:3072 sc1
    v_mfma_f32_32x32x16_bf16 v[208:223], a[124:127], v[156:159], v[208:223]
    v_mfma_f32_32x32x16_bf16 v[160:175], a[128:131], v[32:35], v[160:175]
    s_add_u32 s35, s77, 28672
    s_add_u32 s36, s35, s78
    buffer_load_dwordx4 v[128:131], v2, s[16:19], s35 offen offset:0 sc1
    v_mfma_f32_32x32x16_bf16 v[192:207], a[128:131], v[36:39], v[192:207]
    v_mfma_f32_32x32x16_bf16 v[176:191], a[132:135], v[32:35], v[176:191]
    buffer_load_dwordx4 v[132:135], v2, s[16:19], s36 offen offset:0 sc1
    v_mfma_f32_32x32x16_bf16 v[208:223], a[132:135], v[36:39], v[208:223]
    v_mfma_f32_32x32x16_bf16 v[160:175], a[136:139], v[40:43], v[160:175]
    buffer_load_dwordx4 v[136:139], v2, s[16:19], s35 offen offset:1024 sc1
    v_mfma_f32_32x32x16_bf16 v[192:207], a[136:139], v[44:47], v[192:207]
    v_mfma_f32_32x32x16_bf16 v[176:191], a[140:143], v[40:43], v[176:191]
    buffer_load_dwordx4 v[140:143], v2, s[16:19], s36 offen offset:1024 sc1
    v_mfma_f32_32x32x16_bf16 v[208:223], a[140:143], v[44:47], v[208:223]
    v_mfma_f32_32x32x16_bf16 v[160:175], a[144:147], v[48:51], v[160:175]
    buffer_load_dwordx4 v[144:147], v2, s[16:19], s35 offen offset:2048 sc1
    v_mfma_f32_32x32x16_bf16 v[192:207], a[144:147], v[52:55], v[192:207]
    v_mfma_f32_32x32x16_bf16 v[176:191], a[148:151], v[48:51], v[176:191]
    buffer_load_dwordx4 v[148:151], v2, s[16:19], s36 offen offset:2048 sc1
    v_mfma_f32_32x32x16_bf16 v[208:223], a[148:151], v[52:55], v[208:223]
    s_waitcnt vmcnt(14)
    v_max3_u32 v17, v64, v68, v72
    v_max3_u32 v18, v76, v80, v84
    v_max3_u32 v17, v17, v88, v92
    v_max_u32 v17, v17, v18
    v_cmp_eq_u32 vcc, -1, v17
    s_cbranch_vccnz L_kd_retry5
L_kd_ok5:
    v_mfma_f32_32x32x16_bf16 v[160:175], a[152:155], v[56:59], v[160:175]
    buffer_load_dwordx4 v[152:155], v2, s[16:19], s35 offen offset:3072 sc1
    v_mfma_f32_32x32x16_bf16 v[192:207], a[152:155], v[60:63], v[192:207]
    v_mfma_f32_32x32x16_bf16 v[176:191], a[156:159], v[56:59], v[176:191]
    buffer_load_dwordx4 v[156:159], v2, s[16:19], s36 offen offset:3072 sc1
    v_mfma_f32_32x32x16_bf16 v[208:223], a[156:159], v[60:63], v[208:223]
    v_mfma_f32_32x32x16_bf16 v[160:175], a[160:163], v[64:67], v[160:175]
    s_add_u32 m0, s80, 8192
    s_add_u32 s34, s75, 0
    buffer_load_dwordx4 v20, s[12:15], s34 offen offset:0 lds
    v_mfma_f32_32x32x16_bf16 v[192:207], a[160:163], v[68:71], v[192:207]
    v_mfma_f32_32x32x16_bf16 v[176:191], a[164:167], v[64:67], v[176:191]
    buffer_load_dwordx4 v21, s[12:15], s34 offen offset:1024 lds
    v_mfma_f32_32x32x16_bf16 v[208:223], a[164:167], v[68:71], v[208:223]
    v_mfma_f32_32x32x16_bf16 v[160:175], a[168:171], v[72:75], v[160:175]
    buffer_load_dwordx4 v22, s[12:15], s34 offen offset:2048 lds
    v_mfma_f32_32x32x16_bf16 v[192:207], a[168:171], v[76:79], v[192:207]
    v_mfma_f32_32x32x16_bf16 v[176:191], a[172:175], v[72:75], v[176:191]
    buffer_load_dwordx4 v23, s[12:15], s34 offen offset:3072 lds
    v_mfma_f32_32x32x16_bf16 v[208:223], a[172:175], v[76:79], v[208:223]
    v_mfma_f32_32x32x16_bf16 v[160:175], a[176:179], v[80:83], v[160:175]
    s_add_u32 m0, s80, 12288
    s_add_u32 s34, s75, 131072
    buffer_load_dwordx4 v20, s[12:15], s34 offen offset:0 lds
    v_mfma_f32_32x32x16_bf16 v[192:207], a[176:179], v[84:87], v[192:207]
    v_mfma_f32_32x32x16_bf16 v[176:191], a[180:183], v[80:83], v[176:191]
    buffer_load_dwordx4 v21, s[12:15], s34 offen offset:1024 lds
    v_mfma_f32_32x32x16_bf16 v[208:223], a[180:183], v[84:87], v[208:223]
    s_waitcnt vmcnt(14)
    v_max3_u32 v17, v96, v100, v104
    v_max3_u32 v18, v108, v112, v116
    v_max3_u32 v17, v17, v120, v124
    v_max_u32 v17, v17, v18
    v_cmp_eq_u32 vcc, -1, v17
    s_cbranch_vccnz L_kd_retry6
L_kd_ok6:
    v_mfma_f32_32x32x16_bf16 v[160:175], a[184:187], v[88:91], v[160:175]
    buffer_load_dwordx4 v22, s[12:15], s34 offen offset:2048 lds
    v_mfma_f32_32x32x16_bf16 v[192:207], a[184:187], v[92:95], v[192:207]
    v_mfma_f32_32x32x16_bf16 v[176:191], a[188:191], v[88:91], v[176:191]
    buffer_load_dwordx4 v23, s[12:15], s34 offen offset:3072 lds
    v_mfma_f32_32x32x16_bf16 v[208:223], a[188:191], v[92:95], v[208:223]
    s_xor_b32 s34, s22, 1
    s_mul_i32 s34, s34, 12288
    s_add_u32 s34, s34, 98304
    v_add_u32 v13, s34, v2
    s_xor_b32 s34, s22, 2
    s_mul_i32 s34, s34, 12288
    s_add_u32 s34, s34, 102400
    v_add_u32 v14, s34, v2
    s_xor_b32 s34, s22, 3
    s_mul_i32 s34, s34, 12288
    s_add_u32 s34, s34, 106496
    v_add_u32 v15, s34, v2
    s_mul_i32 s34, s22, 12288
    s_add_u32 s34, s34, 98304
    v_add_u32 v9, s34, v2
    v_mfma_f32_32x32x16_bf16 v[176:191], a[196:199], v[96:99], v[176:191]
    s_add_u32 m0, s80, 16384
    s_add_u32 s34, s75, 262144
    buffer_load_dwordx4 v20, s[12:15], s34 offen offset:0 lds
    v_mfma_f32_32x32x16_bf16 v[176:191], a[204:207], v[104:107], v[176:191]
    v_mfma_f32_32x32x16_bf16 v[176:191], a[212:215], v[112:115], v[176:191]
    buffer_load_dwordx4 v21, s[12:15], s34 offen offset:1024 lds
    v_mfma_f32_32x32x16_bf16 v[176:191], a[220:223], v[120:123], v[176:191]
    s_waitcnt vmcnt(10)
    v_max3_u32 v17, v128, v132, v136
    v_max3_u32 v18, v140, v144, v148
    v_max3_u32 v17, v17, v152, v156
    v_max_u32 v17, v17, v18
    v_cmp_eq_u32 vcc, -1, v17
    s_cbranch_vccnz L_kd_retry7
L_kd_ok7:
    v_mfma_f32_32x32x16_bf16 v[176:191], a[228:231], v[128:131], v[176:191]
    buffer_load_dwordx4 v22, s[12:15], s34 offen offset:2048 lds
    v_mfma_f32_32x32x16_bf16 v[176:191], a[236:239], v[136:139], v[176:191]
    v_mfma_f32_32x32x16_bf16 v[176:191], a[244:247], v[144:147], v[176:191]
    buffer_load_dwordx4 v23, s[12:15], s34 offen offset:3072 lds
    v_mfma_f32_32x32x16_bf16 v[176:191], a[252:255], v[152:155], v[176:191]
    v_mfma_f32_32x32x16_bf16 v[192:207], a[192:195], v[100:103], v[192:207]
    s_add_u32 m0, s80, 20480
    s_add_u32 s34, s75, 393216
    buffer_load_dwordx4 v20, s[12:15], s34 offen offset:0 lds
    v_mfma_f32_32x32x16_bf16 v[192:207], a[200:203], v[108:111], v[192:207]
    v_mfma_f32_32x32x16_bf16 v[192:207], a[208:211], v[116:119], v[192:207]
    buffer_load_dwordx4 v21, s[12:15], s34 offen offset:1024 lds
    v_mfma_f32_32x32x16_bf16 v[192:207], a[216:219], v[124:127], v[192:207]
    v_mfma_f32_32x32x16_bf16 v[192:207], a[224:227], v[132:135], v[192:207]
    buffer_load_dwordx4 v22, s[12:15], s34 offen offset:2048 lds
    s_nop 1
    ds_write_b128 v13, v[176:179] offset:0
    v_mfma_f32_32x32x16_bf16 v[192:207], a[232:235], v[140:143], v[192:207]
    ds_write_b128 v13, v[180:183] offset:1024
    v_mfma_f32_32x32x16_bf16 v[192:207], a[240:243], v[148:151], v[192:207]
    buffer_load_dwordx4 v23, s[12:15], s34 offen offset:3072 lds
    ds_write_b128 v13, v[184:187] offset:2048
    v_mfma_f32_32x32x16_bf16 v[192:207], a[248:251], v[156:159], v[192:207]
    ds_write_b128 v13, v[188:191] offset:3072
    s_waitcnt vmcnt(8)
    v_mfma_f32_32x32x16_bf16 v[208:223], a[196:199], v[100:103], v[208:223]
    s_add_u32 m0, s80, 0
    s_add_u32 s34, s75, 524288
    buffer_load_dwordx4 v20, s[12:15], s34 offen offset:0 lds
    ds_read_b64_tr_b16 a[0:1], v26 offset:8192
    v_mfma_f32_32x32x16_bf16 v[208:223], a[204:207], v[108:111], v[208:223]
    ds_read_b64_tr_b16 a[2:3], v26 offset:9216
    v_mfma_f32_32x32x16_bf16 v[208:223], a[212:215], v[116:119], v[208:223]
    buffer_load_dwordx4 v21, s[12:15], s34 offen offset:1024 lds
    ds_read_b64_tr_b16 a[4:5], v27 offset:8192
    v_mfma_f32_32x32x16_bf16 v[208:223], a[220:223], v[124:127], v[208:223]
    ds_read_b64_tr_b16 a[6:7], v27 offset:9216
    v_mfma_f32_32x32x16_bf16 v[208:223], a[228:231], v[132:135], v[208:223]
    buffer_load_dwordx4 v22, s[12:15], s34 offen offset:2048 lds
    ds_write_b128 v14, v[192:195] offset:0
    ds_read_b64_tr_b16 a[8:9], v26 offset:10240
    v_mfma_f32_32x32x16_bf16 v[208:223], a[236:239], v[140:143], v[208:223]
    ds_write_b128 v14, v[196:199] offset:1024
    ds_read_b64_tr_b16 a[10:11], v26 offset:11264
    v_mfma_f32_32x32x16_bf16 v[208:223], a[244:247], v[148:151], v[208:223]
    buffer_load_dwordx4 v23, s[12:15], s34 offen offset:3072 lds
    ds_write_b128 v14, v[200:203] offset:2048
    ds_read_b64_tr_b16 a[12:13], v27 offset:10240
    v_mfma_f32_32x32x16_bf16 v[208:223], a[252:255], v[156:159], v[208:223]
    ds_write_b128 v14, v[204:207] offset:3072
    ds_read_b64_tr_b16 a[14:15], v27 offset:11264
    v_mfma_f32_32x32x16_bf16 v[160:175], a[192:195], v[96:99], v[160:175]
    s_add_u32 m0, s80, 4096
    s_add_u32 s34, s75, 655360
    buffer_load_dwordx4 v20, s[12:15], s34 offen offset:0 lds
    ds_read_b64_tr_b16 a[16:17], v26 offset:12288
    v_mfma_f32_32x32x16_bf16 v[160:175], a[200:203], v[104:107], v[160:175]
    ds_read_b64_tr_b16 a[18:19], v26 offset:13312
    v_mfma_f32_32x32x16_bf16 v[160:175], a[208:211], v[112:115], v[160:175]
    buffer_load_dwordx4 v21, s[12:15], s34 offen offset:1024 lds
    ds_read_b64_tr_b16 a[20:21], v27 offset:12288
    v_mfma_f32_32x32x16_bf16 v[160:175], a[216:219], v[120:123], v[160:175]
    ds_read_b64_tr_b16 a[22:23], v27 offset:13312
    v_mfma_f32_32x32x16_bf16 v[160:175], a[224:227], v[128:131], v[160:175]
    buffer_load_dwordx4 v22, s[12:15], s34 offen offset:2048 lds
    ds_write_b128 v15, v[208:211] offset:0
    ds_read_b64_tr_b16 a[24:25], v26 offset:14336
    v_mfma_f32_32x32x16_bf16 v[160:175], a[232:235], v[136:139], v[160:175]
    ds_write_b128 v15, v[212:215] offset:1024
    ds_read_b64_tr_b16 a[26:27], v26 offset:15360
    v_mfma_f32_32x32x16_bf16 v[160:175], a[240:243], v[144:147], v[160:175]
    buffer_load_dwordx4 v23, s[12:15], s34 offen offset:3072 lds
    ds_write_b128 v15, v[216:219] offset:2048
    ds_read_b64_tr_b16 a[28:29], v27 offset:14336
    v_mfma_f32_32x32x16_bf16 v[160:175], a[248:251], v[152:155], v[160:175]
    ds_write_b128 v15, v[220:223] offset:3072
    ds_read_b64_tr_b16 a[30:31], v27 offset:15360
    s_waitcnt vmcnt(8)
    s_waitcnt lgkmcnt(0)
    ds_read_b64_tr_b16 a[32:33], v26 offset:16384
    ds_read_b64_tr_b16 a[34:35], v26 offset:17408
    ds_read_b64_tr_b16 a[36:37], v27 offset:16384
    ds_read_b64_tr_b16 a[38:39], v27 offset:17408
    ds_read_b64_tr_b16 a[40:41], v26 offset:18432
    ds_read_b64_tr_b16 a[42:43], v26 offset:19456
    ds_read_b64_tr_b16 a[44:45], v27 offset:18432
    ds_read_b64_tr_b16 a[46:47], v27 offset:19456
    ds_read_b64_tr_b16 a[48:49], v26 offset:20480
    ds_read_b64_tr_b16 a[50:51], v26 offset:21504
    ds_read_b64_tr_b16 a[52:53], v27 offset:20480
    ds_read_b64_tr_b16 a[54:55], v27 offset:21504
    s_waitcnt lgkmcnt(8)
    ds_read_b64_tr_b16 a[56:57], v26 offset:22528
    ds_read_b64_tr_b16 a[58:59], v26 offset:23552
    ds_read_b64_tr_b16 a[60:61], v27 offset:22528
    ds_read_b64_tr_b16 a[62:63], v27 offset:23552
    s_waitcnt lgkmcnt(0)
    s_barrier
    ds_read_b128 v[32:35], v9 offset:0
    ds_read_b128 v[36:39], v9 offset:1024
    ds_read_b128 v[40:43], v9 offset:2048
    ds_read_b128 v[44:47], v9 offset:3072
    ds_read_b128 v[48:51], v9 offset:4096
    ds_read_b128 v[52:55], v9 offset:5120
    ds_read_b128 v[56:59], v9 offset:6144
    ds_read_b128 v[60:63], v9 offset:7168
    ds_read_b128 v[64:67], v9 offset:8192
    ds_read_b128 v[68:71], v9 offset:9216
    ds_read_b128 v[72:75], v9 offset:10240
    ds_read_b128 v[76:79], v9 offset:11264
    s_add_u32 m0, s80, 8192
    s_add_u32 s34, s75, 786432
    buffer_load_dwordx4 v20, s[12:15], s34 offen offset:0 lds
    buffer_load_dwordx4 v21, s[12:15], s34 offen offset:1024 lds
    buffer_load_dwordx4 v22, s[12:15], s34 offen offset:2048 lds
    buffer_load_dwordx4 v23, s[12:15], s34 offen offset:3072 lds
    s_add_u32 m0, s80, 12288
    s_add_u32 s34, s75, 917504
    buffer_load_dwordx4 v20, s[12:15], s34 offen offset:0 lds
    buffer_load_dwordx4 v21, s[12:15], s34 offen offset:1024 lds
    buffer_load_dwordx4 v22, s[12:15], s34 offen offset:2048 lds
    buffer_load_dwordx4 v23, s[12:15], s34 offen offset:3072 lds
    s_waitcnt lgkmcnt(8)
    v_add_f32 v160, v160, v32
    v_add_f32 v161, v161, v33
    v_add_f32 v162, v162, v34
    v_add_f32 v163, v163, v35
    v_add_f32 v164, v164, v36
    v_add_f32 v165, v165, v37
    v_add_f32 v166, v166, v38
    v_add_f32 v167, v167, v39
    v_add_f32 v168, v168, v40
    v_add_f32 v169, v169, v41
    v_add_f32 v170, v170, v42
    v_add_f32 v171, v171, v43
    v_add_f32 v172, v172, v44
    v_add_f32 v173, v173, v45
    v_add_f32 v174, v174, v46
    v_add_f32 v175, v175, v47
    s_waitcnt lgkmcnt(0)
    v_add_f32 v48, v48, v64
    v_add_f32 v49, v49, v65
    v_add_f32 v50, v50, v66
    v_add_f32 v51, v51, v67
    s_add_u32 m0, s80, 16384
    s_add_u32 s34, s75, 1048576
    buffer_load_dwordx4 v20, s[12:15], s34 offen offset:0 lds
    v_add_f32 v52, v52, v68
    v_add_f32 v53, v53, v69
    v_add_f32 v54, v54, v70
    v_add_f32 v55, v55, v71
    buffer_load_dwordx4 v21, s[12:15], s34 offen offset:1024 lds
    v_add_f32 v56, v56, v72
    v_add_f32 v57, v57, v73
    v_add_f32 v58, v58, v74
    v_add_f32 v59, v59, v75
    buffer_load_dwordx4 v22, s[12:15], s34 offen offset:2048 lds
    v_add_f32 v60, v60, v76
    v_add_f32 v61, v61, v77
    v_add_f32 v62, v62, v78
    v_add_f32 v63, v63, v79
    buffer_load_dwordx4 v23, s[12:15], s34 offen offset:3072 lds
    v_add_f32 v160, v160, v48
    v_add_f32 v161, v161, v49
    v_add_f32 v162, v162, v50
    v_add_f32 v163, v163, v51
    s_add_u32 m0, s80, 20480
    s_add_u32 s34, s75, 1179648
    buffer_load_dwordx4 v20, s[12:15], s34 offen offset:0 lds
    v_add_f32 v164, v164, v52
    v_add_f32 v165, v165, v53
    v_add_f32 v166, v166, v54
    v_add_f32 v167, v167, v55
    buffer_load_dwordx4 v21, s[12:15], s34 offen offset:1024 lds
    v_add_f32 v168, v168, v56
    v_add_f32 v169, v169, v57
    v_add_f32 v170, v170, v58
    v_add_f32 v171, v171, v59
    buffer_load_dwordx4 v22, s[12:15], s34 offen offset:2048 lds
    v_add_f32 v172, v172, v60
    v_add_f32 v173, v173, v61
    v_add_f32 v174, v174, v62
    v_add_f32 v175, v175, v63
    buffer_load_dwordx4 v23, s[12:15], s34 offen offset:3072 lds
    s_mov_b32 s36, 0xbdd2d3e8
    s_mov_b32 s37, 0xc0135761
    v_mov_b32 v16, s37
    v_mov_b32 v17, s37
    v_mov_b32 v18, s36
    v_mov_b32 v19, s36
    v_mov_b32 v28, 1.0
    v_mov_b32 v29, 1.0
    v_pk_mul_f32 v[184:185], v[160:161], v[160:161]
    v_pk_mul_f32 v[186:187], v[162:163], v[162:163]
    v_pk_mul_f32 v[188:189], v[164:165], v[164:165]
    v_pk_mul_f32 v[190:191], v[166:167], v[166:167]
    v_pk_mul_f32 v[192:193], v[168:169], v[168:169]
    v_pk_mul_f32 v[194:195], v[170:171], v[170:171]
    v_pk_mul_f32 v[196:197], v[172:173], v[172:173]
    v_pk_mul_f32 v[198:199], v[174:175], v[174:175]
    v_pk_fma_f32 v[184:185], v[184:185], v[18:19], v[16:17]
    v_pk_fma_f32 v[186:187], v[186:187], v[18:19], v[16:17]
    v_pk_fma_f32 v[188:189], v[188:189], v[18:19], v[16:17]
    v_pk_fma_f32 v[190:191], v[190:191], v[18:19], v[16:17]
    v_pk_fma_f32 v[192:193], v[192:193], v[18:19], v[16:17]
    v_pk_fma_f32 v[194:195], v[194:195], v[18:19], v[16:17]
    v_pk_fma_f32 v[196:197], v[196:197], v[18:19], v[16:17]
    v_pk_fma_f32 v[198:199], v[198:199], v[18:19], v[16:17]
    v_pk_mul_f32 v[184:185], v[184:185], v[160:161]
    v_pk_mul_f32 v[186:187], v[186:187], v[162:163]
    v_pk_mul_f32 v[188:189], v[188:189], v[164:165]
    v_pk_mul_f32 v[190:191], v[190:191], v[166:167]
    v_pk_mul_f32 v[192:193], v[192:193], v[168:169]
    v_pk_mul_f32 v[194:195], v[194:195], v[170:171]
    v_pk_mul_f32 v[196:197], v[196:197], v[172:173]
    v_pk_mul_f32 v[198:199], v[198:199], v[174:175]
    v_exp_f32 v184, v184
    v_exp_f32 v185, v185
    v_exp_f32 v186, v186
    v_exp_f32 v187, v187
    v_exp_f32 v188, v188
    v_exp_f32 v189, v189
    v_exp_f32 v190, v190
    v_exp_f32 v191, v191
    v_exp_f32 v192, v192
    v_exp_f32 v193, v193
    v_exp_f32 v194, v194
    v_exp_f32 v195, v195
    v_exp_f32 v196, v196
    v_exp_f32 v197, v197
    v_exp_f32 v198, v198
    v_exp_f32 v199, v199
    v_pk_add_f32 v[184:185], v[184:185], v[28:29]
    v_pk_add_f32 v[186:187], v[186:187], v[28:29]
    v_pk_add_f32 v[188:189], v[188:189], v[28:29]
    v_pk_add_f32 v[190:191], v[190:191], v[28:29]
    v_pk_add_f32 v[192:193], v[192:193], v[28:29]
    v_pk_add_f32 v[194:195], v[194:195], v[28:29]
    v_pk_add_f32 v[196:197], v[196:197], v[28:29]
    v_pk_add_f32 v[198:199], v[198:199], v[28:29]
    v_rcp_f32 v184, v184
    v_rcp_f32 v185, v185
    v_rcp_f32 v186, v186
    v_rcp_f32 v187, v187
    v_rcp_f32 v188, v188
    v_rcp_f32 v189, v189
    v_rcp_f32 v190, v190
    v_rcp_f32 v191, v191
    v_rcp_f32 v192, v192
    v_rcp_f32 v193, v193
    v_rcp_f32 v194, v194
    v_rcp_f32 v195, v195
    v_rcp_f32 v196, v196
    v_rcp_f32 v197, v197
    v_rcp_f32 v198, v198
    v_rcp_f32 v199, v199
    v_pk_mul_f32 v[160:161], v[160:161], v[184:185]
    v_pk_mul_f32 v[162:163], v[162:163], v[186:187]
    v_pk_mul_f32 v[164:165], v[164:165], v[188:189]
    v_pk_mul_f32 v[166:167], v[166:167], v[190:191]
    v_pk_mul_f32 v[168:169], v[168:169], v[192:193]
    v_pk_mul_f32 v[170:171], v[170:171], v[194:195]
    v_pk_mul_f32 v[172:173], v[172:173], v[196:197]
    v_pk_mul_f32 v[174:175], v[174:175], v[198:199]
    v_cvt_pk_bf16_f32 v48, v160, v161
    v_cvt_pk_bf16_f32 v49, v162, v163
    v_cvt_pk_bf16_f32 v50, v164, v165
    v_cvt_pk_bf16_f32 v51, v166, v167
    v_cvt_pk_bf16_f32 v52, v168, v169
    v_cvt_pk_bf16_f32 v53, v170, v171
    v_cvt_pk_bf16_f32 v54, v172, v173
    v_cvt_pk_bf16_f32 v55, v174, v175
    s_lshl_b32 s31, s70, 1
    s_lshr_b32 s36, s22, 1
    s_add_u32 s31, s31, s36
    s_mul_i32 s35, s31, 112
    s_lshl_b32 s36, s71, 2
    s_add_u32 s35, s35, s36
    s_and_b32 s36, s22, 1
    s_lshl_b32 s36, s36, 1
    s_add_u32 s35, s35, s36
    s_lshl_b32 s35, s35, 10
    s_add_u32 s35, s35, 14680064
    v_min_u32 v48, 0xfffffffe, v48
    v_min_u32 v52, 0xfffffffe, v52
    buffer_store_dwordx4 v[48:51], v2, s[16:19], s35 offen sc1
    buffer_store_dwordx4 v[52:55], v2, s[16:19], s35 offen offset:1024 sc1
    s_barrier
    s_waitcnt vmcnt(18)
    s_waitcnt lgkmcnt(0)
    ds_read_b64_tr_b16 a[64:65], v26 offset:0
    ds_read_b64_tr_b16 a[66:67], v26 offset:1024
    ds_read_b64_tr_b16 a[68:69], v27 offset:0
    ds_read_b64_tr_b16 a[70:71], v27 offset:1024
    ds_read_b64_tr_b16 a[72:73], v26 offset:2048
    ds_read_b64_tr_b16 a[74:75], v26 offset:3072
    ds_read_b64_tr_b16 a[76:77], v27 offset:2048
    ds_read_b64_tr_b16 a[78:79], v27 offset:3072
    ds_read_b64_tr_b16 a[80:81], v26 offset:4096
    ds_read_b64_tr_b16 a[82:83], v26 offset:5120
    ds_read_b64_tr_b16 a[84:85], v27 offset:4096
    ds_read_b64_tr_b16 a[86:87], v27 offset:5120
    s_waitcnt lgkmcnt(8)
    ds_read_b64_tr_b16 a[88:89], v26 offset:6144
    ds_read_b64_tr_b16 a[90:91], v26 offset:7168
    ds_read_b64_tr_b16 a[92:93], v27 offset:6144
    ds_read_b64_tr_b16 a[94:95], v27 offset:7168
    s_waitcnt lgkmcnt(0)
    s_add_u32 m0, s80, 0
    s_add_u32 s34, s75, 1310720
    buffer_load_dwordx4 v20, s[12:15], s34 offen offset:0 lds
    buffer_load_dwordx4 v21, s[12:15], s34 offen offset:1024 lds
    buffer_load_dwordx4 v22, s[12:15], s34 offen offset:2048 lds
    buffer_load_dwordx4 v23, s[12:15], s34 offen offset:3072 lds
    s_add_u32 m0, s80, 4096
    s_add_u32 s34, s75, 1441792
    buffer_load_dwordx4 v20, s[12:15], s34 offen offset:0 lds
    buffer_load_dwordx4 v21, s[12:15], s34 offen offset:1024 lds
    buffer_load_dwordx4 v22, s[12:15], s34 offen offset:2048 lds
    buffer_load_dwordx4 v23, s[12:15], s34 offen offset:3072 lds
    s_branch L_kd_join
L_kd_skip:
    s_lshl_b32 s69, s25, 6
    v_xor_b32 v26, s69, v24
    v_xor_b32 v27, s69, v25
    v_add_u32 v26, s80, v26
    v_add_u32 v27, s80, v27
    s_add_u32 m0, s80, 8192
    s_add_u32 s34, s75, 0
    buffer_load_dwordx4 v20, s[12:15], s34 offen offset:0 lds
    buffer_load_dwordx4 v21, s[12:15], s34 offen offset:1024 lds
    buffer_load_dwordx4 v22, s[12:15], s34 offen offset:2048 lds
    buffer_load_dwordx4 v23, s[12:15], s34 offen offset:3072 lds
    s_add_u32 m0, s80, 12288
    s_add_u32 s34, s75, 131072
    buffer_load_dwordx4 v20, s[12:15], s34 offen offset:0 lds
    buffer_load_dwordx4 v21, s[12:15], s34 offen offset:1024 lds
    buffer_load_dwordx4 v22, s[12:15], s34 offen offset:2048 lds
    buffer_load_dwordx4 v23, s[12:15], s34 offen offset:3072 lds
    s_add_u32 m0, s80, 16384
    s_add_u32 s34, s75, 262144
    buffer_load_dwordx4 v20, s[12:15], s34 offen offset:0 lds
    buffer_load_dwordx4 v21, s[12:15], s34 offen offset:1024 lds
    buffer_load_dwordx4 v22, s[12:15], s34 offen offset:2048 lds
    buffer_load_dwordx4 v23, s[12:15], s34 offen offset:3072 lds
    s_add_u32 m0, s80, 20480
    s_add_u32 s34, s75, 393216
    buffer_load_dwordx4 v20, s[12:15], s34 offen offset:0 lds
    buffer_load_dwordx4 v21, s[12:15], s34 offen offset:1024 lds
    buffer_load_dwordx4 v22, s[12:15], s34 offen offset:2048 lds
    buffer_load_dwordx4 v23, s[12:15], s34 offen offset:3072 lds
    s_add_u32 m0, s80, 0
    s_add_u32 s34, s75, 524288
    buffer_load_dwordx4 v20, s[12:15], s34 offen offset:0 lds
    buffer_load_dwordx4 v21, s[12:15], s34 offen offset:1024 lds
    buffer_load_dwordx4 v22, s[12:15], s34 offen offset:2048 lds
    buffer_load_dwordx4 v23, s[12:15], s34 offen offset:3072 lds
    s_add_u32 m0, s80, 4096
    s_add_u32 s34, s75, 655360
    buffer_load_dwordx4 v20, s[12:15], s34 offen offset:0 lds
    buffer_load_dwordx4 v21, s[12:15], s34 offen offset:1024 lds
    buffer_load_dwordx4 v22, s[12:15], s34 offen offset:2048 lds
    buffer_load_dwordx4 v23, s[12:15], s34 offen offset:3072 lds
    s_waitcnt vmcnt(16)
    s_waitcnt lgkmcnt(0)
    ds_read_b64_tr_b16 a[0:1], v26 offset:8192
    ds_read_b64_tr_b16 a[2:3], v26 offset:9216
    ds_read_b64_tr_b16 a[4:5], v27 offset:8192
    ds_read_b64_tr_b16 a[6:7], v27 offset:9216
    ds_read_b64_tr_b16 a[8:9], v26 offset:10240
    ds_read_b64_tr_b16 a[10:11], v26 offset:11264
    ds_read_b64_tr_b16 a[12:13], v27 offset:10240
    ds_read_b64_tr_b16 a[14:15], v27 offset:11264
    ds_read_b64_tr_b16 a[16:17], v26 offset:12288
    ds_read_b64_tr_b16 a[18:19], v26 offset:13312
    ds_read_b64_tr_b16 a[20:21], v27 offset:12288
    ds_read_b64_tr_b16 a[22:23], v27 offset:13312
    s_waitcnt lgkmcnt(8)
    ds_read_b64_tr_b16 a[24:25], v26 offset:14336
    ds_read_b64_tr_b16 a[26:27], v26 offset:15360
    ds_read_b64_tr_b16 a[28:29], v27 offset:14336
    ds_read_b64_tr_b16 a[30:31], v27 offset:15360
    s_waitcnt vmcnt(8)
    s_waitcnt lgkmcnt(0)
    ds_read_b64_tr_b16 a[32:33], v26 offset:16384
    ds_read_b64_tr_b16 a[34:35], v26 offset:17408
    ds_read_b64_tr_b16 a[36:37], v27 offset:16384
    ds_read_b64_tr_b16 a[38:39], v27 offset:17408
    ds_read_b64_tr_b16 a[40:41], v26 offset:18432
    ds_read_b64_tr_b16 a[42:43], v26 offset:19456
    ds_read_b64_tr_b16 a[44:45], v27 offset:18432
    ds_read_b64_tr_b16 a[46:47], v27 offset:19456
    ds_read_b64_tr_b16 a[48:49], v26 offset:20480
    ds_read_b64_tr_b16 a[50:51], v26 offset:21504
    ds_read_b64_tr_b16 a[52:53], v27 offset:20480
    ds_read_b64_tr_b16 a[54:55], v27 offset:21504
    s_waitcnt lgkmcnt(8)
    ds_read_b64_tr_b16 a[56:57], v26 offset:22528
    ds_read_b64_tr_b16 a[58:59], v26 offset:23552
    ds_read_b64_tr_b16 a[60:61], v27 offset:22528
    ds_read_b64_tr_b16 a[62:63], v27 offset:23552
    s_waitcnt vmcnt(0)
    s_waitcnt lgkmcnt(0)
    ds_read_b64_tr_b16 a[64:65], v26 offset:0
    ds_read_b64_tr_b16 a[66:67], v26 offset:1024
    ds_read_b64_tr_b16 a[68:69], v27 offset:0
    ds_read_b64_tr_b16 a[70:71], v27 offset:1024
    ds_read_b64_tr_b16 a[72:73], v26 offset:2048
    ds_read_b64_tr_b16 a[74:75], v26 offset:3072
    ds_read_b64_tr_b16 a[76:77], v27 offset:2048
    ds_read_b64_tr_b16 a[78:79], v27 offset:3072
    ds_read_b64_tr_b16 a[80:81], v26 offset:4096
    ds_read_b64_tr_b16 a[82:83], v26 offset:5120
    ds_read_b64_tr_b16 a[84:85], v27 offset:4096
    ds_read_b64_tr_b16 a[86:87], v27 offset:5120
    s_waitcnt lgkmcnt(8)
    ds_read_b64_tr_b16 a[88:89], v26 offset:6144
    ds_read_b64_tr_b16 a[90:91], v26 offset:7168
    ds_read_b64_tr_b16 a[92:93], v27 offset:6144
    ds_read_b64_tr_b16 a[94:95], v27 offset:7168
    s_waitcnt lgkmcnt(0)
    s_add_u32 m0, s80, 8192
    s_add_u32 s34, s75, 786432
    buffer_load_dwordx4 v20, s[12:15], s34 offen offset:0 lds
    buffer_load_dwordx4 v21, s[12:15], s34 offen offset:1024 lds
    buffer_load_dwordx4 v22, s[12:15], s34 offen offset:2048 lds
    buffer_load_dwordx4 v23, s[12:15], s34 offen offset:3072 lds
    s_add_u32 m0, s80, 12288
    s_add_u32 s34, s75, 917504
    buffer_load_dwordx4 v20, s[12:15], s34 offen offset:0 lds
    buffer_load_dwordx4 v21, s[12:15], s34 offen offset:1024 lds
    buffer_load_dwordx4 v22, s[12:15], s34 offen offset:2048 lds
    buffer_load_dwordx4 v23, s[12:15], s34 offen offset:3072 lds
    s_add_u32 m0, s80, 16384
    s_add_u32 s34, s75, 1048576
    buffer_load_dwordx4 v20, s[12:15], s34 offen offset:0 lds
    buffer_load_dwordx4 v21, s[12:15], s34 offen offset:1024 lds
    buffer_load_dwordx4 v22, s[12:15], s34 offen offset:2048 lds
    buffer_load_dwordx4 v23, s[12:15], s34 offen offset:3072 lds
    s_add_u32 m0, s80, 20480
    s_add_u32 s34, s75, 1179648
    buffer_load_dwordx4 v20, s[12:15], s34 offen offset:0 lds
    buffer_load_dwordx4 v21, s[12:15], s34 offen offset:1024 lds
    buffer_load_dwordx4 v22, s[12:15], s34 offen offset:2048 lds
    buffer_load_dwordx4 v23, s[12:15], s34 offen offset:3072 lds
    s_add_u32 m0, s80, 0
    s_add_u32 s34, s75, 1310720
    buffer_load_dwordx4 v20, s[12:15], s34 offen offset:0 lds
    buffer_load_dwordx4 v21, s[12:15], s34 offen offset:1024 lds
    buffer_load_dwordx4 v22, s[12:15], s34 offen offset:2048 lds
    buffer_load_dwordx4 v23, s[12:15], s34 offen offset:3072 lds
    s_add_u32 m0, s80, 4096
    s_add_u32 s34, s75, 1441792
    buffer_load_dwordx4 v20, s[12:15], s34 offen offset:0 lds
    buffer_load_dwordx4 v21, s[12:15], s34 offen offset:1024 lds
    buffer_load_dwordx4 v22, s[12:15], s34 offen offset:2048 lds
    buffer_load_dwordx4 v23, s[12:15], s34 offen offset:3072 lds
L_kd_join:
    s_mov_b32 s23, s72
    s_mov_b32 s24, s73
    s_mov_b32 s4, s56
    s_and_b32 s5, s57, 0xffff
    s_mov_b32 s6, 2097152
    s_mov_b32 s7, 0x00020000
    s_mul_i32 s32, s23, 2*112*1024
    s_mul_i32 s33, s22, 28*1024
    s_add_u32 s32, s32, s33
    s_add_u32 s32, s32, 14680064
    s_and_b32 s33, s22, 1
    s_mul_i32 s77, s33, 114688
    s_add_u32 s77, s77, s32
    s_mul_i32 s78, s33, 4294737920
    s_add_u32 s78, s78, 114688
    v_bfe_u32 v16, v1, 2, 1
    s_mov_b32 s69, 114688
    v_mul_lo_u32 v16, v16, s69
    v_and_b32 v17, 3, v1
    v_lshl_add_u32 v16, v17, 10, v16
    v_lshlrev_b32 v184, 16, v232
    v_add_f32 v160, v240, v184
    v_add_f32 v161, v241, v184
    v_add_f32 v162, v242, v184
    v_add_f32 v163, v243, v184
    v_add_f32 v164, v244, v184
    v_add_f32 v165, v245, v184
    v_add_f32 v166, v246, v184
    v_add_f32 v167, v247, v184
    v_add_f32 v168, v248, v184
    v_add_f32 v169, v249, v184
    v_add_f32 v170, v250, v184
    v_add_f32 v171, v251, v184
    v_add_f32 v172, v252, v184
    v_add_f32 v173, v253, v184
    v_add_f32 v174, v254, v184
    v_add_f32 v175, v255, v184
    v_mov_b32 v176, 0
    v_mov_b32 v177, 0
    v_mov_b32 v178, 0
    v_mov_b32 v179, 0
    v_mov_b32 v180, 0
    v_mov_b32 v181, 0
    v_mov_b32 v182, 0
    v_mov_b32 v183, 0
    v_mov_b32 v184, 0
    v_mov_b32 v185, 0
    v_mov_b32 v186, 0
    v_mov_b32 v187, 0
    v_mov_b32 v188, 0
    v_mov_b32 v189, 0
    v_mov_b32 v190, 0
    v_mov_b32 v191, 0
    v_mov_b32 v192, 0
    v_mov_b32 v193, 0
    v_mov_b32 v194, 0
    v_mov_b32 v195, 0
    v_mov_b32 v196, 0
    v_mov_b32 v197, 0
    v_mov_b32 v198, 0
    v_mov_b32 v199, 0
    v_mov_b32 v200, 0
    v_mov_b32 v201, 0
    v_mov_b32 v202, 0
    v_mov_b32 v203, 0
    v_mov_b32 v204, 0
    v_mov_b32 v205, 0
    v_mov_b32 v206, 0
    v_mov_b32 v207, 0
    v_mov_b32 v208, 0
    v_mov_b32 v209, 0
    v_mov_b32 v210, 0
    v_mov_b32 v211, 0
    v_mov_b32 v212, 0
    v_mov_b32 v213, 0
    v_mov_b32 v214, 0
    v_mov_b32 v215, 0
    v_mov_b32 v216, 0
    v_mov_b32 v217, 0
    v_mov_b32 v218, 0
    v_mov_b32 v219, 0
    v_mov_b32 v220, 0
    v_mov_b32 v221, 0
    v_mov_b32 v222, 0
    v_mov_b32 v223, 0
    s_waitcnt vmcnt(16)
    s_waitcnt lgkmcnt(0)
    ds_read_b64_tr_b16 a[96:97], v26 offset:8192
    ds_read_b64_tr_b16 a[98:99], v26 offset:9216
    ds_read_b64_tr_b16 a[100:101], v27 offset:8192
    ds_read_b64_tr_b16 a[102:103], v27 offset:9216
    ds_read_b64_tr_b16 a[104:105], v26 offset:10240
    ds_read_b64_tr_b16 a[106:107], v26 offset:11264
    ds_read_b64_tr_b16 a[108:109], v27 offset:10240
    ds_read_b64_tr_b16 a[110:111], v27 offset:11264
    ds_read_b64_tr_b16 a[112:113], v26 offset:12288
    ds_read_b64_tr_b16 a[114:115], v26 offset:13312
    ds_read_b64_tr_b16 a[116:117], v27 offset:12288
    ds_read_b64_tr_b16 a[118:119], v27 offset:13312
    s_waitcnt lgkmcnt(8)
    ds_read_b64_tr_b16 a[120:121], v26 offset:14336
    ds_read_b64_tr_b16 a[122:123], v26 offset:15360
    ds_read_b64_tr_b16 a[124:125], v27 offset:14336
    ds_read_b64_tr_b16 a[126:127], v27 offset:15360
    s_waitcnt lgkmcnt(0)
    s_add_u32 m0, s80, 8192
    s_add_u32 s34, s75, 1572864
    buffer_load_dwordx4 v20, s[12:15], s34 offen offset:0 lds
    buffer_load_dwordx4 v21, s[12:15], s34 offen offset:1024 lds
    buffer_load_dwordx4 v22, s[12:15], s34 offen offset:2048 lds
    buffer_load_dwordx4 v23, s[12:15], s34 offen offset:3072 lds
    s_add_u32 m0, s80, 12288
    s_add_u32 s34, s75, 1703936
    buffer_load_dwordx4 v20, s[12:15], s34 offen offset:0 lds
    buffer_load_dwordx4 v21, s[12:15], s34 offen offset:1024 lds
    buffer_load_dwordx4 v22, s[12:15], s34 offen offset:2048 lds
    buffer_load_dwordx4 v23, s[12:15], s34 offen offset:3072 lds
    s_add_u32 s35, s77, 0
    s_add_u32 s36, s35, s78
    buffer_load_dwordx4 v[32:35], v2, s[16:19], s35 offen offset:0 sc1
    buffer_load_dwordx4 v[36:39], v2, s[16:19], s36 offen offset:0 sc1
    buffer_load_dwordx4 v[40:43], v2, s[16:19], s35 offen offset:1024 sc1
    buffer_load_dwordx4 v[44:47], v2, s[16:19], s36 offen offset:1024 sc1
    buffer_load_dwordx4 v[48:51], v2, s[16:19], s35 offen offset:2048 sc1
    buffer_load_dwordx4 v[52:55], v2, s[16:19], s36 offen offset:2048 sc1
    buffer_load_dwordx4 v[56:59], v2, s[16:19], s35 offen offset:3072 sc1
    buffer_load_dwordx4 v[60:63], v2, s[16:19], s36 offen offset:3072 sc1
    s_add_u32 s35, s77, 4096
    s_add_u32 s36, s35, s78
    buffer_load_dwordx4 v[64:67], v2, s[16:19], s35 offen offset:0 sc1
    buffer_load_dwordx4 v[68:71], v2, s[16:19], s36 offen offset:0 sc1
    buffer_load_dwordx4 v[72:75], v2, s[16:19], s35 offen offset:1024 sc1
    buffer_load_dwordx4 v[76:79], v2, s[16:19], s36 offen offset:1024 sc1
    buffer_load_dwordx4 v[80:83], v2, s[16:19], s35 offen offset:2048 sc1
    buffer_load_dwordx4 v[84:87], v2, s[16:19], s36 offen offset:2048 sc1
    buffer_load_dwordx4 v[88:91], v2, s[16:19], s35 offen offset:3072 sc1
    buffer_load_dwordx4 v[92:95], v2, s[16:19], s36 offen offset:3072 sc1
    s_waitcnt vmcnt(32)
    s_waitcnt lgkmcnt(0)
    ds_read_b64_tr_b16 a[128:129], v26 offset:16384
    ds_read_b64_tr_b16 a[130:131], v26 offset:17408
    ds_read_b64_tr_b16 a[132:133], v27 offset:16384
    ds_read_b64_tr_b16 a[134:135], v27 offset:17408
    ds_read_b64_tr_b16 a[136:137], v26 offset:18432
    ds_read_b64_tr_b16 a[138:139], v26 offset:19456
    ds_read_b64_tr_b16 a[140:141], v27 offset:18432
    ds_read_b64_tr_b16 a[142:143], v27 offset:19456
    ds_read_b64_tr_b16 a[144:145], v26 offset:20480
    ds_read_b64_tr_b16 a[146:147], v26 offset:21504
    ds_read_b64_tr_b16 a[148:149], v27 offset:20480
    ds_read_b64_tr_b16 a[150:151], v27 offset:21504
    s_waitcnt lgkmcnt(8)
    ds_read_b64_tr_b16 a[152:153], v26 offset:22528
    ds_read_b64_tr_b16 a[154:155], v26 offset:23552
    ds_read_b64_tr_b16 a[156:157], v27 offset:22528
    ds_read_b64_tr_b16 a[158:159], v27 offset:23552
    s_waitcnt vmcnt(24)
    s_waitcnt lgkmcnt(0)
    ds_read_b64_tr_b16 a[160:161], v26 offset:0
    ds_read_b64_tr_b16 a[162:163], v26 offset:1024
    ds_read_b64_tr_b16 a[164:165], v27 offset:0
    ds_read_b64_tr_b16 a[166:167], v27 offset:1024
    ds_read_b64_tr_b16 a[168:169], v26 offset:2048
    ds_read_b64_tr_b16 a[170:171], v26 offset:3072
    ds_read_b64_tr_b16 a[172:173], v27 offset:2048
    ds_read_b64_tr_b16 a[174:175], v27 offset:3072
    ds_read_b64_tr_b16 a[176:177], v26 offset:4096
    ds_read_b64_tr_b16 a[178:179], v26 offset:5120
    ds_read_b64_tr_b16 a[180:181], v27 offset:4096
    ds_read_b64_tr_b16 a[182:183], v27 offset:5120
    s_waitcnt lgkmcnt(8)
    ds_read_b64_tr_b16 a[184:185], v26 offset:6144
    ds_read_b64_tr_b16 a[186:187], v26 offset:7168
    ds_read_b64_tr_b16 a[188:189], v27 offset:6144
    ds_read_b64_tr_b16 a[190:191], v27 offset:7168
    s_waitcnt vmcnt(16)
    s_waitcnt lgkmcnt(0)
    ds_read_b64_tr_b16 a[192:193], v26 offset:8192
    ds_read_b64_tr_b16 a[194:195], v26 offset:9216
    ds_read_b64_tr_b16 a[196:197], v27 offset:8192
    ds_read_b64_tr_b16 a[198:199], v27 offset:9216
    ds_read_b64_tr_b16 a[200:201], v26 offset:10240
    ds_read_b64_tr_b16 a[202:203], v26 offset:11264
    ds_read_b64_tr_b16 a[204:205], v27 offset:10240
    ds_read_b64_tr_b16 a[206:207], v27 offset:11264
    ds_read_b64_tr_b16 a[208:209], v26 offset:12288
    ds_read_b64_tr_b16 a[210:211], v26 offset:13312
    ds_read_b64_tr_b16 a[212:213], v27 offset:12288
    ds_read_b64_tr_b16 a[214:215], v27 offset:13312
    s_waitcnt lgkmcnt(8)
    ds_read_b64_tr_b16 a[216:217], v26 offset:14336
    ds_read_b64_tr_b16 a[218:219], v26 offset:15360
    ds_read_b64_tr_b16 a[220:221], v27 offset:14336
    ds_read_b64_tr_b16 a[222:223], v27 offset:15360
    s_add_u32 s35, s77, 8192
    s_add_u32 s36, s35, s78
    buffer_load_dwordx4 v[96:99], v2, s[16:19], s35 offen offset:0 sc1
    buffer_load_dwordx4 v[100:103], v2, s[16:19], s36 offen offset:0 sc1
    buffer_load_dwordx4 v[104:107], v2, s[16:19], s35 offen offset:1024 sc1
    buffer_load_dwordx4 v[108:111], v2, s[16:19], s36 offen offset:1024 sc1
    buffer_load_dwordx4 v[112:115], v2, s[16:19], s35 offen offset:2048 sc1
    buffer_load_dwordx4 v[116:119], v2, s[16:19], s36 offen offset:2048 sc1
    buffer_load_dwordx4 v[120:123], v2, s[16:19], s35 offen offset:3072 sc1
    buffer_load_dwordx4 v[124:127], v2, s[16:19], s36 offen offset:3072 sc1
    s_waitcnt vmcnt(16)
    v_max3_u32 v17, v32, v36, v40
    v_max3_u32 v18, v44, v48, v52
    v_max3_u32 v17, v17, v56, v60
    v_max_u32 v17, v17, v18
    v_cmp_eq_u32 vcc, -1, v17
    s_cbranch_vccnz L_ke_first_again
L_ke_first_ok:
    s_waitcnt lgkmcnt(0)
    v_mfma_f32_32x32x16_bf16 v[160:175], v[32:35], a[0:3], v[160:175]
    s_add_u32 s35, s77, 12288
    s_add_u32 s36, s35, s78
    buffer_load_dwordx4 v[128:131], v2, s[16:19], s35 offen offset:0 sc1
    v_mfma_f32_32x32x16_bf16 v[176:191], v[36:39], a[0:3], v[176:191]
    v_mfma_f32_32x32x16_bf16 v[192:207], v[32:35], a[4:7], v[192:207]
    buffer_load_dwordx4 v[132:135], v2, s[16:19], s36 offen offset:0 sc1
    v_mfma_f32_32x32x16_bf16 v[208:223], v[36:39], a[4:7], v[208:223]
    v_mfma_f32_32x32x16_bf16 v[160:175], v[40:43], a[8:11], v[160:175]
    buffer_load_dwordx4 v[136:139], v2, s[16:19], s35 offen offset:1024 sc1
    v_mfma_f32_32x32x16_bf16 v[176:191], v[44:47], a[8:11], v[176:191]
    v_mfma_f32_32x32x16_bf16 v[192:207], v[40:43], a[12:15], v[192:207]
    buffer_load_dwordx4 v[140:143], v2, s[16:19], s36 offen offset:1024 sc1
    v_mfma_f32_32x32x16_bf16 v[208:223], v[44:47], a[12:15], v[208:223]
    v_mfma_f32_32x32x16_bf16 v[160:175], v[48:51], a[16:19], v[160:175]
    buffer_load_dwordx4 v[144:147], v2, s[16:19], s35 offen offset:2048 sc1
    v_mfma_f32_32x32x16_bf16 v[176:191], v[52:55], a[16:19], v[176:191]
    v_mfma_f32_32x32x16_bf16 v[192:207], v[48:51], a[20:23], v[192:207]
    buffer_load_dwordx4 v[148:151], v2, s[16:19], s36 offen offset:2048 sc1
    v_mfma_f32_32x32x16_bf16 v[208:223], v[52:55], a[20:23], v[208:223]
    s_waitcnt vmcnt(14)
    v_max3_u32 v17, v64, v68, v72
    v_max3_u32 v18, v76, v80, v84
    v_max3_u32 v17, v17, v88, v92
    v_max_u32 v17, v17, v18
    v_cmp_eq_u32 vcc, -1, v17
    s_cbranch_vccnz L_ke_retry1
L_ke_ok1:
    v_mfma_f32_32x32x16_bf16 v[160:175], v[56:59], a[24:27], v[160:175]
    buffer_load_dwordx4 v[152:155], v2, s[16:19], s35 offen offset:3072 sc1
    v_mfma_f32_32x32x16_bf16 v[176:191], v[60:63], a[24:27], v[176:191]
    v_mfma_f32_32x32x16_bf16 v[192:207], v[56:59], a[28:31], v[192:207]
    buffer_load_dwordx4 v[156:159], v2, s[16:19], s36 offen offset:3072 sc1
    v_mfma_f32_32x32x16_bf16 v[208:223], v[60:63], a[28:31], v[208:223]
    v_mfma_f32_32x32x16_bf16 v[160:175], v[64:67], a[32:35], v[160:175]
    s_add_u32 s35, s77, 16384
    s_add_u32 s36, s35, s78
    buffer_load_dwordx4 v[32:35], v2, s[16:19], s35 offen offset:0 sc1
    v_mfma_f32_32x32x16_bf16 v[176:191], v[68:71], a[32:35], v[176:191]
    v_mfma_f32_32x32x16_bf16 v[192:207], v[64:67], a[36:39], v[192:207]
    buffer_load_dwordx4 v[36:39], v2, s[16:19], s36 offen offset:0 sc1
    v_mfma_f32_32x32x16_bf16 v[208:223], v[68:71], a[36:39], v[208:223]
    v_mfma_f32_32x32x16_bf16 v[160:175], v[72:75], a[40:43], v[160:175]
    buffer_load_dwordx4 v[40:43], v2, s[16:19], s35 offen offset:1024 sc1
    v_mfma_f32_32x32x16_bf16 v[176:191], v[76:79], a[40:43], v[176:191]
    v_mfma_f32_32x32x16_bf16 v[192:207], v[72:75], a[44:47], v[192:207]
    buffer_load_dwordx4 v[44:47], v2, s[16:19], s36 offen offset:1024 sc1
    v_mfma_f32_32x32x16_bf16 v[208:223], v[76:79], a[44:47], v[208:223]
    v_mfma_f32_32x32x16_bf16 v[160:175], v[80:83], a[48:51], v[160:175]
    buffer_load_dwordx4 v[48:51], v2, s[16:19], s35 offen offset:2048 sc1
    v_mfma_f32_32x32x16_bf16 v[176:191], v[84:87], a[48:51], v[176:191]
    v_mfma_f32_32x32x16_bf16 v[192:207], v[80:83], a[52:55], v[192:207]
    buffer_load_dwordx4 v[52:55], v2, s[16:19], s36 offen offset:2048 sc1
    v_mfma_f32_32x32x16_bf16 v[208:223], v[84:87], a[52:55], v[208:223]
    s_waitcnt vmcnt(14)
    v_max3_u32 v17, v96, v100, v104
    v_max3_u32 v18, v108, v112, v116
    v_max3_u32 v17, v17, v120, v124
    v_max_u32 v17, v17, v18
    v_cmp_eq_u32 vcc, -1, v17
    s_cbranch_vccnz L_ke_retry2
L_ke_ok2:
    v_mfma_f32_32x32x16_bf16 v[160:175], v[88:91], a[56:59], v[160:175]
    buffer_load_dwordx4 v[56:59], v2, s[16:19], s35 offen offset:3072 sc1
    v_mfma_f32_32x32x16_bf16 v[176:191], v[92:95], a[56:59], v[176:191]
    v_mfma_f32_32x32x16_bf16 v[192:207], v[88:91], a[60:63], v[192:207]
    buffer_load_dwordx4 v[60:63], v2, s[16:19], s36 offen offset:3072 sc1
    v_mfma_f32_32x32x16_bf16 v[208:223], v[92:95], a[60:63], v[208:223]
    v_mfma_f32_32x32x16_bf16 v[160:175], v[96:99], a[64:67], v[160:175]
    s_add_u32 s35, s77, 20480
    s_add_u32 s36, s35, s78
    buffer_load_dwordx4 v[64:67], v2, s[16:19], s35 offen offset:0 sc1
    v_mfma_f32_32x32x16_bf16 v[176:191], v[100:103], a[64:67], v[176:191]
    v_mfma_f32_32x32x16_bf16 v[192:207], v[96:99], a[68:71], v[192:207]
    buffer_load_dwordx4 v[68:71], v2, s[16:19], s36 offen offset:0 sc1
    v_mfma_f32_32x32x16_bf16 v[208:223], v[100:103], a[68:71], v[208:223]
    v_mfma_f32_32x32x16_bf16 v[160:175], v[104:107], a[72:75], v[160:175]
    buffer_load_dwordx4 v[72:75], v2, s[16:19], s35 offen offset:1024 sc1
    v_mfma_f32_32x32x16_bf16 v[176:191], v[108:111], a[72:75], v[176:191]
    v_mfma_f32_32x32x16_bf16 v[192:207], v[104:107], a[76:79], v[192:207]
    buffer_load_dwordx4 v[76:79], v2, s[16:19], s36 offen offset:1024 sc1
    v_mfma_f32_32x32x16_bf16 v[208:223], v[108:111], a[76:79], v[208:223]
    v_mfma_f32_32x32x16_bf16 v[160:175], v[112:115], a[80:83], v[160:175]
    buffer_load_dwordx4 v[80:83], v2, s[16:19], s35 offen offset:2048 sc1
    v_mfma_f32_32x32x16_bf16 v[176:191], v[116:119], a[80:83], v[176:191]
    v_mfma_f32_32x32x16_bf16 v[192:207], v[112:115], a[84:87], v[192:207]
    buffer_load_dwordx4 v[84:87], v2, s[16:19], s36 offen offset:2048 sc1
    v_mfma_f32_32x32x16_bf16 v[208:223], v[116:119], a[84:87], v[208:223]
    s_waitcnt vmcnt(14)
    v_max3_u32 v17, v128, v132, v136
    v_max3_u32 v18, v140, v144, v148
    v_max3_u32 v17, v17, v152, v156
    v_max_u32 v17, v17, v18
    v_cmp_eq_u32 vcc, -1, v17
    s_cbranch_vccnz L_ke_retry3
L_ke_ok3:
    v_mfma_f32_32x32x16_bf16 v[160:175], v[120:123], a[88:91], v[160:175]
    buffer_load_dwordx4 v[88:91], v2, s[16:19], s35 offen offset:3072 sc1
    v_mfma_f32_32x32x16_bf16 v[176:191], v[124:127], a[88:91], v[176:191]
    v_mfma_f32_32x32x16_bf16 v[192:207], v[120:123], a[92:95], v[192:207]
    buffer_load_dwordx4 v[92:95], v2, s[16:19], s36 offen offset:3072 sc1
    v_mfma_f32_32x32x16_bf16 v[208:223], v[124:127], a[92:95], v[208:223]
    v_mfma_f32_32x32x16_bf16 v[160:175], v[128:131], a[96:99], v[160:175]
    s_add_u32 s35, s77, 24576
    s_add_u32 s36, s35, s78
    buffer_load_dwordx4 v[96:99], v2, s[16:19], s35 offen offset:0 sc1
    v_mfma_f32_32x32x16_bf16 v[176:191], v[132:135], a[96:99], v[176:191]
    v_mfma_f32_32x32x16_bf16 v[192:207], v[128:131], a[100:103], v[192:207]
    buffer_load_dwordx4 v[100:103], v2, s[16:19], s36 offen offset:0 sc1
    v_mfma_f32_32x32x16_bf16 v[208:223], v[132:135], a[100:103], v[208:223]
    v_mfma_f32_32x32x16_bf16 v[160:175], v[136:139], a[104:107], v[160:175]
    buffer_load_dwordx4 v[104:107], v2, s[16:19], s35 offen offset:1024 sc1
    v_mfma_f32_32x32x16_bf16 v[176:191], v[140:143], a[104:107], v[176:191]
    v_mfma_f32_32x32x16_bf16 v[192:207], v[136:139], a[108:111], v[192:207]
    buffer_load_dwordx4 v[108:111], v2, s[16:19], s36 offen offset:1024 sc1
    v_mfma_f32_32x32x16_bf16 v[208:223], v[140:143], a[108:111], v[208:223]
    v_mfma_f32_32x32x16_bf16 v[160:175], v[144:147], a[112:115], v[160:175]
    buffer_load_dwordx4 v[112:115], v2, s[16:19], s35 offen offset:2048 sc1
    v_mfma_f32_32x32x16_bf16 v[176:191], v[148:151], a[112:115], v[176:191]
    v_mfma_f32_32x32x16_bf16 v[192:207], v[144:147], a[116:119], v[192:207]
    buffer_load_dwordx4 v[116:119], v2, s[16:19], s36 offen offset:2048 sc1
    v_mfma_f32_32x32x16_bf16 v[208:223], v[148:151], a[116:119], v[208:223]
    s_waitcnt vmcnt(14)
    v_max3_u32 v17, v32, v36, v40
    v_max3_u32 v18, v44, v48, v52
    v_max3_u32 v17, v17, v56, v60
    v_max_u32 v17, v17, v18
    v_cmp_eq_u32 vcc, -1, v17
    s_cbranch_vccnz L_ke_retry4
L_ke_ok4:
    v_mfma_f32_32x32x16_bf16 v[160:175], v[152:155], a[120:123], v[160:175]
    buffer_load_dwordx4 v[120:123], v2, s[16:19], s35 offen offset:3072 sc1
    v_mfma_f32_32x32x16_bf16 v[176:191], v[156:159], a[120:123], v[176:191]
    v_mfma_f32_32x32x16_bf16 v[192:207], v[152:155], a[124:127], v[192:207]
    buffer_load_dwordx4 v[124:127], v2, s[16:19], s36 offen offset:3072 sc1
    v_mfma_f32_32x32x16_bf16 v[208:223], v[156:159], a[124:127], v[208:223]
    v_mfma_f32_32x32x16_bf16 v[160:175], v[32:35], a[128:131], v[160:175]
    v_mfma_f32_32x32x16_bf16 v[176:191], v[36:39], a[128:131], v[176:191]
    v_mfma_f32_32x32x16_bf16 v[192:207], v[32:35], a[132:135], v[192:207]
    v_mfma_f32_32x32x16_bf16 v[208:223], v[36:39], a[132:135], v[208:223]
    v_mfma_f32_32x32x16_bf16 v[160:175], v[40:43], a[136:139], v[160:175]
    v_mfma_f32_32x32x16_bf16 v[176:191], v[44:47], a[136:139], v[176:191]
    v_mfma_f32_32x32x16_bf16 v[192:207], v[40:43], a[140:143], v[192:207]
    v_mfma_f32_32x32x16_bf16 v[208:223], v[44:47], a[140:143], v[208:223]
    v_mfma_f32_32x32x16_bf16 v[160:175], v[48:51], a[144:147], v[160:175]
    v_mfma_f32_32x32x16_bf16 v[176:191], v[52:55], a[144:147], v[176:191]
    v_mfma_f32_32x32x16_bf16 v[192:207], v[48:51], a[148:151], v[192:207]
    v_mfma_f32_32x32x16_bf16 v[208:223], v[52:55], a[148:151], v[208:223]
    s_waitcnt vmcnt(8)
    v_max3_u32 v17, v64, v68, v72
    v_max3_u32 v18, v76, v80, v84
    v_max3_u32 v17, v17, v88, v92
    v_max_u32 v17, v17, v18
    v_cmp_eq_u32 vcc, -1, v17
    s_cbranch_vccnz L_ke_retry5
L_ke_ok5:
    v_mfma_f32_32x32x16_bf16 v[160:175], v[56:59], a[152:155], v[160:175]
    v_mfma_f32_32x32x16_bf16 v[176:191], v[60:63], a[152:155], v[176:191]
    v_mfma_f32_32x32x16_bf16 v[192:207], v[56:59], a[156:159], v[192:207]
    v_mfma_f32_32x32x16_bf16 v[208:223], v[60:63], a[156:159], v[208:223]
    s_xor_b32 s34, s22, 1
    s_mul_i32 s34, s34, 12288
    s_add_u32 s34, s34, 98304
    v_add_u32 v13, s34, v2
    s_xor_b32 s34, s22, 2
    s_mul_i32 s34, s34, 12288
    s_add_u32 s34, s34, 102400
    v_add_u32 v14, s34, v2
    s_xor_b32 s34, s22, 3
    s_mul_i32 s34, s34, 12288
    s_add_u32 s34, s34, 106496
    v_add_u32 v15, s34, v2
    s_mul_i32 s34, s22, 12288
    s_add_u32 s34, s34, 98304
    v_add_u32 v9, s34, v2
    v_mfma_f32_32x32x16_bf16 v[176:191], v[68:71], a[160:163], v[176:191]
    v_mfma_f32_32x32x16_bf16 v[176:191], v[76:79], a[168:171], v[176:191]
    v_mfma_f32_32x32x16_bf16 v[176:191], v[84:87], a[176:179], v[176:191]
    v_mfma_f32_32x32x16_bf16 v[176:191], v[92:95], a[184:187], v[176:191]
    s_waitcnt vmcnt(0)
    v_max3_u32 v17, v96, v100, v104
    v_max3_u32 v18, v108, v112, v116
    v_max3_u32 v17, v17, v120, v124
    v_max_u32 v17, v17, v18
    v_cmp_eq_u32 vcc, -1, v17
    s_cbranch_vccnz L_ke_retry6
L_ke_ok6:
    v_mfma_f32_32x32x16_bf16 v[176:191], v[100:103], a[192:195], v[176:191]
    v_mfma_f32_32x32x16_bf16 v[176:191], v[108:111], a[200:203], v[176:191]
    v_mfma_f32_32x32x16_bf16 v[176:191], v[116:119], a[208:211], v[176:191]
    v_mfma_f32_32x32x16_bf16 v[176:191], v[124:127], a[216:219], v[176:191]
    v_mfma_f32_32x32x16_bf16 v[192:207], v[64:67], a[164:167], v[192:207]
    v_mfma_f32_32x32x16_bf16 v[192:207], v[72:75], a[172:175], v[192:207]
    v_mfma_f32_32x32x16_bf16 v[192:207], v[80:83], a[180:183], v[192:207]
    v_mfma_f32_32x32x16_bf16 v[192:207], v[88:91], a[188:191], v[192:207]
    v_mfma_f32_32x32x16_bf16 v[192:207], v[96:99], a[196:199], v[192:207]
    s_nop 6
    ds_write_b128 v13, v[176:179] offset:0
    v_mfma_f32_32x32x16_bf16 v[192:207], v[104:107], a[204:207], v[192:207]
    ds_write_b128 v13, v[180:183] offset:1024
    v_mfma_f32_32x32x16_bf16 v[192:207], v[112:115], a[212:215], v[192:207]
    ds_write_b128 v13, v[184:187] offset:2048
    v_mfma_f32_32x32x16_bf16 v[192:207], v[120:123], a[220:223], v[192:207]
    ds_write_b128 v13, v[188:191] offset:3072
    v_mfma_f32_32x32x16_bf16 v[208:223], v[68:71], a[164:167], v[208:223]
    v_mfma_f32_32x32x16_bf16 v[208:223], v[76:79], a[172:175], v[208:223]
    v_mfma_f32_32x32x16_bf16 v[208:223], v[84:87], a[180:183], v[208:223]
    v_mfma_f32_32x32x16_bf16 v[208:223], v[92:95], a[188:191], v[208:223]
    v_mfma_f32_32x32x16_bf16 v[208:223], v[100:103], a[196:199], v[208:223]
    s_nop 5
    ds_write_b128 v14, v[192:195] offset:0
    v_mfma_f32_32x32x16_bf16 v[208:223], v[108:111], a[204:207], v[208:223]
    ds_write_b128 v14, v[196:199] offset:1024
    v_mfma_f32_32x32x16_bf16 v[208:223], v[116:119], a[212:215], v[208:223]
    ds_write_b128 v14, v[200:203] offset:2048
    v_mfma_f32_32x32x16_bf16 v[208:223], v[124:127], a[220:223], v[208:223]
    ds_write_b128 v14, v[204:207] offset:3072
    v_mfma_f32_32x32x16_bf16 v[160:175], v[64:67], a[160:163], v[160:175]
    v_mfma_f32_32x32x16_bf16 v[160:175], v[72:75], a[168:171], v[160:175]
    v_mfma_f32_32x32x16_bf16 v[160:175], v[80:83], a[176:179], v[160:175]
    v_mfma_f32_32x32x16_bf16 v[160:175], v[88:91], a[184:187], v[160:175]
    v_mfma_f32_32x32x16_bf16 v[160:175], v[96:99], a[192:195], v[160:175]
    s_nop 5
    ds_write_b128 v15, v[208:211] offset:0
    v_mfma_f32_32x32x16_bf16 v[160:175], v[104:107], a[200:203], v[160:175]
    ds_write_b128 v15, v[212:215] offset:1024
    v_mfma_f32_32x32x16_bf16 v[160:175], v[112:115], a[208:211], v[160:175]
    ds_write_b128 v15, v[216:219] offset:2048
    v_mfma_f32_32x32x16_bf16 v[160:175], v[120:123], a[216:219], v[160:175]
    ds_write_b128 v15, v[220:223] offset:3072
    s_waitcnt lgkmcnt(0)
    s_barrier
    ds_read_b128 v[32:35], v9 offset:0
    ds_read_b128 v[36:39], v9 offset:1024
    ds_read_b128 v[40:43], v9 offset:2048
    ds_read_b128 v[44:47], v9 offset:3072
    ds_read_b128 v[48:51], v9 offset:4096
    ds_read_b128 v[52:55], v9 offset:5120
    ds_read_b128 v[56:59], v9 offset:6144
    ds_read_b128 v[60:63], v9 offset:7168
    ds_read_b128 v[64:67], v9 offset:8192
    ds_read_b128 v[68:71], v9 offset:9216
    ds_read_b128 v[72:75], v9 offset:10240
    ds_read_b128 v[76:79], v9 offset:11264
    s_waitcnt lgkmcnt(8)
    v_add_f32 v160, v160, v32
    v_add_f32 v161, v161, v33
    v_add_f32 v162, v162, v34
    v_add_f32 v163, v163, v35
    v_add_f32 v164, v164, v36
    v_add_f32 v165, v165, v37
    v_add_f32 v166, v166, v38
    v_add_f32 v167, v167, v39
    v_add_f32 v168, v168, v40
    v_add_f32 v169, v169, v41
    v_add_f32 v170, v170, v42
    v_add_f32 v171, v171, v43
    v_add_f32 v172, v172, v44
    v_add_f32 v173, v173, v45
    v_add_f32 v174, v174, v46
    v_add_f32 v175, v175, v47
    s_waitcnt lgkmcnt(0)
    v_add_f32 v48, v48, v64
    v_add_f32 v49, v49, v65
    v_add_f32 v50, v50, v66
    v_add_f32 v51, v51, v67
    v_add_f32 v52, v52, v68
    v_add_f32 v53, v53, v69
    v_add_f32 v54, v54, v70
    v_add_f32 v55, v55, v71
    v_add_f32 v56, v56, v72
    v_add_f32 v57, v57, v73
    v_add_f32 v58, v58, v74
    v_add_f32 v59, v59, v75
    v_add_f32 v60, v60, v76
    v_add_f32 v61, v61, v77
    v_add_f32 v62, v62, v78
    v_add_f32 v63, v63, v79
    v_add_f32 v160, v160, v48
    v_add_f32 v161, v161, v49
    v_add_f32 v162, v162, v50
    v_add_f32 v163, v163, v51
    v_add_f32 v164, v164, v52
    v_add_f32 v165, v165, v53
    v_add_f32 v166, v166, v54
    v_add_f32 v167, v167, v55
    v_add_f32 v168, v168, v56
    v_add_f32 v169, v169, v57
    v_add_f32 v170, v170, v58
    v_add_f32 v171, v171, v59
    v_add_f32 v172, v172, v60
    v_add_f32 v173, v173, v61
    v_add_f32 v174, v174, v62
    v_add_f32 v175, v175, v63
    v_cvt_pk_bf16_f32 v48, v160, v161
    v_cvt_pk_bf16_f32 v49, v162, v163
    v_cvt_pk_bf16_f32 v50, v164, v165
    v_cvt_pk_bf16_f32 v51, v166, v167
    v_cvt_pk_bf16_f32 v52, v168, v169
    v_cvt_pk_bf16_f32 v53, v170, v171
    v_cvt_pk_bf16_f32 v54, v172, v173
    v_cvt_pk_bf16_f32 v55, v174, v175
    v_and_b32 v8, 31, v1
    v_lshlrev_b32 v8, 10, v8
    v_lshrrev_b32 v9, 5, v1
    v_lshl_add_u32 v8, v9, 4, v8
    v_permlane32_swap_b32 v48, v50
    v_permlane32_swap_b32 v49, v51
    v_permlane32_swap_b32 v52, v54
    v_permlane32_swap_b32 v53, v55
    s_lshl_b32 s35, s24, 1
    s_lshr_b32 s36, s22, 1
    s_add_u32 s35, s35, s36
    s_lshl_b32 s35, s35, 15
    s_lshl_b32 s36, s23, 1
    s_and_b32 s33, s22, 1
    s_add_u32 s36, s36, s33
    s_lshl_b32 s36, s36, 6
    s_add_u32 s35, s35, s36
    buffer_store_dwordx4 v[48:51], v8, s[4:7], s35 offen nt
    buffer_store_dwordx4 v[52:55], v8, s[4:7], s35 offen offset:32 nt
    s_branch L_F_fin
L_kb_cfspin:
    s_mov_b32 s37, 262144
    v_and_b32 v222, 15, v1
    v_lshlrev_b32 v222, 8, v222
    s_mov_b32 s65, 6361088
L_kb_cfspin2:
    buffer_load_dword v233, v222, s[16:19], s65 offen sc1
    s_waitcnt vmcnt(0)
    v_cmp_gt_u32 vcc, 16, v233
    s_sub_u32 s37, s37, 1
    s_cmp_eq_u32 s37, 0
    s_cbranch_scc1 L_kb_cfok
    s_cbranch_vccnz L_kb_cfspin2
    s_branch L_kb_cfok
L_kc_spin:
    s_mov_b32 s37, 262144
L_kc_spin2:
    s_add_u32 s33, s32, 0
    buffer_load_dwordx4 v[32:35], v2, s[16:19], s33 offen offset:0 sc1
    buffer_load_dwordx4 v[36:39], v2, s[16:19], s33 offen offset:1024 sc1
    buffer_load_dwordx4 v[40:43], v2, s[16:19], s33 offen offset:2048 sc1
    buffer_load_dwordx4 v[44:47], v2, s[16:19], s33 offen offset:3072 sc1
    s_add_u32 s33, s32, 4096
    buffer_load_dwordx4 v[48:51], v2, s[16:19], s33 offen offset:0 sc1
    buffer_load_dwordx4 v[52:55], v2, s[16:19], s33 offen offset:1024 sc1
    buffer_load_dwordx4 v[56:59], v2, s[16:19], s33 offen offset:2048 sc1
    buffer_load_dwordx4 v[60:63], v2, s[16:19], s33 offen offset:3072 sc1
    s_add_u32 s33, s32, 8192
    buffer_load_dwordx4 v[64:67], v2, s[16:19], s33 offen offset:0 sc1
    buffer_load_dwordx4 v[68:71], v2, s[16:19], s33 offen offset:1024 sc1
    buffer_load_dwordx4 v[72:75], v2, s[16:19], s33 offen offset:2048 sc1
    buffer_load_dwordx4 v[76:79], v2, s[16:19], s33 offen offset:3072 sc1
    s_add_u32 s33, s32, 12288
    buffer_load_dwordx4 v[80:83], v2, s[16:19], s33 offen offset:0 sc1
    buffer_load_dwordx4 v[84:87], v2, s[16:19], s33 offen offset:1024 sc1
    buffer_load_dwordx4 v[88:91], v2, s[16:19], s33 offen offset:2048 sc1
    buffer_load_dwordx4 v[92:95], v2, s[16:19], s33 offen offset:3072 sc1
    s_waitcnt vmcnt(0)
    s_sub_u32 s37, s37, 1
    s_cmp_eq_u32 s37, 0
    s_cbranch_scc1 L_kc_ok
    v_max3_u32 v17, v32, v36, v40
    v_max3_u32 v18, v44, v48, v52
    v_max3_u32 v17, v17, v56, v60
    v_max3_u32 v18, v18, v64, v68
    v_max3_u32 v17, v17, v72, v76
    v_max3_u32 v18, v18, v80, v84
    v_max3_u32 v17, v17, v88, v92
    v_max_u32 v17, v17, v18
    v_cmp_eq_u32 vcc, -1, v17
    s_cbranch_vccnz L_kc_spin2
L_kc_ok_x:
    s_branch L_kc_ok
L_kd_first_again:
    s_mov_b32 s37, 262144
L_kd_first_spin:
    s_waitcnt vmcnt(0)
    s_add_u32 s81, s77, 0
    s_add_u32 s82, s81, s78
    buffer_load_dwordx4 v[32:35], v2, s[16:19], s81 offen offset:0 sc1
    buffer_load_dwordx4 v[36:39], v2, s[16:19], s82 offen offset:0 sc1
    buffer_load_dwordx4 v[40:43], v2, s[16:19], s81 offen offset:1024 sc1
    buffer_load_dwordx4 v[44:47], v2, s[16:19], s82 offen offset:1024 sc1
    buffer_load_dwordx4 v[48:51], v2, s[16:19], s81 offen offset:2048 sc1
    buffer_load_dwordx4 v[52:55], v2, s[16:19], s82 offen offset:2048 sc1
    buffer_load_dwordx4 v[56:59], v2, s[16:19], s81 offen offset:3072 sc1
    buffer_load_dwordx4 v[60:63], v2, s[16:19], s82 offen offset:3072 sc1
    s_add_u32 s81, s77, 4096
    s_add_u32 s82, s81, s78
    buffer_load_dwordx4 v[64:67], v2, s[16:19], s81 offen offset:0 sc1
    buffer_load_dwordx4 v[68:71], v2, s[16:19], s82 offen offset:0 sc1
    buffer_load_dwordx4 v[72:75], v2, s[16:19], s81 offen offset:1024 sc1
    buffer_load_dwordx4 v[76:79], v2, s[16:19], s82 offen offset:1024 sc1
    buffer_load_dwordx4 v[80:83], v2, s[16:19], s81 offen offset:2048 sc1
    buffer_load_dwordx4 v[84:87], v2, s[16:19], s82 offen offset:2048 sc1
    buffer_load_dwordx4 v[88:91], v2, s[16:19], s81 offen offset:3072 sc1
    buffer_load_dwordx4 v[92:95], v2, s[16:19], s82 offen offset:3072 sc1
    s_waitcnt vmcnt(8)
    s_sub_u32 s37, s37, 1
    s_cmp_eq_u32 s37, 0
    s_cbranch_scc1 L_kd_first_ok_x
    v_max3_u32 v17, v32, v36, v40
    v_max3_u32 v18, v44, v48, v52
    v_max3_u32 v17, v17, v56, v60
    v_max_u32 v17, v17, v18
    v_cmp_eq_u32 vcc, -1, v17
    s_cbranch_vccnz L_kd_first_spin
L_kd_first_ok_x:
    s_waitcnt vmcnt(0)
    s_branch L_kd_first_ok
L_kd_retry1:
    s_mov_b32 s37, 262144
    s_add_u32 s38, s32, 4096
L_kd_retry1_spin:
    buffer_load_dword v17, v16, s[16:19], s38 offen sc1
    s_waitcnt vmcnt(0)
    v_cmp_eq_u32 vcc, -1, v17
    s_sub_u32 s37, s37, 1
    s_cmp_eq_u32 s37, 0
    s_cbranch_scc1 L_kd_ok1
    s_cbranch_vccnz L_kd_retry1_spin
    s_add_u32 s81, s77, 4096
    s_add_u32 s82, s81, s78
    buffer_load_dwordx4 v[64:67], v2, s[16:19], s81 offen offset:0 sc1
    buffer_load_dwordx4 v[68:71], v2, s[16:19], s82 offen offset:0 sc1
    buffer_load_dwordx4 v[72:75], v2, s[16:19], s81 offen offset:1024 sc1
    buffer_load_dwordx4 v[76:79], v2, s[16:19], s82 offen offset:1024 sc1
    buffer_load_dwordx4 v[80:83], v2, s[16:19], s81 offen offset:2048 sc1
    buffer_load_dwordx4 v[84:87], v2, s[16:19], s82 offen offset:2048 sc1
    buffer_load_dwordx4 v[88:91], v2, s[16:19], s81 offen offset:3072 sc1
    buffer_load_dwordx4 v[92:95], v2, s[16:19], s82 offen offset:3072 sc1
    s_waitcnt vmcnt(0)
    v_max3_u32 v17, v64, v68, v72
    v_max3_u32 v18, v76, v80, v84
    v_max3_u32 v17, v17, v88, v92
    v_max_u32 v17, v17, v18
    v_cmp_eq_u32 vcc, -1, v17
    s_cbranch_vccnz L_kd_retry1_spin
L_kd_ok1_x:
    s_branch L_kd_ok1
L_kd_retry2:
    s_mov_b32 s37, 262144
    s_add_u32 s38, s32, 8192
L_kd_retry2_spin:
    buffer_load_dword v17, v16, s[16:19], s38 offen sc1
    s_waitcnt vmcnt(0)
    v_cmp_eq_u32 vcc, -1, v17
    s_sub_u32 s37, s37, 1
    s_cmp_eq_u32 s37, 0
    s_cbranch_scc1 L_kd_ok2
    s_cbranch_vccnz L_kd_retry2_spin
    s_add_u32 s81, s77, 8192
    s_add_u32 s82, s81, s78
    buffer_load_dwordx4 v[96:99], v2, s[16:19], s81 offen offset:0 sc1
    buffer_load_dwordx4 v[100:103], v2, s[16:19], s82 offen offset:0 sc1
    buffer_load_dwordx4 v[104:107], v2, s[16:19], s81 offen offset:1024 sc1
    buffer_load_dwordx4 v[108:111], v2, s[16:19], s82 offen offset:1024 sc1
    buffer_load_dwordx4 v[112:115], v2, s[16:19], s81 offen offset:2048 sc1
    buffer_load_dwordx4 v[116:119], v2, s[16:19], s82 offen offset:2048 sc1
    buffer_load_dwordx4 v[120:123], v2, s[16:19], s81 offen offset:3072 sc1
    buffer_load_dwordx4 v[124:127], v2, s[16:19], s82 offen offset:3072 sc1
    s_waitcnt vmcnt(0)
    v_max3_u32 v17, v96, v100, v104
    v_max3_u32 v18, v108, v112, v116
    v_max3_u32 v17, v17, v120, v124
    v_max_u32 v17, v17, v18
    v_cmp_eq_u32 vcc, -1, v17
    s_cbranch_vccnz L_kd_retry2_spin
L_kd_ok2_x:
    s_branch L_kd_ok2
L_kd_retry3:
    s_mov_b32 s37, 262144
    s_add_u32 s38, s32, 12288
L_kd_retry3_spin:
    buffer_load_dword v17, v16, s[16:19], s38 offen sc1
    s_waitcnt vmcnt(0)
    v_cmp_eq_u32 vcc, -1, v17
    s_sub_u32 s37, s37, 1
    s_cmp_eq_u32 s37, 0
    s_cbranch_scc1 L_kd_ok3
    s_cbranch_vccnz L_kd_retry3_spin
    s_add_u32 s81, s77, 12288
    s_add_u32 s82, s81, s78
    buffer_load_dwordx4 v[128:131], v2, s[16:19], s81 offen offset:0 sc1
    buffer_load_dwordx4 v[132:135], v2, s[16:19], s82 offen offset:0 sc1
    buffer_load_dwordx4 v[136:139], v2, s[16:19], s81 offen offset:1024 sc1
    buffer_load_dwordx4 v[140:143], v2, s[16:19], s82 offen offset:1024 sc1
    buffer_load_dwordx4 v[144:147], v2, s[16:19], s81 offen offset:2048 sc1
    buffer_load_dwordx4 v[148:151], v2, s[16:19], s82 offen offset:2048 sc1
    buffer_load_dwordx4 v[152:155], v2, s[16:19], s81 offen offset:3072 sc1
    buffer_load_dwordx4 v[156:159], v2, s[16:19], s82 offen offset:3072 sc1
    s_waitcnt vmcnt(0)
    v_max3_u32 v17, v128, v132, v136
    v_max3_u32 v18, v140, v144, v148
    v_max3_u32 v17, v17, v152, v156
    v_max_u32 v17, v17, v18
    v_cmp_eq_u32 vcc, -1, v17
    s_cbranch_vccnz L_kd_retry3_spin
L_kd_ok3_x:
    s_branch L_kd_ok3
L_kd_retry4:
    s_mov_b32 s37, 262144
    s_add_u32 s38, s32, 16384
L_kd_retry4_spin:
    buffer_load_dword v17, v16, s[16:19], s38 offen sc1
    s_waitcnt vmcnt(0)
    v_cmp_eq_u32 vcc, -1, v17
    s_sub_u32 s37, s37, 1
    s_cmp_eq_u32 s37, 0
    s_cbranch_scc1 L_kd_ok4
    s_cbranch_vccnz L_kd_retry4_spin
    s_add_u32 s81, s77, 16384
    s_add_u32 s82, s81, s78
    buffer_load_dwordx4 v[32:35], v2, s[16:19], s81 offen offset:0 sc1
    buffer_load_dwordx4 v[36:39], v2, s[16:19], s82 offen offset:0 sc1
    buffer_load_dwordx4 v[40:43], v2, s[16:19], s81 offen offset:1024 sc1
    buffer_load_dwordx4 v[44:47], v2, s[16:19], s82 offen offset:1024 sc1
    buffer_load_dwordx4 v[48:51], v2, s[16:19], s81 offen offset:2048 sc1
    buffer_load_dwordx4 v[52:55], v2, s[16:19], s82 offen offset:2048 sc1
    buffer_load_dwordx4 v[56:59], v2, s[16:19], s81 offen offset:3072 sc1
    buffer_load_dwordx4 v[60:63], v2, s[16:19], s82 offen offset:3072 sc1
    s_waitcnt vmcnt(0)
    v_max3_u32 v17, v32, v36, v40
    v_max3_u32 v18, v44, v48, v52
    v_max3_u32 v17, v17, v56, v60
    v_max_u32 v17, v17, v18
    v_cmp_eq_u32 vcc, -1, v17
    s_cbranch_vccnz L_kd_retry4_spin
L_kd_ok4_x:
    s_branch L_kd_ok4
L_kd_retry5:
    s_mov_b32 s37, 262144
    s_add_u32 s38, s32, 20480
L_kd_retry5_spin:
    buffer_load_dword v17, v16, s[16:19], s38 offen sc1
    s_waitcnt vmcnt(0)
    v_cmp_eq_u32 vcc, -1, v17
    s_sub_u32 s37, s37, 1
    s_cmp_eq_u32 s37, 0
    s_cbranch_scc1 L_kd_ok5
    s_cbranch_vccnz L_kd_retry5_spin
    s_add_u32 s81, s77, 20480
    s_add_u32 s82, s81, s78
    buffer_load_dwordx4 v[64:67], v2, s[16:19], s81 offen offset:0 sc1
    buffer_load_dwordx4 v[68:71], v2, s[16:19], s82 offen offset:0 sc1
    buffer_load_dwordx4 v[72:75], v2, s[16:19], s81 offen offset:1024 sc1
    buffer_load_dwordx4 v[76:79], v2, s[16:19], s82 offen offset:1024 sc1
    buffer_load_dwordx4 v[80:83], v2, s[16:19], s81 offen offset:2048 sc1
    buffer_load_dwordx4 v[84:87], v2, s[16:19], s82 offen offset:2048 sc1
    buffer_load_dwordx4 v[88:91], v2, s[16:19], s81 offen offset:3072 sc1
    buffer_load_dwordx4 v[92:95], v2, s[16:19], s82 offen offset:3072 sc1
    s_waitcnt vmcnt(0)
    v_max3_u32 v17, v64, v68, v72
    v_max3_u32 v18, v76, v80, v84
    v_max3_u32 v17, v17, v88, v92
    v_max_u32 v17, v17, v18
    v_cmp_eq_u32 vcc, -1, v17
    s_cbranch_vccnz L_kd_retry5_spin
L_kd_ok5_x:
    s_branch L_kd_ok5
L_kd_retry6:
    s_mov_b32 s37, 262144
    s_add_u32 s38, s32, 24576
L_kd_retry6_spin:
    buffer_load_dword v17, v16, s[16:19], s38 offen sc1
    s_waitcnt vmcnt(0)
    v_cmp_eq_u32 vcc, -1, v17
    s_sub_u32 s37, s37, 1
    s_cmp_eq_u32 s37, 0
    s_cbranch_scc1 L_kd_ok6
    s_cbranch_vccnz L_kd_retry6_spin
    s_add_u32 s81, s77, 24576
    s_add_u32 s82, s81, s78
    buffer_load_dwordx4 v[96:99], v2, s[16:19], s81 offen offset:0 sc1
    buffer_load_dwordx4 v[100:103], v2, s[16:19], s82 offen offset:0 sc1
    buffer_load_dwordx4 v[104:107], v2, s[16:19], s81 offen offset:1024 sc1
    buffer_load_dwordx4 v[108:111], v2, s[16:19], s82 offen offset:1024 sc1
    buffer_load_dwordx4 v[112:115], v2, s[16:19], s81 offen offset:2048 sc1
    buffer_load_dwordx4 v[116:119], v2, s[16:19], s82 offen offset:2048 sc1
    buffer_load_dwordx4 v[120:123], v2, s[16:19], s81 offen offset:3072 sc1
    buffer_load_dwordx4 v[124:127], v2, s[16:19], s82 offen offset:3072 sc1
    s_waitcnt vmcnt(0)
    v_max3_u32 v17, v96, v100, v104
    v_max3_u32 v18, v108, v112, v116
    v_max3_u32 v17, v17, v120, v124
    v_max_u32 v17, v17, v18
    v_cmp_eq_u32 vcc, -1, v17
    s_cbranch_vccnz L_kd_retry6_spin
L_kd_ok6_x:
    s_branch L_kd_ok6
L_kd_retry7:
    s_mov_b32 s37, 262144
    s_add_u32 s38, s32, 28672
L_kd_retry7_spin:
    buffer_load_dword v17, v16, s[16:19], s38 offen sc1
    s_waitcnt vmcnt(0)
    v_cmp_eq_u32 vcc, -1, v17
    s_sub_u32 s37, s37, 1
    s_cmp_eq_u32 s37, 0
    s_cbranch_scc1 L_kd_ok7
    s_cbranch_vccnz L_kd_retry7_spin
    s_add_u32 s81, s77, 28672
    s_add_u32 s82, s81, s78
    buffer_load_dwordx4 v[128:131], v2, s[16:19], s81 offen offset:0 sc1
    buffer_load_dwordx4 v[132:135], v2, s[16:19], s82 offen offset:0 sc1
    buffer_load_dwordx4 v[136:139], v2, s[16:19], s81 offen offset:1024 sc1
    buffer_load_dwordx4 v[140:143], v2, s[16:19], s82 offen offset:1024 sc1
    buffer_load_dwordx4 v[144:147], v2, s[16:19], s81 offen offset:2048 sc1
    buffer_load_dwordx4 v[148:151], v2, s[16:19], s82 offen offset:2048 sc1
    buffer_load_dwordx4 v[152:155], v2, s[16:19], s81 offen offset:3072 sc1
    buffer_load_dwordx4 v[156:159], v2, s[16:19], s82 offen offset:3072 sc1
    s_waitcnt vmcnt(0)
    v_max3_u32 v17, v128, v132, v136
    v_max3_u32 v18, v140, v144, v148
    v_max3_u32 v17, v17, v152, v156
    v_max_u32 v17, v17, v18
    v_cmp_eq_u32 vcc, -1, v17
    s_cbranch_vccnz L_kd_retry7_spin
L_kd_ok7_x:
    s_branch L_kd_ok7
L_ke_first_again:
    s_mov_b32 s37, 262144
L_ke_first_spin:
    s_waitcnt vmcnt(0)
    s_add_u32 s81, s77, 0
    s_add_u32 s82, s81, s78
    buffer_load_dwordx4 v[32:35], v2, s[16:19], s81 offen offset:0 sc1
    buffer_load_dwordx4 v[36:39], v2, s[16:19], s82 offen offset:0 sc1
    buffer_load_dwordx4 v[40:43], v2, s[16:19], s81 offen offset:1024 sc1
    buffer_load_dwordx4 v[44:47], v2, s[16:19], s82 offen offset:1024 sc1
    buffer_load_dwordx4 v[48:51], v2, s[16:19], s81 offen offset:2048 sc1
    buffer_load_dwordx4 v[52:55], v2, s[16:19], s82 offen offset:2048 sc1
    buffer_load_dwordx4 v[56:59], v2, s[16:19], s81 offen offset:3072 sc1
    buffer_load_dwordx4 v[60:63], v2, s[16:19], s82 offen offset:3072 sc1
    s_add_u32 s81, s77, 4096
    s_add_u32 s82, s81, s78
    buffer_load_dwordx4 v[64:67], v2, s[16:19], s81 offen offset:0 sc1
    buffer_load_dwordx4 v[68:71], v2, s[16:19], s82 offen offset:0 sc1
    buffer_load_dwordx4 v[72:75], v2, s[16:19], s81 offen offset:1024 sc1
    buffer_load_dwordx4 v[76:79], v2, s[16:19], s82 offen offset:1024 sc1
    buffer_load_dwordx4 v[80:83], v2, s[16:19], s81 offen offset:2048 sc1
    buffer_load_dwordx4 v[84:87], v2, s[16:19], s82 offen offset:2048 sc1
    buffer_load_dwordx4 v[88:91], v2, s[16:19], s81 offen offset:3072 sc1
    buffer_load_dwordx4 v[92:95], v2, s[16:19], s82 offen offset:3072 sc1
    s_waitcnt vmcnt(8)
    s_sub_u32 s37, s37, 1
    s_cmp_eq_u32 s37, 0
    s_cbranch_scc1 L_ke_first_ok_x
    v_max3_u32 v17, v32, v36, v40
    v_max3_u32 v18, v44, v48, v52
    v_max3_u32 v17, v17, v56, v60
    v_max_u32 v17, v17, v18
    v_cmp_eq_u32 vcc, -1, v17
    s_cbranch_vccnz L_ke_first_spin
L_ke_first_ok_x:
    s_waitcnt vmcnt(0)
    s_branch L_ke_first_ok
L_ke_retry1:
    s_mov_b32 s37, 262144
    s_add_u32 s38, s32, 4096
L_ke_retry1_spin:
    buffer_load_dword v17, v16, s[16:19], s38 offen sc1
    s_waitcnt vmcnt(0)
    v_cmp_eq_u32 vcc, -1, v17
    s_sub_u32 s37, s37, 1
    s_cmp_eq_u32 s37, 0
    s_cbranch_scc1 L_ke_ok1
    s_cbranch_vccnz L_ke_retry1_spin
    s_add_u32 s81, s77, 4096
    s_add_u32 s82, s81, s78
    buffer_load_dwordx4 v[64:67], v2, s[16:19], s81 offen offset:0 sc1
    buffer_load_dwordx4 v[68:71], v2, s[16:19], s82 offen offset:0 sc1
    buffer_load_dwordx4 v[72:75], v2, s[16:19], s81 offen offset:1024 sc1
    buffer_load_dwordx4 v[76:79], v2, s[16:19], s82 offen offset:1024 sc1
    buffer_load_dwordx4 v[80:83], v2, s[16:19], s81 offen offset:2048 sc1
    buffer_load_dwordx4 v[84:87], v2, s[16:19], s82 offen offset:2048 sc1
    buffer_load_dwordx4 v[88:91], v2, s[16:19], s81 offen offset:3072 sc1
    buffer_load_dwordx4 v[92:95], v2, s[16:19], s82 offen offset:3072 sc1
    s_waitcnt vmcnt(0)
    v_max3_u32 v17, v64, v68, v72
    v_max3_u32 v18, v76, v80, v84
    v_max3_u32 v17, v17, v88, v92
    v_max_u32 v17, v17, v18
    v_cmp_eq_u32 vcc, -1, v17
    s_cbranch_vccnz L_ke_retry1_spin
L_ke_ok1_x:
    s_branch L_ke_ok1
L_ke_retry2:
    s_mov_b32 s37, 262144
    s_add_u32 s38, s32, 8192
L_ke_retry2_spin:
    buffer_load_dword v17, v16, s[16:19], s38 offen sc1
    s_waitcnt vmcnt(0)
    v_cmp_eq_u32 vcc, -1, v17
    s_sub_u32 s37, s37, 1
    s_cmp_eq_u32 s37, 0
    s_cbranch_scc1 L_ke_ok2
    s_cbranch_vccnz L_ke_retry2_spin
    s_add_u32 s81, s77, 8192
    s_add_u32 s82, s81, s78
    buffer_load_dwordx4 v[96:99], v2, s[16:19], s81 offen offset:0 sc1
    buffer_load_dwordx4 v[100:103], v2, s[16:19], s82 offen offset:0 sc1
    buffer_load_dwordx4 v[104:107], v2, s[16:19], s81 offen offset:1024 sc1
    buffer_load_dwordx4 v[108:111], v2, s[16:19], s82 offen offset:1024 sc1
    buffer_load_dwordx4 v[112:115], v2, s[16:19], s81 offen offset:2048 sc1
    buffer_load_dwordx4 v[116:119], v2, s[16:19], s82 offen offset:2048 sc1
    buffer_load_dwordx4 v[120:123], v2, s[16:19], s81 offen offset:3072 sc1
    buffer_load_dwordx4 v[124:127], v2, s[16:19], s82 offen offset:3072 sc1
    s_waitcnt vmcnt(0)
    v_max3_u32 v17, v96, v100, v104
    v_max3_u32 v18, v108, v112, v116
    v_max3_u32 v17, v17, v120, v124
    v_max_u32 v17, v17, v18
    v_cmp_eq_u32 vcc, -1, v17
    s_cbranch_vccnz L_ke_retry2_spin
L_ke_ok2_x:
    s_branch L_ke_ok2
L_ke_retry3:
    s_mov_b32 s37, 262144
    s_add_u32 s38, s32, 12288
L_ke_retry3_spin:
    buffer_load_dword v17, v16, s[16:19], s38 offen sc1
    s_waitcnt vmcnt(0)
    v_cmp_eq_u32 vcc, -1, v17
    s_sub_u32 s37, s37, 1
    s_cmp_eq_u32 s37, 0
    s_cbranch_scc1 L_ke_ok3
    s_cbranch_vccnz L_ke_retry3_spin
    s_add_u32 s81, s77, 12288
    s_add_u32 s82, s81, s78
    buffer_load_dwordx4 v[128:131], v2, s[16:19], s81 offen offset:0 sc1
    buffer_load_dwordx4 v[132:135], v2, s[16:19], s82 offen offset:0 sc1
    buffer_load_dwordx4 v[136:139], v2, s[16:19], s81 offen offset:1024 sc1
    buffer_load_dwordx4 v[140:143], v2, s[16:19], s82 offen offset:1024 sc1
    buffer_load_dwordx4 v[144:147], v2, s[16:19], s81 offen offset:2048 sc1
    buffer_load_dwordx4 v[148:151], v2, s[16:19], s82 offen offset:2048 sc1
    buffer_load_dwordx4 v[152:155], v2, s[16:19], s81 offen offset:3072 sc1
    buffer_load_dwordx4 v[156:159], v2, s[16:19], s82 offen offset:3072 sc1
    s_waitcnt vmcnt(0)
    v_max3_u32 v17, v128, v132, v136
    v_max3_u32 v18, v140, v144, v148
    v_max3_u32 v17, v17, v152, v156
    v_max_u32 v17, v17, v18
    v_cmp_eq_u32 vcc, -1, v17
    s_cbranch_vccnz L_ke_retry3_spin
L_ke_ok3_x:
    s_branch L_ke_ok3
L_ke_retry4:
    s_mov_b32 s37, 262144
    s_add_u32 s38, s32, 16384
L_ke_retry4_spin:
    buffer_load_dword v17, v16, s[16:19], s38 offen sc1
    s_waitcnt vmcnt(0)
    v_cmp_eq_u32 vcc, -1, v17
    s_sub_u32 s37, s37, 1
    s_cmp_eq_u32 s37, 0
    s_cbranch_scc1 L_ke_ok4
    s_cbranch_vccnz L_ke_retry4_spin
    s_add_u32 s81, s77, 16384
    s_add_u32 s82, s81, s78
    buffer_load_dwordx4 v[32:35], v2, s[16:19], s81 offen offset:0 sc1
    buffer_load_dwordx4 v[36:39], v2, s[16:19], s82 offen offset:0 sc1
    buffer_load_dwordx4 v[40:43], v2, s[16:19], s81 offen offset:1024 sc1
    buffer_load_dwordx4 v[44:47], v2, s[16:19], s82 offen offset:1024 sc1
    buffer_load_dwordx4 v[48:51], v2, s[16:19], s81 offen offset:2048 sc1
    buffer_load_dwordx4 v[52:55], v2, s[16:19], s82 offen offset:2048 sc1
    buffer_load_dwordx4 v[56:59], v2, s[16:19], s81 offen offset:3072 sc1
    buffer_load_dwordx4 v[60:63], v2, s[16:19], s82 offen offset:3072 sc1
    s_waitcnt vmcnt(0)
    v_max3_u32 v17, v32, v36, v40
    v_max3_u32 v18, v44, v48, v52
    v_max3_u32 v17, v17, v56, v60
    v_max_u32 v17, v17, v18
    v_cmp_eq_u32 vcc, -1, v17
    s_cbranch_vccnz L_ke_retry4_spin
L_ke_ok4_x:
    s_branch L_ke_ok4
L_ke_retry5:
    s_mov_b32 s37, 262144
    s_add_u32 s38, s32, 20480
L_ke_retry5_spin:
    buffer_load_dword v17, v16, s[16:19], s38 offen sc1
    s_waitcnt vmcnt(0)
    v_cmp_eq_u32 vcc, -1, v17
    s_sub_u32 s37, s37, 1
    s_cmp_eq_u32 s37, 0
    s_cbranch_scc1 L_ke_ok5
    s_cbranch_vccnz L_ke_retry5_spin
    s_add_u32 s81, s77, 20480
    s_add_u32 s82, s81, s78
    buffer_load_dwordx4 v[64:67], v2, s[16:19], s81 offen offset:0 sc1
    buffer_load_dwordx4 v[68:71], v2, s[16:19], s82 offen offset:0 sc1
    buffer_load_dwordx4 v[72:75], v2, s[16:19], s81 offen offset:1024 sc1
    buffer_load_dwordx4 v[76:79], v2, s[16:19], s82 offen offset:1024 sc1
    buffer_load_dwordx4 v[80:83], v2, s[16:19], s81 offen offset:2048 sc1
    buffer_load_dwordx4 v[84:87], v2, s[16:19], s82 offen offset:2048 sc1
    buffer_load_dwordx4 v[88:91], v2, s[16:19], s81 offen offset:3072 sc1
    buffer_load_dwordx4 v[92:95], v2, s[16:19], s82 offen offset:3072 sc1
    s_waitcnt vmcnt(0)
    v_max3_u32 v17, v64, v68, v72
    v_max3_u32 v18, v76, v80, v84
    v_max3_u32 v17, v17, v88, v92
    v_max_u32 v17, v17, v18
    v_cmp_eq_u32 vcc, -1, v17
    s_cbranch_vccnz L_ke_retry5_spin
L_ke_ok5_x:
    s_branch L_ke_ok5
L_ke_retry6:
    s_mov_b32 s37, 262144
    s_add_u32 s38, s32, 24576
L_ke_retry6_spin:
    buffer_load_dword v17, v16, s[16:19], s38 offen sc1
    s_waitcnt vmcnt(0)
    v_cmp_eq_u32 vcc, -1, v17
    s_sub_u32 s37, s37, 1
    s_cmp_eq_u32 s37, 0
    s_cbranch_scc1 L_ke_ok6
    s_cbranch_vccnz L_ke_retry6_spin
    s_add_u32 s81, s77, 24576
    s_add_u32 s82, s81, s78
    buffer_load_dwordx4 v[96:99], v2, s[16:19], s81 offen offset:0 sc1
    buffer_load_dwordx4 v[100:103], v2, s[16:19], s82 offen offset:0 sc1
    buffer_load_dwordx4 v[104:107], v2, s[16:19], s81 offen offset:1024 sc1
    buffer_load_dwordx4 v[108:111], v2, s[16:19], s82 offen offset:1024 sc1
    buffer_load_dwordx4 v[112:115], v2, s[16:19], s81 offen offset:2048 sc1
    buffer_load_dwordx4 v[116:119], v2, s[16:19], s82 offen offset:2048 sc1
    buffer_load_dwordx4 v[120:123], v2, s[16:19], s81 offen offset:3072 sc1
    buffer_load_dwordx4 v[124:127], v2, s[16:19], s82 offen offset:3072 sc1
    s_waitcnt vmcnt(0)
    v_max3_u32 v17, v96, v100, v104
    v_max3_u32 v18, v108, v112, v116
    v_max3_u32 v17, v17, v120, v124
    v_max_u32 v17, v17, v18
    v_cmp_eq_u32 vcc, -1, v17
    s_cbranch_vccnz L_ke_retry6_spin
L_ke_ok6_x:
    s_branch L_ke_ok6
L_F_fin:
L_sequential_preLN__mha_block__mixer_token_mlp__prompt_kernel_end:
    s_endpgm
L_k2_code_end:
.section .rodata,"a"
.p2align 6
.amdhsa_kernel sequential_preLN__mha_block__mixer_token_mlp__prompt_kernel
  .amdhsa_next_free_vgpr 512
  .amdhsa_next_free_sgpr 100
  .amdhsa_accum_offset 256
  .amdhsa_group_segment_fixed_size 0
  .amdhsa_kernarg_size 88
  .amdhsa_user_sgpr_count 2
  .amdhsa_user_sgpr_kernarg_segment_ptr 1
  .amdhsa_system_sgpr_workgroup_id_x 1
.end_amdhsa_kernel
```
